```python
import torch

def _softmax(x, axis=-1):
    return torch.softmax(x, dim=axis)
def _gelu(x):
    return torch.nn.functional.gelu(x, approximate="tanh")
def _silu(x):
    return torch.nn.functional.silu(x)
def _sigmoid(x):
    return torch.sigmoid(x)
def _layernorm(x, axis=-1, eps=1e-5):
    m = x.mean(dim=axis, keepdim=True)
    v = x.var(dim=axis, keepdim=True, unbiased=False)
    return (x - m) / torch.sqrt(v + eps)
def _scatter_add(tgt, idx, src, axis=0):
    return tgt.clone().index_add_(axis, idx, src)
def _segment_sum(src, seg, n):
    out = torch.zeros((n,) + src.shape[1:], dtype=src.dtype)
    return out.index_add_(0, seg, src)
def _pad(x, pw):
    flat = tuple(v for pair in reversed(pw) for v in pair)
    return torch.nn.functional.pad(x, flat)

kernel_name = 'parallel_sum__mha_block_cached__dense_activation_gelu__decode'

def setup_inputs():

    _w = (lambda a: (lambda t: t.to(torch.bfloat16) if t.is_floating_point() else t)(torch.as_tensor(a)))
    def _A_setup():
        B, Sq, D = 8, 1, 512
        H, Sk, Dh = 32, 4096, 128
        return {
            "x": _w((lambda *s: torch.randn(*s, dtype=torch.bfloat16) * 0.05)(B, Sq, D)),
            "k_cache": _w((lambda *s: torch.randn(*s, dtype=torch.bfloat16) * 3.2)(B, H, Sk, Dh)),
            "v_cache": _w((lambda *s: torch.randn(*s, dtype=torch.bfloat16) * 0.8)(B, H, Sk, Dh)),
            "wq": _w((lambda *s: torch.randn(*s, dtype=torch.bfloat16) * 3.2)(D, H * Dh) * (D ** -0.5)),
            "wo": _w((lambda *s: torch.randn(*s, dtype=torch.bfloat16) * 0.8)(H * Dh, D) * ((H * Dh) ** -0.5)),
        }
    _A_in = _A_setup()

    def _B_setup():
        B, S, D, F = 8, 1, 512, 1792
        return {
            "x": _w((lambda *s: torch.randn(*s, dtype=torch.bfloat16) * 0.05)(B, S, D)),
            "w1": _w((lambda *s: torch.randn(*s, dtype=torch.bfloat16) * 3.2)(D, F) * (D ** -0.5)),
            "b1": _w((lambda *s: torch.randn(*s, dtype=torch.bfloat16) * 3.2)(F) * 0.01),
            "w2": _w((lambda *s: torch.randn(*s, dtype=torch.bfloat16) * 0.4)(F, D) * (F ** -0.5)),
            "b2": _w((lambda *s: torch.randn(*s, dtype=torch.bfloat16) * 0.4)(D) * 0.01),
        }
    _B_in = _B_setup()

    return {
        "A_x": _A_in["x"],
        "A_k_cache": _A_in["k_cache"],
        "A_v_cache": _A_in["v_cache"],
        "A_wq": _A_in["wq"],
        "A_wo": _A_in["wo"],
        "B_x": _B_in["x"],
        "B_w1": _B_in["w1"],
        "B_b1": _B_in["b1"],
        "B_w2": _B_in["w2"],
        "B_b2": _B_in["b2"],
    }

def reference(A_x, A_k_cache, A_v_cache, A_wq, A_wo, B_x, B_w1, B_b1, B_w2, B_b2):
    def _A_ref(x, k_cache, v_cache, wq, wo):
        B, Sq, D = x.shape
        H, Dh = 32, 128
        q = (lambda x, *d: x.permute(*d))((x @ wq).reshape(B, Sq, H, Dh), 0, 2, 1, 3)
        scores = torch.einsum("bhqd,bhkd->bhqk", q, k_cache) * (Dh ** -0.5)
        p = _softmax(scores, axis=-1)
        o = torch.einsum("bhqk,bhkd->bhqd", p, v_cache)
        return (lambda x, *d: x.permute(*d))(o, 0, 2, 1, 3).reshape(B, Sq, H * Dh) @ wo

    def _B_ref(x, w1, b1, w2, b2):
        h = torch.einsum("bsd,df->bsf", x, w1) + b1
        h = _gelu(h)
        return torch.einsum("bsf,fd->bsd", h, w2) + b2

    x = A_x
    xn = _layernorm(x, axis=-1)
    return x + _A_ref(xn, A_k_cache, A_v_cache, A_wq, A_wo) + _B_ref(xn, B_w1, B_b1, B_w2, B_b2)
```

```asm
; @launch grid=(256,1,1) block=(512,1,1) lds=6400
.amdgcn_target "amdgcn-amd-amdhsa--gfx950"
.text
.globl parallel_sum__mha_block_cached__dense_activation_gelu__decode_kernel
.p2align 8
.type parallel_sum__mha_block_cached__dense_activation_gelu__decode_kernel,@function
parallel_sum__mha_block_cached__dense_activation_gelu__decode_kernel:
    s_cmp_ge_u32 s2, 256
    s_cbranch_scc1 L_done
    s_load_dwordx16 s[16:31], s[0:1], 0
    s_load_dwordx8 s[32:39], s[0:1], 64
    s_load_dwordx2 s[40:41], s[0:1], 96
    v_lshrrev_b32 v1, 6, v0
    v_and_b32 v0, 63, v0
    v_readfirstlane_b32 s3, v1
    v_lshlrev_b32 v1, 4, v0
    v_and_b32 v2, 15, v0
    v_lshrrev_b32 v3, 4, v0
    s_lshr_b32 s4, s2, 5
    s_and_b32 s5, s2, 31
    s_and_b32 s8, s3, 3
    s_cmp_ge_u32 s3, 4
    s_cbranch_scc1 L_helper
    s_setprio 2
    s_lshl_b32 s6, s2, 20
    s_mul_i32 s7, s8, 4096
    s_add_u32 s6, s6, s7
    s_waitcnt lgkmcnt(0)
    s_mov_b32 s44, s18
    s_mov_b32 s45, s19
    s_mov_b32 s46, 268435456
    s_mov_b32 s47, 0x20000
    s_add_u32 s77, s6, 0
    buffer_load_dwordx4 v[64:67], v1, s[44:47], s77 offen offset:0 nt
    buffer_load_dwordx4 v[68:71], v1, s[44:47], s77 offen offset:1024 nt
    buffer_load_dwordx4 v[72:75], v1, s[44:47], s77 offen offset:2048 nt
    buffer_load_dwordx4 v[76:79], v1, s[44:47], s77 offen offset:3072 nt
    s_add_u32 s78, s6, 16384
    buffer_load_dwordx4 v[80:83], v1, s[44:47], s78 offen offset:0 nt
    buffer_load_dwordx4 v[84:87], v1, s[44:47], s78 offen offset:1024 nt
    s_mov_b32 s48, s20
    s_mov_b32 s49, s21
    s_mov_b32 s50, 268435456
    s_mov_b32 s51, 0x20000
    s_mov_b32 s68, s40
    s_mov_b32 s69, s41
    s_mov_b32 s70, 16777216
    s_mov_b32 s71, 0x20000
    v_lshl_add_u32 v7, v3, 5, v2
    v_lshlrev_b32 v7, 2, v7
    s_lshl_b32 s7, s8, 9
    v_add_u32 v7, s7, v7
    v_mov_b32 v60, 0xffff
    v_mov_b32 v61, 0xffff0000
    v_cmp_eq_u32 vcc, 0, v2
    s_nop 1
    v_cndmask_b32 v8, 0, v60, vcc
    v_cmp_eq_u32 vcc, 1, v2
    s_nop 1
    v_cndmask_b32 v8, v8, v61, vcc
    v_cmp_eq_u32 vcc, 2, v2
    s_nop 1
    v_cndmask_b32 v9, 0, v60, vcc
    v_cmp_eq_u32 vcc, 3, v2
    s_nop 1
    v_cndmask_b32 v9, v9, v61, vcc
    v_cmp_eq_u32 vcc, 4, v2
    s_nop 1
    v_cndmask_b32 v10, 0, v60, vcc
    v_cmp_eq_u32 vcc, 5, v2
    s_nop 1
    v_cndmask_b32 v10, v10, v61, vcc
    v_cmp_eq_u32 vcc, 6, v2
    s_nop 1
    v_cndmask_b32 v11, 0, v60, vcc
    v_cmp_eq_u32 vcc, 7, v2
    s_nop 1
    v_cndmask_b32 v11, v11, v61, vcc
    s_mov_b32 s92, 0xcccccccc
    s_mov_b32 s93, 0xcccccccc
    s_mov_b32 s94, 0xaaaaaaaa
    s_mov_b32 s95, 0xaaaaaaaa
    s_mov_b32 s96, 0x00ff00ff
    s_mov_b32 s97, 0x00ff00ff
    v_lshlrev_b32 v4, 5, v2
    v_and_b32 v5, 3, v0
    v_lshlrev_b32 v5, 3, v5
    s_lshl_b32 s7, s8, 3
    v_mov_b32 v6, s7
    s_waitcnt vmcnt(5)
    buffer_load_dwordx4 v[88:91], v1, s[44:47], s78 offen offset:2048 nt
    s_waitcnt vmcnt(5)
    buffer_load_dwordx4 v[92:95], v1, s[44:47], s78 offen offset:3072 nt
    s_waitcnt vmcnt(5)
    s_add_u32 s79, s6, 32768
    buffer_load_dwordx4 v[96:99], v1, s[44:47], s79 offen offset:0 nt
    s_waitcnt vmcnt(5)
    buffer_load_dwordx4 v[100:103], v1, s[44:47], s79 offen offset:1024 nt
    s_waitcnt vmcnt(5)
    buffer_load_dwordx4 v[104:107], v1, s[44:47], s79 offen offset:2048 nt
    s_waitcnt vmcnt(5)
    buffer_load_dwordx4 v[108:111], v1, s[44:47], s79 offen offset:3072 nt
    s_waitcnt vmcnt(5)
    s_add_u32 s80, s6, 49152
    buffer_load_dwordx4 v[112:115], v1, s[44:47], s80 offen offset:0 nt
    s_waitcnt vmcnt(5)
    buffer_load_dwordx4 v[116:119], v1, s[44:47], s80 offen offset:1024 nt
    s_waitcnt vmcnt(5)
    buffer_load_dwordx4 v[120:123], v1, s[44:47], s80 offen offset:2048 nt
    s_waitcnt vmcnt(5)
    buffer_load_dwordx4 v[124:127], v1, s[44:47], s80 offen offset:3072 nt
    s_waitcnt vmcnt(5)
    s_add_u32 s81, s6, 65536
    buffer_load_dwordx4 v[128:131], v1, s[44:47], s81 offen offset:0 nt
    s_waitcnt vmcnt(5)
    buffer_load_dwordx4 v[132:135], v1, s[44:47], s81 offen offset:1024 nt
    s_waitcnt vmcnt(5)
    buffer_load_dwordx4 v[136:139], v1, s[44:47], s81 offen offset:2048 nt
    s_waitcnt vmcnt(5)
    buffer_load_dwordx4 v[140:143], v1, s[44:47], s81 offen offset:3072 nt
    s_waitcnt vmcnt(5)
    s_add_u32 s82, s6, 81920
    buffer_load_dwordx4 v[144:147], v1, s[44:47], s82 offen offset:0 nt
    s_waitcnt vmcnt(5)
    buffer_load_dwordx4 v[148:151], v1, s[44:47], s82 offen offset:1024 nt
    s_waitcnt vmcnt(5)
    buffer_load_dwordx4 v[152:155], v1, s[44:47], s82 offen offset:2048 nt
    s_waitcnt vmcnt(5)
    buffer_load_dwordx4 v[156:159], v1, s[44:47], s82 offen offset:3072 nt
    s_waitcnt vmcnt(5)
    s_add_u32 s83, s6, 98304
    buffer_load_dwordx4 v[160:163], v1, s[44:47], s83 offen offset:0 nt
    s_waitcnt vmcnt(5)
    buffer_load_dwordx4 v[164:167], v1, s[44:47], s83 offen offset:1024 nt
    s_waitcnt vmcnt(5)
    buffer_load_dwordx4 v[168:171], v1, s[44:47], s83 offen offset:2048 nt
    s_waitcnt vmcnt(5)
    buffer_load_dwordx4 v[172:175], v1, s[44:47], s83 offen offset:3072 nt
    s_waitcnt vmcnt(5)
    s_add_u32 s84, s6, 114688
    buffer_load_dwordx4 v[176:179], v1, s[44:47], s84 offen offset:0 nt
    s_waitcnt vmcnt(5)
    buffer_load_dwordx4 v[180:183], v1, s[44:47], s84 offen offset:1024 nt
    s_waitcnt vmcnt(5)
    buffer_load_dwordx4 v[184:187], v1, s[44:47], s84 offen offset:2048 nt
    s_waitcnt vmcnt(5)
    buffer_load_dwordx4 v[188:191], v1, s[44:47], s84 offen offset:3072 nt
    s_waitcnt vmcnt(5)
    s_add_u32 s85, s6, 131072
    buffer_load_dwordx4 v[192:195], v1, s[44:47], s85 offen offset:0 nt
    s_waitcnt vmcnt(5)
    buffer_load_dwordx4 v[196:199], v1, s[44:47], s85 offen offset:1024 nt
    s_waitcnt vmcnt(5)
    buffer_load_dwordx4 v[200:203], v1, s[44:47], s85 offen offset:2048 nt
    s_waitcnt vmcnt(5)
    buffer_load_dwordx4 v[204:207], v1, s[44:47], s85 offen offset:3072 nt
    s_waitcnt vmcnt(5)
    s_add_u32 s86, s6, 147456
    buffer_load_dwordx4 v[208:211], v1, s[44:47], s86 offen offset:0 nt
    s_waitcnt vmcnt(5)
    buffer_load_dwordx4 v[212:215], v1, s[44:47], s86 offen offset:1024 nt
    s_waitcnt vmcnt(5)
    buffer_load_dwordx4 v[216:219], v1, s[44:47], s86 offen offset:2048 nt
    s_barrier
    ds_read_b128 v[32:35], v4 offset:0
    ds_read_b128 v[36:39], v4 offset:16
    ds_read_b128 v[40:43], v4 offset:512
    ds_read_b128 v[44:47], v4 offset:528
    ds_read_b128 v[48:51], v4 offset:1024
    ds_read_b128 v[52:55], v4 offset:1040
    ds_read_b128 v[56:59], v4 offset:1536
    ds_read_b128 v[60:63], v4 offset:1552
    s_waitcnt vmcnt(5)
    buffer_load_dwordx4 v[220:223], v1, s[44:47], s86 offen offset:3072 nt
    s_waitcnt lgkmcnt(0)
    v_pk_add_f32 v[32:33], v[32:33], v[40:41]
    v_pk_add_f32 v[48:49], v[48:49], v[56:57]
    v_pk_add_f32 v[34:35], v[34:35], v[42:43]
    v_pk_add_f32 v[50:51], v[50:51], v[58:59]
    v_pk_add_f32 v[36:37], v[36:37], v[44:45]
    v_pk_add_f32 v[52:53], v[52:53], v[60:61]
    v_pk_add_f32 v[38:39], v[38:39], v[46:47]
    v_pk_add_f32 v[54:55], v[54:55], v[62:63]
    v_pk_add_f32 v[32:33], v[32:33], v[48:49]
    v_pk_add_f32 v[34:35], v[34:35], v[50:51]
    v_pk_add_f32 v[36:37], v[36:37], v[52:53]
    v_pk_add_f32 v[38:39], v[38:39], v[54:55]
    v_cvt_pk_bf16_f32 v12, v32, v33
    v_cvt_pk_bf16_f32 v13, v34, v35
    v_cvt_pk_bf16_f32 v14, v36, v37
    v_cvt_pk_bf16_f32 v15, v38, v39
    v_dot2_f32_bf16 v44, v64, v12, 0
    v_dot2_f32_bf16 v44, v65, v13, v44
    v_dot2_f32_bf16 v44, v66, v14, v44
    v_dot2_f32_bf16 v44, v67, v15, v44
    v_dot2_f32_bf16 v45, v68, v12, 0
    v_dot2_f32_bf16 v45, v69, v13, v45
    v_dot2_f32_bf16 v45, v70, v14, v45
    v_dot2_f32_bf16 v45, v71, v15, v45
    v_dot2_f32_bf16 v46, v72, v12, 0
    v_dot2_f32_bf16 v46, v73, v13, v46
    v_dot2_f32_bf16 v46, v74, v14, v46
    v_dot2_f32_bf16 v46, v75, v15, v46
    v_add_f32_dpp v44, v44, v44 row_ror:8 row_mask:0xf bank_mask:0x3
    s_nop 1
    v_add_f32_dpp v44, v45, v45 row_ror:8 row_mask:0xf bank_mask:0xc
    v_dot2_f32_bf16 v47, v76, v12, 0
    v_dot2_f32_bf16 v47, v77, v13, v47
    v_dot2_f32_bf16 v47, v78, v14, v47
    v_dot2_f32_bf16 v47, v79, v15, v47
    s_waitcnt vmcnt(5)
    s_add_u32 s87, s6, 163840
    buffer_load_dwordx4 v[224:227], v1, s[44:47], s87 offen offset:0 nt
    v_dot2_f32_bf16 v48, v80, v12, 0
    v_dot2_f32_bf16 v48, v81, v13, v48
    v_dot2_f32_bf16 v48, v82, v14, v48
    v_dot2_f32_bf16 v48, v83, v15, v48
    v_add_f32_dpp v46, v46, v46 row_ror:8 row_mask:0xf bank_mask:0x3
    s_nop 1
    v_add_f32_dpp v46, v47, v47 row_ror:8 row_mask:0xf bank_mask:0xc
    v_dot2_f32_bf16 v49, v84, v12, 0
    v_dot2_f32_bf16 v49, v85, v13, v49
    v_dot2_f32_bf16 v49, v86, v14, v49
    v_dot2_f32_bf16 v49, v87, v15, v49
    v_add_f32_dpp v44, v44, v44 row_half_mirror row_mask:0xf bank_mask:0x5
    s_nop 1
    v_add_f32_dpp v44, v46, v46 row_half_mirror row_mask:0xf bank_mask:0xa
    v_dot2_f32_bf16 v50, v88, v12, 0
    v_dot2_f32_bf16 v50, v89, v13, v50
    v_dot2_f32_bf16 v50, v90, v14, v50
    v_dot2_f32_bf16 v50, v91, v15, v50
    v_add_f32_dpp v48, v48, v48 row_ror:8 row_mask:0xf bank_mask:0x3
    s_nop 1
    v_add_f32_dpp v48, v49, v49 row_ror:8 row_mask:0xf bank_mask:0xc
    v_dot2_f32_bf16 v51, v92, v12, 0
    v_dot2_f32_bf16 v51, v93, v13, v51
    v_dot2_f32_bf16 v51, v94, v14, v51
    v_dot2_f32_bf16 v51, v95, v15, v51
    v_dot2_f32_bf16 v52, v96, v12, 0
    v_dot2_f32_bf16 v52, v97, v13, v52
    v_dot2_f32_bf16 v52, v98, v14, v52
    v_dot2_f32_bf16 v52, v99, v15, v52
    v_add_f32_dpp v50, v50, v50 row_ror:8 row_mask:0xf bank_mask:0x3
    s_nop 1
    v_add_f32_dpp v50, v51, v51 row_ror:8 row_mask:0xf bank_mask:0xc
    v_dot2_f32_bf16 v53, v100, v12, 0
    v_dot2_f32_bf16 v53, v101, v13, v53
    v_dot2_f32_bf16 v53, v102, v14, v53
    v_dot2_f32_bf16 v53, v103, v15, v53
    v_add_f32_dpp v48, v48, v48 row_half_mirror row_mask:0xf bank_mask:0x5
    s_nop 1
    v_add_f32_dpp v48, v50, v50 row_half_mirror row_mask:0xf bank_mask:0xa
    v_dot2_f32_bf16 v54, v104, v12, 0
    v_dot2_f32_bf16 v54, v105, v13, v54
    v_dot2_f32_bf16 v54, v106, v14, v54
    v_dot2_f32_bf16 v54, v107, v15, v54
    v_add_f32_dpp v52, v52, v52 row_ror:8 row_mask:0xf bank_mask:0x3
    s_nop 1
    v_add_f32_dpp v52, v53, v53 row_ror:8 row_mask:0xf bank_mask:0xc
    s_waitcnt vmcnt(5)
    buffer_load_dwordx4 v[228:231], v1, s[44:47], s87 offen offset:1024 nt
    v_dot2_f32_bf16 v55, v108, v12, 0
    v_dot2_f32_bf16 v55, v109, v13, v55
    v_dot2_f32_bf16 v55, v110, v14, v55
    v_dot2_f32_bf16 v55, v111, v15, v55
    v_add_f32_dpp v44, v44, v44 quad_perm:[2,3,0,1] row_mask:0xf bank_mask:0xf
    v_add_f32_dpp v48, v48, v48 quad_perm:[2,3,0,1] row_mask:0xf bank_mask:0xf
    v_cndmask_b32 v44, v44, v48, s[92:93]
    v_dot2_f32_bf16 v56, v112, v12, 0
    v_dot2_f32_bf16 v56, v113, v13, v56
    v_dot2_f32_bf16 v56, v114, v14, v56
    v_dot2_f32_bf16 v56, v115, v15, v56
    v_add_f32_dpp v54, v54, v54 row_ror:8 row_mask:0xf bank_mask:0x3
    s_nop 1
    v_add_f32_dpp v54, v55, v55 row_ror:8 row_mask:0xf bank_mask:0xc
    v_dot2_f32_bf16 v57, v116, v12, 0
    v_dot2_f32_bf16 v57, v117, v13, v57
    v_dot2_f32_bf16 v57, v118, v14, v57
    v_dot2_f32_bf16 v57, v119, v15, v57
    v_add_f32_dpp v52, v52, v52 row_half_mirror row_mask:0xf bank_mask:0x5
    s_nop 1
    v_add_f32_dpp v52, v54, v54 row_half_mirror row_mask:0xf bank_mask:0xa
    v_dot2_f32_bf16 v58, v120, v12, 0
    v_dot2_f32_bf16 v58, v121, v13, v58
    v_dot2_f32_bf16 v58, v122, v14, v58
    v_dot2_f32_bf16 v58, v123, v15, v58
    v_add_f32_dpp v56, v56, v56 row_ror:8 row_mask:0xf bank_mask:0x3
    s_nop 1
    v_add_f32_dpp v56, v57, v57 row_ror:8 row_mask:0xf bank_mask:0xc
    v_dot2_f32_bf16 v59, v124, v12, 0
    v_dot2_f32_bf16 v59, v125, v13, v59
    v_dot2_f32_bf16 v59, v126, v14, v59
    v_dot2_f32_bf16 v59, v127, v15, v59
    v_add_f32_dpp v58, v58, v58 row_ror:8 row_mask:0xf bank_mask:0x3
    s_nop 1
    v_add_f32_dpp v58, v59, v59 row_ror:8 row_mask:0xf bank_mask:0xc
    v_add_f32_dpp v56, v56, v56 row_half_mirror row_mask:0xf bank_mask:0x5
    s_nop 1
    v_add_f32_dpp v56, v58, v58 row_half_mirror row_mask:0xf bank_mask:0xa
    v_add_f32_dpp v52, v52, v52 quad_perm:[2,3,0,1] row_mask:0xf bank_mask:0xf
    s_nop 0
    v_add_f32_dpp v56, v56, v56 quad_perm:[2,3,0,1] row_mask:0xf bank_mask:0xf
    v_cndmask_b32 v52, v52, v56, s[92:93]
    v_add_f32_dpp v44, v44, v44 quad_perm:[1,0,3,2] row_mask:0xf bank_mask:0xf
    s_nop 0
    v_add_f32_dpp v52, v52, v52 quad_perm:[1,0,3,2] row_mask:0xf bank_mask:0xf
    v_cndmask_b32 v16, v44, v52, s[94:95]
    v_cvt_pk_bf16_f32 v16, v16, v16
    v_and_b32 v16, 0xffff0000, v16
    v_mul_f32 v16, 0x3db504f3, v16
    v_cvt_pk_bf16_f32 v16, v16, v16
    v_and_b32 v16, 0xffff0000, v16
    v_mov_b32 v60, v16
    s_waitcnt vmcnt(5)
    buffer_load_dwordx4 v[232:235], v1, s[44:47], s87 offen offset:2048 nt
    v_dot2_f32_bf16 v44, v128, v12, 0
    v_dot2_f32_bf16 v44, v129, v13, v44
    v_dot2_f32_bf16 v44, v130, v14, v44
    v_dot2_f32_bf16 v44, v131, v15, v44
    v_dot2_f32_bf16 v45, v132, v12, 0
    v_dot2_f32_bf16 v45, v133, v13, v45
    v_dot2_f32_bf16 v45, v134, v14, v45
    v_dot2_f32_bf16 v45, v135, v15, v45
    v_dot2_f32_bf16 v46, v136, v12, 0
    v_dot2_f32_bf16 v46, v137, v13, v46
    v_dot2_f32_bf16 v46, v138, v14, v46
    v_dot2_f32_bf16 v46, v139, v15, v46
    v_add_f32_dpp v44, v44, v44 row_ror:8 row_mask:0xf bank_mask:0x3
    s_nop 1
    v_add_f32_dpp v44, v45, v45 row_ror:8 row_mask:0xf bank_mask:0xc
    v_dot2_f32_bf16 v47, v140, v12, 0
    v_dot2_f32_bf16 v47, v141, v13, v47
    v_dot2_f32_bf16 v47, v142, v14, v47
    v_dot2_f32_bf16 v47, v143, v15, v47
    v_dot2_f32_bf16 v48, v144, v12, 0
    v_dot2_f32_bf16 v48, v145, v13, v48
    v_dot2_f32_bf16 v48, v146, v14, v48
    v_dot2_f32_bf16 v48, v147, v15, v48
    v_add_f32_dpp v46, v46, v46 row_ror:8 row_mask:0xf bank_mask:0x3
    s_nop 1
    v_add_f32_dpp v46, v47, v47 row_ror:8 row_mask:0xf bank_mask:0xc
    v_dot2_f32_bf16 v49, v148, v12, 0
    v_dot2_f32_bf16 v49, v149, v13, v49
    v_dot2_f32_bf16 v49, v150, v14, v49
    v_dot2_f32_bf16 v49, v151, v15, v49
    v_add_f32_dpp v44, v44, v44 row_half_mirror row_mask:0xf bank_mask:0x5
    s_nop 1
    v_add_f32_dpp v44, v46, v46 row_half_mirror row_mask:0xf bank_mask:0xa
    v_dot2_f32_bf16 v50, v152, v12, 0
    v_dot2_f32_bf16 v50, v153, v13, v50
    v_dot2_f32_bf16 v50, v154, v14, v50
    v_dot2_f32_bf16 v50, v155, v15, v50
    v_add_f32_dpp v48, v48, v48 row_ror:8 row_mask:0xf bank_mask:0x3
    s_nop 1
    v_add_f32_dpp v48, v49, v49 row_ror:8 row_mask:0xf bank_mask:0xc
    s_waitcnt vmcnt(5)
    buffer_load_dwordx4 v[236:239], v1, s[44:47], s87 offen offset:3072 nt
    v_dot2_f32_bf16 v51, v156, v12, 0
    v_dot2_f32_bf16 v51, v157, v13, v51
    v_dot2_f32_bf16 v51, v158, v14, v51
    v_dot2_f32_bf16 v51, v159, v15, v51
    v_dot2_f32_bf16 v52, v160, v12, 0
    v_dot2_f32_bf16 v52, v161, v13, v52
    v_dot2_f32_bf16 v52, v162, v14, v52
    v_dot2_f32_bf16 v52, v163, v15, v52
    v_add_f32_dpp v50, v50, v50 row_ror:8 row_mask:0xf bank_mask:0x3
    s_nop 1
    v_add_f32_dpp v50, v51, v51 row_ror:8 row_mask:0xf bank_mask:0xc
    v_dot2_f32_bf16 v53, v164, v12, 0
    v_dot2_f32_bf16 v53, v165, v13, v53
    v_dot2_f32_bf16 v53, v166, v14, v53
    v_dot2_f32_bf16 v53, v167, v15, v53
    v_add_f32_dpp v48, v48, v48 row_half_mirror row_mask:0xf bank_mask:0x5
    s_nop 1
    v_add_f32_dpp v48, v50, v50 row_half_mirror row_mask:0xf bank_mask:0xa
    v_dot2_f32_bf16 v54, v168, v12, 0
    v_dot2_f32_bf16 v54, v169, v13, v54
    v_dot2_f32_bf16 v54, v170, v14, v54
    v_dot2_f32_bf16 v54, v171, v15, v54
    v_add_f32_dpp v52, v52, v52 row_ror:8 row_mask:0xf bank_mask:0x3
    s_nop 1
    v_add_f32_dpp v52, v53, v53 row_ror:8 row_mask:0xf bank_mask:0xc
    v_dot2_f32_bf16 v55, v172, v12, 0
    v_dot2_f32_bf16 v55, v173, v13, v55
    v_dot2_f32_bf16 v55, v174, v14, v55
    v_dot2_f32_bf16 v55, v175, v15, v55
    v_add_f32_dpp v44, v44, v44 quad_perm:[2,3,0,1] row_mask:0xf bank_mask:0xf
    v_add_f32_dpp v48, v48, v48 quad_perm:[2,3,0,1] row_mask:0xf bank_mask:0xf
    v_cndmask_b32 v44, v44, v48, s[92:93]
    v_dot2_f32_bf16 v56, v176, v12, 0
    v_dot2_f32_bf16 v56, v177, v13, v56
    v_dot2_f32_bf16 v56, v178, v14, v56
    v_dot2_f32_bf16 v56, v179, v15, v56
    v_add_f32_dpp v54, v54, v54 row_ror:8 row_mask:0xf bank_mask:0x3
    s_nop 1
    v_add_f32_dpp v54, v55, v55 row_ror:8 row_mask:0xf bank_mask:0xc
    v_dot2_f32_bf16 v57, v180, v12, 0
    v_dot2_f32_bf16 v57, v181, v13, v57
    v_dot2_f32_bf16 v57, v182, v14, v57
    v_dot2_f32_bf16 v57, v183, v15, v57
    v_add_f32_dpp v52, v52, v52 row_half_mirror row_mask:0xf bank_mask:0x5
    s_nop 1
    v_add_f32_dpp v52, v54, v54 row_half_mirror row_mask:0xf bank_mask:0xa
    s_waitcnt vmcnt(4)
    s_add_u32 s88, s6, 180224
    buffer_load_dwordx4 v[240:243], v1, s[44:47], s88 offen offset:0 nt
    v_dot2_f32_bf16 v58, v184, v12, 0
    v_dot2_f32_bf16 v58, v185, v13, v58
    v_dot2_f32_bf16 v58, v186, v14, v58
    v_dot2_f32_bf16 v58, v187, v15, v58
    v_add_f32_dpp v56, v56, v56 row_ror:8 row_mask:0xf bank_mask:0x3
    s_nop 1
    v_add_f32_dpp v56, v57, v57 row_ror:8 row_mask:0xf bank_mask:0xc
    v_dot2_f32_bf16 v59, v188, v12, 0
    v_dot2_f32_bf16 v59, v189, v13, v59
    v_dot2_f32_bf16 v59, v190, v14, v59
    v_dot2_f32_bf16 v59, v191, v15, v59
    v_add_f32_dpp v58, v58, v58 row_ror:8 row_mask:0xf bank_mask:0x3
    s_nop 1
    v_add_f32_dpp v58, v59, v59 row_ror:8 row_mask:0xf bank_mask:0xc
    v_add_f32_dpp v56, v56, v56 row_half_mirror row_mask:0xf bank_mask:0x5
    s_nop 1
    v_add_f32_dpp v56, v58, v58 row_half_mirror row_mask:0xf bank_mask:0xa
    v_add_f32_dpp v52, v52, v52 quad_perm:[2,3,0,1] row_mask:0xf bank_mask:0xf
    s_nop 0
    v_add_f32_dpp v56, v56, v56 quad_perm:[2,3,0,1] row_mask:0xf bank_mask:0xf
    v_cndmask_b32 v52, v52, v56, s[92:93]
    v_add_f32_dpp v44, v44, v44 quad_perm:[1,0,3,2] row_mask:0xf bank_mask:0xf
    s_nop 0
    v_add_f32_dpp v52, v52, v52 quad_perm:[1,0,3,2] row_mask:0xf bank_mask:0xf
    v_cndmask_b32 v17, v44, v52, s[94:95]
    v_cvt_pk_bf16_f32 v17, v17, v17
    v_and_b32 v17, 0xffff0000, v17
    v_mul_f32 v17, 0x3db504f3, v17
    v_cvt_pk_bf16_f32 v17, v17, v17
    v_and_b32 v17, 0xffff0000, v17
    v_max_f32 v60, v60, v17
    v_dot2_f32_bf16 v44, v192, v12, 0
    v_dot2_f32_bf16 v44, v193, v13, v44
    v_dot2_f32_bf16 v44, v194, v14, v44
    v_dot2_f32_bf16 v44, v195, v15, v44
    v_dot2_f32_bf16 v45, v196, v12, 0
    v_dot2_f32_bf16 v45, v197, v13, v45
    v_dot2_f32_bf16 v45, v198, v14, v45
    v_dot2_f32_bf16 v45, v199, v15, v45
    s_waitcnt vmcnt(4)
    buffer_load_dwordx4 v[244:247], v1, s[44:47], s88 offen offset:1024 nt
    v_dot2_f32_bf16 v46, v200, v12, 0
    v_dot2_f32_bf16 v46, v201, v13, v46
    v_dot2_f32_bf16 v46, v202, v14, v46
    v_dot2_f32_bf16 v46, v203, v15, v46
    v_add_f32_dpp v44, v44, v44 row_ror:8 row_mask:0xf bank_mask:0x3
    s_nop 1
    v_add_f32_dpp v44, v45, v45 row_ror:8 row_mask:0xf bank_mask:0xc
    v_dot2_f32_bf16 v47, v204, v12, 0
    v_dot2_f32_bf16 v47, v205, v13, v47
    v_dot2_f32_bf16 v47, v206, v14, v47
    v_dot2_f32_bf16 v47, v207, v15, v47
    v_dot2_f32_bf16 v48, v208, v12, 0
    v_dot2_f32_bf16 v48, v209, v13, v48
    v_dot2_f32_bf16 v48, v210, v14, v48
    v_dot2_f32_bf16 v48, v211, v15, v48
    v_add_f32_dpp v46, v46, v46 row_ror:8 row_mask:0xf bank_mask:0x3
    s_nop 1
    v_add_f32_dpp v46, v47, v47 row_ror:8 row_mask:0xf bank_mask:0xc
    v_dot2_f32_bf16 v49, v212, v12, 0
    v_dot2_f32_bf16 v49, v213, v13, v49
    v_dot2_f32_bf16 v49, v214, v14, v49
    v_dot2_f32_bf16 v49, v215, v15, v49
    v_add_f32_dpp v44, v44, v44 row_half_mirror row_mask:0xf bank_mask:0x5
    s_nop 1
    v_add_f32_dpp v44, v46, v46 row_half_mirror row_mask:0xf bank_mask:0xa
    v_dot2_f32_bf16 v50, v216, v12, 0
    v_dot2_f32_bf16 v50, v217, v13, v50
    v_dot2_f32_bf16 v50, v218, v14, v50
    v_dot2_f32_bf16 v50, v219, v15, v50
    v_add_f32_dpp v48, v48, v48 row_ror:8 row_mask:0xf bank_mask:0x3
    s_nop 1
    v_add_f32_dpp v48, v49, v49 row_ror:8 row_mask:0xf bank_mask:0xc
    v_dot2_f32_bf16 v51, v220, v12, 0
    v_dot2_f32_bf16 v51, v221, v13, v51
    v_dot2_f32_bf16 v51, v222, v14, v51
    v_dot2_f32_bf16 v51, v223, v15, v51
    v_dot2_f32_bf16 v52, v224, v12, 0
    v_dot2_f32_bf16 v52, v225, v13, v52
    v_dot2_f32_bf16 v52, v226, v14, v52
    v_dot2_f32_bf16 v52, v227, v15, v52
    v_add_f32_dpp v50, v50, v50 row_ror:8 row_mask:0xf bank_mask:0x3
    s_nop 1
    v_add_f32_dpp v50, v51, v51 row_ror:8 row_mask:0xf bank_mask:0xc
    s_waitcnt vmcnt(4)
    buffer_load_dwordx4 v[248:251], v1, s[44:47], s88 offen offset:2048 nt
    v_dot2_f32_bf16 v53, v228, v12, 0
    v_dot2_f32_bf16 v53, v229, v13, v53
    v_dot2_f32_bf16 v53, v230, v14, v53
    v_dot2_f32_bf16 v53, v231, v15, v53
    v_add_f32_dpp v48, v48, v48 row_half_mirror row_mask:0xf bank_mask:0x5
    s_nop 1
    v_add_f32_dpp v48, v50, v50 row_half_mirror row_mask:0xf bank_mask:0xa
    s_waitcnt vmcnt(4)
    buffer_load_dwordx4 v[64:67], v1, s[44:47], s88 offen offset:3072 nt
    v_dot2_f32_bf16 v54, v232, v12, 0
    v_dot2_f32_bf16 v54, v233, v13, v54
    v_dot2_f32_bf16 v54, v234, v14, v54
    v_dot2_f32_bf16 v54, v235, v15, v54
    v_add_f32_dpp v52, v52, v52 row_ror:8 row_mask:0xf bank_mask:0x3
    s_nop 1
    v_add_f32_dpp v52, v53, v53 row_ror:8 row_mask:0xf bank_mask:0xc
    s_waitcnt vmcnt(4)
    s_add_u32 s89, s6, 196608
    buffer_load_dwordx4 v[68:71], v1, s[44:47], s89 offen offset:0 nt
    v_dot2_f32_bf16 v55, v236, v12, 0
    v_dot2_f32_bf16 v55, v237, v13, v55
    v_dot2_f32_bf16 v55, v238, v14, v55
    v_dot2_f32_bf16 v55, v239, v15, v55
    v_add_f32_dpp v44, v44, v44 quad_perm:[2,3,0,1] row_mask:0xf bank_mask:0xf
    v_add_f32_dpp v48, v48, v48 quad_perm:[2,3,0,1] row_mask:0xf bank_mask:0xf
    v_cndmask_b32 v44, v44, v48, s[92:93]
    s_waitcnt vmcnt(4)
    buffer_load_dwordx4 v[72:75], v1, s[44:47], s89 offen offset:1024 nt
    v_dot2_f32_bf16 v56, v240, v12, 0
    v_dot2_f32_bf16 v56, v241, v13, v56
    v_dot2_f32_bf16 v56, v242, v14, v56
    v_dot2_f32_bf16 v56, v243, v15, v56
    v_add_f32_dpp v54, v54, v54 row_ror:8 row_mask:0xf bank_mask:0x3
    s_nop 1
    v_add_f32_dpp v54, v55, v55 row_ror:8 row_mask:0xf bank_mask:0xc
    s_waitcnt vmcnt(4)
    buffer_load_dwordx4 v[76:79], v1, s[44:47], s89 offen offset:2048 nt
    v_dot2_f32_bf16 v57, v244, v12, 0
    v_dot2_f32_bf16 v57, v245, v13, v57
    v_dot2_f32_bf16 v57, v246, v14, v57
    v_dot2_f32_bf16 v57, v247, v15, v57
    v_add_f32_dpp v52, v52, v52 row_half_mirror row_mask:0xf bank_mask:0x5
    s_nop 1
    v_add_f32_dpp v52, v54, v54 row_half_mirror row_mask:0xf bank_mask:0xa
    s_waitcnt vmcnt(4)
    buffer_load_dwordx4 v[80:83], v1, s[44:47], s89 offen offset:3072 nt
    v_dot2_f32_bf16 v58, v248, v12, 0
    v_dot2_f32_bf16 v58, v249, v13, v58
    v_dot2_f32_bf16 v58, v250, v14, v58
    v_dot2_f32_bf16 v58, v251, v15, v58
    v_add_f32_dpp v56, v56, v56 row_ror:8 row_mask:0xf bank_mask:0x3
    s_nop 1
    v_add_f32_dpp v56, v57, v57 row_ror:8 row_mask:0xf bank_mask:0xc
    s_waitcnt vmcnt(4)
    s_add_u32 s90, s6, 212992
    buffer_load_dwordx4 v[84:87], v1, s[44:47], s90 offen offset:0 nt
    v_dot2_f32_bf16 v59, v64, v12, 0
    v_dot2_f32_bf16 v59, v65, v13, v59
    v_dot2_f32_bf16 v59, v66, v14, v59
    v_dot2_f32_bf16 v59, v67, v15, v59
    v_add_f32_dpp v58, v58, v58 row_ror:8 row_mask:0xf bank_mask:0x3
    s_nop 1
    v_add_f32_dpp v58, v59, v59 row_ror:8 row_mask:0xf bank_mask:0xc
    v_add_f32_dpp v56, v56, v56 row_half_mirror row_mask:0xf bank_mask:0x5
    s_nop 1
    v_add_f32_dpp v56, v58, v58 row_half_mirror row_mask:0xf bank_mask:0xa
    v_add_f32_dpp v52, v52, v52 quad_perm:[2,3,0,1] row_mask:0xf bank_mask:0xf
    s_nop 0
    v_add_f32_dpp v56, v56, v56 quad_perm:[2,3,0,1] row_mask:0xf bank_mask:0xf
    v_cndmask_b32 v52, v52, v56, s[92:93]
    v_add_f32_dpp v44, v44, v44 quad_perm:[1,0,3,2] row_mask:0xf bank_mask:0xf
    s_nop 0
    v_add_f32_dpp v52, v52, v52 quad_perm:[1,0,3,2] row_mask:0xf bank_mask:0xf
    v_cndmask_b32 v18, v44, v52, s[94:95]
    v_cvt_pk_bf16_f32 v18, v18, v18
    v_and_b32 v18, 0xffff0000, v18
    v_mul_f32 v18, 0x3db504f3, v18
    v_cvt_pk_bf16_f32 v18, v18, v18
    v_and_b32 v18, 0xffff0000, v18
    v_max_f32 v60, v60, v18
    s_waitcnt vmcnt(4)
    buffer_load_dwordx4 v[88:91], v1, s[44:47], s90 offen offset:1024 nt
    v_dot2_f32_bf16 v44, v68, v12, 0
    v_dot2_f32_bf16 v44, v69, v13, v44
    v_dot2_f32_bf16 v44, v70, v14, v44
    v_dot2_f32_bf16 v44, v71, v15, v44
    s_waitcnt vmcnt(4)
    buffer_load_dwordx4 v[92:95], v1, s[44:47], s90 offen offset:2048 nt
    v_dot2_f32_bf16 v45, v72, v12, 0
    v_dot2_f32_bf16 v45, v73, v13, v45
    v_dot2_f32_bf16 v45, v74, v14, v45
    v_dot2_f32_bf16 v45, v75, v15, v45
    s_waitcnt vmcnt(4)
    buffer_load_dwordx4 v[96:99], v1, s[44:47], s90 offen offset:3072 nt
    v_dot2_f32_bf16 v46, v76, v12, 0
    v_dot2_f32_bf16 v46, v77, v13, v46
    v_dot2_f32_bf16 v46, v78, v14, v46
    v_dot2_f32_bf16 v46, v79, v15, v46
    v_add_f32_dpp v44, v44, v44 row_ror:8 row_mask:0xf bank_mask:0x3
    s_nop 1
    v_add_f32_dpp v44, v45, v45 row_ror:8 row_mask:0xf bank_mask:0xc
    s_waitcnt vmcnt(4)
    s_add_u32 s91, s6, 229376
    buffer_load_dwordx4 v[100:103], v1, s[44:47], s91 offen offset:0 nt
    v_dot2_f32_bf16 v47, v80, v12, 0
    v_dot2_f32_bf16 v47, v81, v13, v47
    v_dot2_f32_bf16 v47, v82, v14, v47
    v_dot2_f32_bf16 v47, v83, v15, v47
    s_waitcnt vmcnt(4)
    buffer_load_dwordx4 v[104:107], v1, s[44:47], s91 offen offset:1024 nt
    v_dot2_f32_bf16 v48, v84, v12, 0
    v_dot2_f32_bf16 v48, v85, v13, v48
    v_dot2_f32_bf16 v48, v86, v14, v48
    v_dot2_f32_bf16 v48, v87, v15, v48
    v_add_f32_dpp v46, v46, v46 row_ror:8 row_mask:0xf bank_mask:0x3
    s_nop 1
    v_add_f32_dpp v46, v47, v47 row_ror:8 row_mask:0xf bank_mask:0xc
    s_waitcnt vmcnt(4)
    buffer_load_dwordx4 v[108:111], v1, s[44:47], s91 offen offset:2048 nt
    v_dot2_f32_bf16 v49, v88, v12, 0
    v_dot2_f32_bf16 v49, v89, v13, v49
    v_dot2_f32_bf16 v49, v90, v14, v49
    v_dot2_f32_bf16 v49, v91, v15, v49
    v_add_f32_dpp v44, v44, v44 row_half_mirror row_mask:0xf bank_mask:0x5
    s_nop 1
    v_add_f32_dpp v44, v46, v46 row_half_mirror row_mask:0xf bank_mask:0xa
    s_waitcnt vmcnt(4)
    buffer_load_dwordx4 v[112:115], v1, s[44:47], s91 offen offset:3072 nt
    v_dot2_f32_bf16 v50, v92, v12, 0
    v_dot2_f32_bf16 v50, v93, v13, v50
    v_dot2_f32_bf16 v50, v94, v14, v50
    v_dot2_f32_bf16 v50, v95, v15, v50
    v_add_f32_dpp v48, v48, v48 row_ror:8 row_mask:0xf bank_mask:0x3
    s_nop 1
    v_add_f32_dpp v48, v49, v49 row_ror:8 row_mask:0xf bank_mask:0xc
    s_waitcnt vmcnt(4)
    s_add_u32 s76, s6, 245760
    buffer_load_dwordx4 v[116:119], v1, s[44:47], s76 offen offset:0 nt
    v_dot2_f32_bf16 v51, v96, v12, 0
    v_dot2_f32_bf16 v51, v97, v13, v51
    v_dot2_f32_bf16 v51, v98, v14, v51
    v_dot2_f32_bf16 v51, v99, v15, v51
    s_waitcnt vmcnt(4)
    buffer_load_dwordx4 v[120:123], v1, s[44:47], s76 offen offset:1024 nt
    v_dot2_f32_bf16 v52, v100, v12, 0
    v_dot2_f32_bf16 v52, v101, v13, v52
    v_dot2_f32_bf16 v52, v102, v14, v52
    v_dot2_f32_bf16 v52, v103, v15, v52
    v_add_f32_dpp v50, v50, v50 row_ror:8 row_mask:0xf bank_mask:0x3
    s_nop 1
    v_add_f32_dpp v50, v51, v51 row_ror:8 row_mask:0xf bank_mask:0xc
    s_waitcnt vmcnt(4)
    buffer_load_dwordx4 v[124:127], v1, s[44:47], s76 offen offset:2048 nt
    v_dot2_f32_bf16 v53, v104, v12, 0
    v_dot2_f32_bf16 v53, v105, v13, v53
    v_dot2_f32_bf16 v53, v106, v14, v53
    v_dot2_f32_bf16 v53, v107, v15, v53
    v_add_f32_dpp v48, v48, v48 row_half_mirror row_mask:0xf bank_mask:0x5
    s_nop 1
    v_add_f32_dpp v48, v50, v50 row_half_mirror row_mask:0xf bank_mask:0xa
    s_waitcnt vmcnt(4)
    buffer_load_dwordx4 v[128:131], v1, s[44:47], s76 offen offset:3072 nt
    v_dot2_f32_bf16 v54, v108, v12, 0
    v_dot2_f32_bf16 v54, v109, v13, v54
    v_dot2_f32_bf16 v54, v110, v14, v54
    v_dot2_f32_bf16 v54, v111, v15, v54
    v_add_f32_dpp v52, v52, v52 row_ror:8 row_mask:0xf bank_mask:0x3
    s_nop 1
    v_add_f32_dpp v52, v53, v53 row_ror:8 row_mask:0xf bank_mask:0xc
    s_waitcnt vmcnt(4)
    s_add_u32 s77, s6, 262144
    buffer_load_dwordx4 v[132:135], v1, s[44:47], s77 offen offset:0 nt
    v_dot2_f32_bf16 v55, v112, v12, 0
    v_dot2_f32_bf16 v55, v113, v13, v55
    v_dot2_f32_bf16 v55, v114, v14, v55
    v_dot2_f32_bf16 v55, v115, v15, v55
    v_add_f32_dpp v44, v44, v44 quad_perm:[2,3,0,1] row_mask:0xf bank_mask:0xf
    v_add_f32_dpp v48, v48, v48 quad_perm:[2,3,0,1] row_mask:0xf bank_mask:0xf
    v_cndmask_b32 v44, v44, v48, s[92:93]
    s_waitcnt vmcnt(4)
    buffer_load_dwordx4 v[136:139], v1, s[44:47], s77 offen offset:1024 nt
    v_dot2_f32_bf16 v56, v116, v12, 0
    v_dot2_f32_bf16 v56, v117, v13, v56
    v_dot2_f32_bf16 v56, v118, v14, v56
    v_dot2_f32_bf16 v56, v119, v15, v56
    v_add_f32_dpp v54, v54, v54 row_ror:8 row_mask:0xf bank_mask:0x3
    s_nop 1
    v_add_f32_dpp v54, v55, v55 row_ror:8 row_mask:0xf bank_mask:0xc
    s_waitcnt vmcnt(4)
    buffer_load_dwordx4 v[140:143], v1, s[44:47], s77 offen offset:2048 nt
    v_dot2_f32_bf16 v57, v120, v12, 0
    v_dot2_f32_bf16 v57, v121, v13, v57
    v_dot2_f32_bf16 v57, v122, v14, v57
    v_dot2_f32_bf16 v57, v123, v15, v57
    v_add_f32_dpp v52, v52, v52 row_half_mirror row_mask:0xf bank_mask:0x5
    s_nop 1
    v_add_f32_dpp v52, v54, v54 row_half_mirror row_mask:0xf bank_mask:0xa
    s_waitcnt vmcnt(4)
    buffer_load_dwordx4 v[144:147], v1, s[44:47], s77 offen offset:3072 nt
    v_dot2_f32_bf16 v58, v124, v12, 0
    v_dot2_f32_bf16 v58, v125, v13, v58
    v_dot2_f32_bf16 v58, v126, v14, v58
    v_dot2_f32_bf16 v58, v127, v15, v58
    v_add_f32_dpp v56, v56, v56 row_ror:8 row_mask:0xf bank_mask:0x3
    s_nop 1
    v_add_f32_dpp v56, v57, v57 row_ror:8 row_mask:0xf bank_mask:0xc
    s_waitcnt vmcnt(4)
    s_add_u32 s78, s6, 278528
    buffer_load_dwordx4 v[148:151], v1, s[44:47], s78 offen offset:0 nt
    v_dot2_f32_bf16 v59, v128, v12, 0
    v_dot2_f32_bf16 v59, v129, v13, v59
    v_dot2_f32_bf16 v59, v130, v14, v59
    v_dot2_f32_bf16 v59, v131, v15, v59
    v_add_f32_dpp v58, v58, v58 row_ror:8 row_mask:0xf bank_mask:0x3
    s_nop 1
    v_add_f32_dpp v58, v59, v59 row_ror:8 row_mask:0xf bank_mask:0xc
    v_add_f32_dpp v56, v56, v56 row_half_mirror row_mask:0xf bank_mask:0x5
    s_nop 1
    v_add_f32_dpp v56, v58, v58 row_half_mirror row_mask:0xf bank_mask:0xa
    v_add_f32_dpp v52, v52, v52 quad_perm:[2,3,0,1] row_mask:0xf bank_mask:0xf
    s_nop 0
    v_add_f32_dpp v56, v56, v56 quad_perm:[2,3,0,1] row_mask:0xf bank_mask:0xf
    v_cndmask_b32 v52, v52, v56, s[92:93]
    v_add_f32_dpp v44, v44, v44 quad_perm:[1,0,3,2] row_mask:0xf bank_mask:0xf
    s_nop 0
    v_add_f32_dpp v52, v52, v52 quad_perm:[1,0,3,2] row_mask:0xf bank_mask:0xf
    v_cndmask_b32 v19, v44, v52, s[94:95]
    v_cvt_pk_bf16_f32 v19, v19, v19
    v_and_b32 v19, 0xffff0000, v19
    v_mul_f32 v19, 0x3db504f3, v19
    v_cvt_pk_bf16_f32 v19, v19, v19
    v_and_b32 v19, 0xffff0000, v19
    v_max_f32 v60, v60, v19
    s_waitcnt vmcnt(4)
    buffer_load_dwordx4 v[152:155], v1, s[44:47], s78 offen offset:1024 nt
    v_dot2_f32_bf16 v44, v132, v12, 0
    v_dot2_f32_bf16 v44, v133, v13, v44
    v_dot2_f32_bf16 v44, v134, v14, v44
    v_dot2_f32_bf16 v44, v135, v15, v44
    s_waitcnt vmcnt(4)
    buffer_load_dwordx4 v[156:159], v1, s[44:47], s78 offen offset:2048 nt
    v_dot2_f32_bf16 v45, v136, v12, 0
    v_dot2_f32_bf16 v45, v137, v13, v45
    v_dot2_f32_bf16 v45, v138, v14, v45
    v_dot2_f32_bf16 v45, v139, v15, v45
    s_waitcnt vmcnt(4)
    buffer_load_dwordx4 v[160:163], v1, s[44:47], s78 offen offset:3072 nt
    v_dot2_f32_bf16 v46, v140, v12, 0
    v_dot2_f32_bf16 v46, v141, v13, v46
    v_dot2_f32_bf16 v46, v142, v14, v46
    v_dot2_f32_bf16 v46, v143, v15, v46
    v_add_f32_dpp v44, v44, v44 row_ror:8 row_mask:0xf bank_mask:0x3
    s_nop 1
    v_add_f32_dpp v44, v45, v45 row_ror:8 row_mask:0xf bank_mask:0xc
    s_waitcnt vmcnt(4)
    s_add_u32 s79, s6, 294912
    buffer_load_dwordx4 v[164:167], v1, s[44:47], s79 offen offset:0 nt
    v_dot2_f32_bf16 v47, v144, v12, 0
    v_dot2_f32_bf16 v47, v145, v13, v47
    v_dot2_f32_bf16 v47, v146, v14, v47
    v_dot2_f32_bf16 v47, v147, v15, v47
    s_waitcnt vmcnt(4)
    buffer_load_dwordx4 v[168:171], v1, s[44:47], s79 offen offset:1024 nt
    v_dot2_f32_bf16 v48, v148, v12, 0
    v_dot2_f32_bf16 v48, v149, v13, v48
    v_dot2_f32_bf16 v48, v150, v14, v48
    v_dot2_f32_bf16 v48, v151, v15, v48
    v_add_f32_dpp v46, v46, v46 row_ror:8 row_mask:0xf bank_mask:0x3
    s_nop 1
    v_add_f32_dpp v46, v47, v47 row_ror:8 row_mask:0xf bank_mask:0xc
    s_waitcnt vmcnt(4)
    buffer_load_dwordx4 v[172:175], v1, s[44:47], s79 offen offset:2048 nt
    v_dot2_f32_bf16 v49, v152, v12, 0
    v_dot2_f32_bf16 v49, v153, v13, v49
    v_dot2_f32_bf16 v49, v154, v14, v49
    v_dot2_f32_bf16 v49, v155, v15, v49
    v_add_f32_dpp v44, v44, v44 row_half_mirror row_mask:0xf bank_mask:0x5
    s_nop 1
    v_add_f32_dpp v44, v46, v46 row_half_mirror row_mask:0xf bank_mask:0xa
    s_waitcnt vmcnt(4)
    buffer_load_dwordx4 v[176:179], v1, s[44:47], s79 offen offset:3072 nt
    v_dot2_f32_bf16 v50, v156, v12, 0
    v_dot2_f32_bf16 v50, v157, v13, v50
    v_dot2_f32_bf16 v50, v158, v14, v50
    v_dot2_f32_bf16 v50, v159, v15, v50
    v_add_f32_dpp v48, v48, v48 row_ror:8 row_mask:0xf bank_mask:0x3
    s_nop 1
    v_add_f32_dpp v48, v49, v49 row_ror:8 row_mask:0xf bank_mask:0xc
    s_waitcnt vmcnt(4)
    s_add_u32 s80, s6, 311296
    buffer_load_dwordx4 v[180:183], v1, s[44:47], s80 offen offset:0 nt
    v_dot2_f32_bf16 v51, v160, v12, 0
    v_dot2_f32_bf16 v51, v161, v13, v51
    v_dot2_f32_bf16 v51, v162, v14, v51
    v_dot2_f32_bf16 v51, v163, v15, v51
    s_waitcnt vmcnt(4)
    buffer_load_dwordx4 v[184:187], v1, s[44:47], s80 offen offset:1024 nt
    v_dot2_f32_bf16 v52, v164, v12, 0
    v_dot2_f32_bf16 v52, v165, v13, v52
    v_dot2_f32_bf16 v52, v166, v14, v52
    v_dot2_f32_bf16 v52, v167, v15, v52
    v_add_f32_dpp v50, v50, v50 row_ror:8 row_mask:0xf bank_mask:0x3
    s_nop 1
    v_add_f32_dpp v50, v51, v51 row_ror:8 row_mask:0xf bank_mask:0xc
    s_waitcnt vmcnt(4)
    buffer_load_dwordx4 v[188:191], v1, s[44:47], s80 offen offset:2048 nt
    v_dot2_f32_bf16 v53, v168, v12, 0
    v_dot2_f32_bf16 v53, v169, v13, v53
    v_dot2_f32_bf16 v53, v170, v14, v53
    v_dot2_f32_bf16 v53, v171, v15, v53
    v_add_f32_dpp v48, v48, v48 row_half_mirror row_mask:0xf bank_mask:0x5
    s_nop 1
    v_add_f32_dpp v48, v50, v50 row_half_mirror row_mask:0xf bank_mask:0xa
    s_waitcnt vmcnt(4)
    buffer_load_dwordx4 v[192:195], v1, s[44:47], s80 offen offset:3072 nt
    v_dot2_f32_bf16 v54, v172, v12, 0
    v_dot2_f32_bf16 v54, v173, v13, v54
    v_dot2_f32_bf16 v54, v174, v14, v54
    v_dot2_f32_bf16 v54, v175, v15, v54
    v_add_f32_dpp v52, v52, v52 row_ror:8 row_mask:0xf bank_mask:0x3
    s_nop 1
    v_add_f32_dpp v52, v53, v53 row_ror:8 row_mask:0xf bank_mask:0xc
    s_waitcnt vmcnt(4)
    s_add_u32 s81, s6, 327680
    buffer_load_dwordx4 v[196:199], v1, s[44:47], s81 offen offset:0 nt
    v_dot2_f32_bf16 v55, v176, v12, 0
    v_dot2_f32_bf16 v55, v177, v13, v55
    v_dot2_f32_bf16 v55, v178, v14, v55
    v_dot2_f32_bf16 v55, v179, v15, v55
    v_add_f32_dpp v44, v44, v44 quad_perm:[2,3,0,1] row_mask:0xf bank_mask:0xf
    v_add_f32_dpp v48, v48, v48 quad_perm:[2,3,0,1] row_mask:0xf bank_mask:0xf
    v_cndmask_b32 v44, v44, v48, s[92:93]
    s_waitcnt vmcnt(4)
    buffer_load_dwordx4 v[200:203], v1, s[44:47], s81 offen offset:1024 nt
    v_dot2_f32_bf16 v56, v180, v12, 0
    v_dot2_f32_bf16 v56, v181, v13, v56
    v_dot2_f32_bf16 v56, v182, v14, v56
    v_dot2_f32_bf16 v56, v183, v15, v56
    v_add_f32_dpp v54, v54, v54 row_ror:8 row_mask:0xf bank_mask:0x3
    s_nop 1
    v_add_f32_dpp v54, v55, v55 row_ror:8 row_mask:0xf bank_mask:0xc
    s_waitcnt vmcnt(4)
    buffer_load_dwordx4 v[204:207], v1, s[44:47], s81 offen offset:2048 nt
    v_dot2_f32_bf16 v57, v184, v12, 0
    v_dot2_f32_bf16 v57, v185, v13, v57
    v_dot2_f32_bf16 v57, v186, v14, v57
    v_dot2_f32_bf16 v57, v187, v15, v57
    v_add_f32_dpp v52, v52, v52 row_half_mirror row_mask:0xf bank_mask:0x5
    s_nop 1
    v_add_f32_dpp v52, v54, v54 row_half_mirror row_mask:0xf bank_mask:0xa
    s_waitcnt vmcnt(4)
    buffer_load_dwordx4 v[208:211], v1, s[44:47], s81 offen offset:3072 nt
    v_dot2_f32_bf16 v58, v188, v12, 0
    v_dot2_f32_bf16 v58, v189, v13, v58
    v_dot2_f32_bf16 v58, v190, v14, v58
    v_dot2_f32_bf16 v58, v191, v15, v58
    v_add_f32_dpp v56, v56, v56 row_ror:8 row_mask:0xf bank_mask:0x3
    s_nop 1
    v_add_f32_dpp v56, v57, v57 row_ror:8 row_mask:0xf bank_mask:0xc
    s_waitcnt vmcnt(4)
    s_add_u32 s82, s6, 344064
    buffer_load_dwordx4 v[212:215], v1, s[44:47], s82 offen offset:0 nt
    v_dot2_f32_bf16 v59, v192, v12, 0
    v_dot2_f32_bf16 v59, v193, v13, v59
    v_dot2_f32_bf16 v59, v194, v14, v59
    v_dot2_f32_bf16 v59, v195, v15, v59
    v_add_f32_dpp v58, v58, v58 row_ror:8 row_mask:0xf bank_mask:0x3
    s_nop 1
    v_add_f32_dpp v58, v59, v59 row_ror:8 row_mask:0xf bank_mask:0xc
    v_add_f32_dpp v56, v56, v56 row_half_mirror row_mask:0xf bank_mask:0x5
    s_nop 1
    v_add_f32_dpp v56, v58, v58 row_half_mirror row_mask:0xf bank_mask:0xa
    v_add_f32_dpp v52, v52, v52 quad_perm:[2,3,0,1] row_mask:0xf bank_mask:0xf
    s_nop 0
    v_add_f32_dpp v56, v56, v56 quad_perm:[2,3,0,1] row_mask:0xf bank_mask:0xf
    v_cndmask_b32 v52, v52, v56, s[92:93]
    v_add_f32_dpp v44, v44, v44 quad_perm:[1,0,3,2] row_mask:0xf bank_mask:0xf
    s_nop 0
    v_add_f32_dpp v52, v52, v52 quad_perm:[1,0,3,2] row_mask:0xf bank_mask:0xf
    v_cndmask_b32 v20, v44, v52, s[94:95]
    v_cvt_pk_bf16_f32 v20, v20, v20
    v_and_b32 v20, 0xffff0000, v20
    v_mul_f32 v20, 0x3db504f3, v20
    v_cvt_pk_bf16_f32 v20, v20, v20
    v_and_b32 v20, 0xffff0000, v20
    v_max_f32 v60, v60, v20
    s_waitcnt vmcnt(4)
    buffer_load_dwordx4 v[216:219], v1, s[44:47], s82 offen offset:1024 nt
    v_dot2_f32_bf16 v44, v196, v12, 0
    v_dot2_f32_bf16 v44, v197, v13, v44
    v_dot2_f32_bf16 v44, v198, v14, v44
    v_dot2_f32_bf16 v44, v199, v15, v44
    s_waitcnt vmcnt(4)
    buffer_load_dwordx4 v[220:223], v1, s[44:47], s82 offen offset:2048 nt
    v_dot2_f32_bf16 v45, v200, v12, 0
    v_dot2_f32_bf16 v45, v201, v13, v45
    v_dot2_f32_bf16 v45, v202, v14, v45
    v_dot2_f32_bf16 v45, v203, v15, v45
    s_waitcnt vmcnt(4)
    buffer_load_dwordx4 v[224:227], v1, s[44:47], s82 offen offset:3072 nt
    v_dot2_f32_bf16 v46, v204, v12, 0
    v_dot2_f32_bf16 v46, v205, v13, v46
    v_dot2_f32_bf16 v46, v206, v14, v46
    v_dot2_f32_bf16 v46, v207, v15, v46
    v_add_f32_dpp v44, v44, v44 row_ror:8 row_mask:0xf bank_mask:0x3
    s_nop 1
    v_add_f32_dpp v44, v45, v45 row_ror:8 row_mask:0xf bank_mask:0xc
    s_waitcnt vmcnt(4)
    s_add_u32 s83, s6, 360448
    buffer_load_dwordx4 v[228:231], v1, s[44:47], s83 offen offset:0 nt
    v_dot2_f32_bf16 v47, v208, v12, 0
    v_dot2_f32_bf16 v47, v209, v13, v47
    v_dot2_f32_bf16 v47, v210, v14, v47
    v_dot2_f32_bf16 v47, v211, v15, v47
    s_waitcnt vmcnt(4)
    buffer_load_dwordx4 v[232:235], v1, s[44:47], s83 offen offset:1024 nt
    v_dot2_f32_bf16 v48, v212, v12, 0
    v_dot2_f32_bf16 v48, v213, v13, v48
    v_dot2_f32_bf16 v48, v214, v14, v48
    v_dot2_f32_bf16 v48, v215, v15, v48
    v_add_f32_dpp v46, v46, v46 row_ror:8 row_mask:0xf bank_mask:0x3
    s_nop 1
    v_add_f32_dpp v46, v47, v47 row_ror:8 row_mask:0xf bank_mask:0xc
    s_waitcnt vmcnt(4)
    buffer_load_dwordx4 v[236:239], v1, s[44:47], s83 offen offset:2048 nt
    v_dot2_f32_bf16 v49, v216, v12, 0
    v_dot2_f32_bf16 v49, v217, v13, v49
    v_dot2_f32_bf16 v49, v218, v14, v49
    v_dot2_f32_bf16 v49, v219, v15, v49
    v_add_f32_dpp v44, v44, v44 row_half_mirror row_mask:0xf bank_mask:0x5
    s_nop 1
    v_add_f32_dpp v44, v46, v46 row_half_mirror row_mask:0xf bank_mask:0xa
    s_waitcnt vmcnt(4)
    buffer_load_dwordx4 v[240:243], v1, s[44:47], s83 offen offset:3072 nt
    v_dot2_f32_bf16 v50, v220, v12, 0
    v_dot2_f32_bf16 v50, v221, v13, v50
    v_dot2_f32_bf16 v50, v222, v14, v50
    v_dot2_f32_bf16 v50, v223, v15, v50
    v_add_f32_dpp v48, v48, v48 row_ror:8 row_mask:0xf bank_mask:0x3
    s_nop 1
    v_add_f32_dpp v48, v49, v49 row_ror:8 row_mask:0xf bank_mask:0xc
    s_waitcnt vmcnt(4)
    s_add_u32 s84, s6, 376832
    buffer_load_dwordx4 v[244:247], v1, s[44:47], s84 offen offset:0 nt
    v_dot2_f32_bf16 v51, v224, v12, 0
    v_dot2_f32_bf16 v51, v225, v13, v51
    v_dot2_f32_bf16 v51, v226, v14, v51
    v_dot2_f32_bf16 v51, v227, v15, v51
    s_waitcnt vmcnt(4)
    buffer_load_dwordx4 v[248:251], v1, s[44:47], s84 offen offset:1024 nt
    v_dot2_f32_bf16 v52, v228, v12, 0
    v_dot2_f32_bf16 v52, v229, v13, v52
    v_dot2_f32_bf16 v52, v230, v14, v52
    v_dot2_f32_bf16 v52, v231, v15, v52
    v_add_f32_dpp v50, v50, v50 row_ror:8 row_mask:0xf bank_mask:0x3
    s_nop 1
    v_add_f32_dpp v50, v51, v51 row_ror:8 row_mask:0xf bank_mask:0xc
    s_waitcnt vmcnt(4)
    buffer_load_dwordx4 v[64:67], v1, s[44:47], s84 offen offset:2048 nt
    v_dot2_f32_bf16 v53, v232, v12, 0
    v_dot2_f32_bf16 v53, v233, v13, v53
    v_dot2_f32_bf16 v53, v234, v14, v53
    v_dot2_f32_bf16 v53, v235, v15, v53
    v_add_f32_dpp v48, v48, v48 row_half_mirror row_mask:0xf bank_mask:0x5
    s_nop 1
    v_add_f32_dpp v48, v50, v50 row_half_mirror row_mask:0xf bank_mask:0xa
    s_waitcnt vmcnt(4)
    buffer_load_dwordx4 v[68:71], v1, s[44:47], s84 offen offset:3072 nt
    v_dot2_f32_bf16 v54, v236, v12, 0
    v_dot2_f32_bf16 v54, v237, v13, v54
    v_dot2_f32_bf16 v54, v238, v14, v54
    v_dot2_f32_bf16 v54, v239, v15, v54
    v_add_f32_dpp v52, v52, v52 row_ror:8 row_mask:0xf bank_mask:0x3
    s_nop 1
    v_add_f32_dpp v52, v53, v53 row_ror:8 row_mask:0xf bank_mask:0xc
    s_waitcnt vmcnt(4)
    s_add_u32 s85, s6, 393216
    buffer_load_dwordx4 v[72:75], v1, s[44:47], s85 offen offset:0 nt
    v_dot2_f32_bf16 v55, v240, v12, 0
    v_dot2_f32_bf16 v55, v241, v13, v55
    v_dot2_f32_bf16 v55, v242, v14, v55
    v_dot2_f32_bf16 v55, v243, v15, v55
    v_add_f32_dpp v44, v44, v44 quad_perm:[2,3,0,1] row_mask:0xf bank_mask:0xf
    v_add_f32_dpp v48, v48, v48 quad_perm:[2,3,0,1] row_mask:0xf bank_mask:0xf
    v_cndmask_b32 v44, v44, v48, s[92:93]
    s_waitcnt vmcnt(4)
    buffer_load_dwordx4 v[76:79], v1, s[44:47], s85 offen offset:1024 nt
    v_dot2_f32_bf16 v56, v244, v12, 0
    v_dot2_f32_bf16 v56, v245, v13, v56
    v_dot2_f32_bf16 v56, v246, v14, v56
    v_dot2_f32_bf16 v56, v247, v15, v56
    v_add_f32_dpp v54, v54, v54 row_ror:8 row_mask:0xf bank_mask:0x3
    s_nop 1
    v_add_f32_dpp v54, v55, v55 row_ror:8 row_mask:0xf bank_mask:0xc
    s_waitcnt vmcnt(4)
    buffer_load_dwordx4 v[80:83], v1, s[44:47], s85 offen offset:2048 nt
    v_dot2_f32_bf16 v57, v248, v12, 0
    v_dot2_f32_bf16 v57, v249, v13, v57
    v_dot2_f32_bf16 v57, v250, v14, v57
    v_dot2_f32_bf16 v57, v251, v15, v57
    v_add_f32_dpp v52, v52, v52 row_half_mirror row_mask:0xf bank_mask:0x5
    s_nop 1
    v_add_f32_dpp v52, v54, v54 row_half_mirror row_mask:0xf bank_mask:0xa
    s_waitcnt vmcnt(4)
    buffer_load_dwordx4 v[84:87], v1, s[44:47], s85 offen offset:3072 nt
    v_dot2_f32_bf16 v58, v64, v12, 0
    v_dot2_f32_bf16 v58, v65, v13, v58
    v_dot2_f32_bf16 v58, v66, v14, v58
    v_dot2_f32_bf16 v58, v67, v15, v58
    v_add_f32_dpp v56, v56, v56 row_ror:8 row_mask:0xf bank_mask:0x3
    s_nop 1
    v_add_f32_dpp v56, v57, v57 row_ror:8 row_mask:0xf bank_mask:0xc
    s_waitcnt vmcnt(4)
    s_add_u32 s86, s6, 409600
    buffer_load_dwordx4 v[88:91], v1, s[44:47], s86 offen offset:0 nt
    v_dot2_f32_bf16 v59, v68, v12, 0
    v_dot2_f32_bf16 v59, v69, v13, v59
    v_dot2_f32_bf16 v59, v70, v14, v59
    v_dot2_f32_bf16 v59, v71, v15, v59
    v_add_f32_dpp v58, v58, v58 row_ror:8 row_mask:0xf bank_mask:0x3
    s_nop 1
    v_add_f32_dpp v58, v59, v59 row_ror:8 row_mask:0xf bank_mask:0xc
    v_add_f32_dpp v56, v56, v56 row_half_mirror row_mask:0xf bank_mask:0x5
    s_nop 1
    v_add_f32_dpp v56, v58, v58 row_half_mirror row_mask:0xf bank_mask:0xa
    v_add_f32_dpp v52, v52, v52 quad_perm:[2,3,0,1] row_mask:0xf bank_mask:0xf
    s_nop 0
    v_add_f32_dpp v56, v56, v56 quad_perm:[2,3,0,1] row_mask:0xf bank_mask:0xf
    v_cndmask_b32 v52, v52, v56, s[92:93]
    v_add_f32_dpp v44, v44, v44 quad_perm:[1,0,3,2] row_mask:0xf bank_mask:0xf
    s_nop 0
    v_add_f32_dpp v52, v52, v52 quad_perm:[1,0,3,2] row_mask:0xf bank_mask:0xf
    v_cndmask_b32 v21, v44, v52, s[94:95]
    v_cvt_pk_bf16_f32 v21, v21, v21
    v_and_b32 v21, 0xffff0000, v21
    v_mul_f32 v21, 0x3db504f3, v21
    v_cvt_pk_bf16_f32 v21, v21, v21
    v_and_b32 v21, 0xffff0000, v21
    v_max_f32 v60, v60, v21
    s_waitcnt vmcnt(4)
    buffer_load_dwordx4 v[92:95], v1, s[44:47], s86 offen offset:1024 nt
    v_dot2_f32_bf16 v44, v72, v12, 0
    v_dot2_f32_bf16 v44, v73, v13, v44
    v_dot2_f32_bf16 v44, v74, v14, v44
    v_dot2_f32_bf16 v44, v75, v15, v44
    s_waitcnt vmcnt(4)
    buffer_load_dwordx4 v[96:99], v1, s[44:47], s86 offen offset:2048 nt
    v_dot2_f32_bf16 v45, v76, v12, 0
    v_dot2_f32_bf16 v45, v77, v13, v45
    v_dot2_f32_bf16 v45, v78, v14, v45
    v_dot2_f32_bf16 v45, v79, v15, v45
    s_waitcnt vmcnt(4)
    buffer_load_dwordx4 v[100:103], v1, s[44:47], s86 offen offset:3072 nt
    v_dot2_f32_bf16 v46, v80, v12, 0
    v_dot2_f32_bf16 v46, v81, v13, v46
    v_dot2_f32_bf16 v46, v82, v14, v46
    v_dot2_f32_bf16 v46, v83, v15, v46
    v_add_f32_dpp v44, v44, v44 row_ror:8 row_mask:0xf bank_mask:0x3
    s_nop 1
    v_add_f32_dpp v44, v45, v45 row_ror:8 row_mask:0xf bank_mask:0xc
    s_waitcnt vmcnt(4)
    s_add_u32 s87, s6, 425984
    buffer_load_dwordx4 v[104:107], v1, s[44:47], s87 offen offset:0 nt
    v_dot2_f32_bf16 v47, v84, v12, 0
    v_dot2_f32_bf16 v47, v85, v13, v47
    v_dot2_f32_bf16 v47, v86, v14, v47
    v_dot2_f32_bf16 v47, v87, v15, v47
    s_waitcnt vmcnt(4)
    buffer_load_dwordx4 v[108:111], v1, s[44:47], s87 offen offset:1024 nt
    v_dot2_f32_bf16 v48, v88, v12, 0
    v_dot2_f32_bf16 v48, v89, v13, v48
    v_dot2_f32_bf16 v48, v90, v14, v48
    v_dot2_f32_bf16 v48, v91, v15, v48
    v_add_f32_dpp v46, v46, v46 row_ror:8 row_mask:0xf bank_mask:0x3
    s_nop 1
    v_add_f32_dpp v46, v47, v47 row_ror:8 row_mask:0xf bank_mask:0xc
    s_waitcnt vmcnt(4)
    buffer_load_dwordx4 v[112:115], v1, s[44:47], s87 offen offset:2048 nt
    v_dot2_f32_bf16 v49, v92, v12, 0
    v_dot2_f32_bf16 v49, v93, v13, v49
    v_dot2_f32_bf16 v49, v94, v14, v49
    v_dot2_f32_bf16 v49, v95, v15, v49
    v_add_f32_dpp v44, v44, v44 row_half_mirror row_mask:0xf bank_mask:0x5
    s_nop 1
    v_add_f32_dpp v44, v46, v46 row_half_mirror row_mask:0xf bank_mask:0xa
    s_waitcnt vmcnt(4)
    buffer_load_dwordx4 v[116:119], v1, s[44:47], s87 offen offset:3072 nt
    v_dot2_f32_bf16 v50, v96, v12, 0
    v_dot2_f32_bf16 v50, v97, v13, v50
    v_dot2_f32_bf16 v50, v98, v14, v50
    v_dot2_f32_bf16 v50, v99, v15, v50
    v_add_f32_dpp v48, v48, v48 row_ror:8 row_mask:0xf bank_mask:0x3
    s_nop 1
    v_add_f32_dpp v48, v49, v49 row_ror:8 row_mask:0xf bank_mask:0xc
    s_waitcnt vmcnt(4)
    s_add_u32 s88, s6, 442368
    buffer_load_dwordx4 v[120:123], v1, s[44:47], s88 offen offset:0 nt
    v_dot2_f32_bf16 v51, v100, v12, 0
    v_dot2_f32_bf16 v51, v101, v13, v51
    v_dot2_f32_bf16 v51, v102, v14, v51
    v_dot2_f32_bf16 v51, v103, v15, v51
    s_waitcnt vmcnt(4)
    buffer_load_dwordx4 v[124:127], v1, s[44:47], s88 offen offset:1024 nt
    v_dot2_f32_bf16 v52, v104, v12, 0
    v_dot2_f32_bf16 v52, v105, v13, v52
    v_dot2_f32_bf16 v52, v106, v14, v52
    v_dot2_f32_bf16 v52, v107, v15, v52
    v_add_f32_dpp v50, v50, v50 row_ror:8 row_mask:0xf bank_mask:0x3
    s_nop 1
    v_add_f32_dpp v50, v51, v51 row_ror:8 row_mask:0xf bank_mask:0xc
    s_waitcnt vmcnt(4)
    buffer_load_dwordx4 v[128:131], v1, s[44:47], s88 offen offset:2048 nt
    v_dot2_f32_bf16 v53, v108, v12, 0
    v_dot2_f32_bf16 v53, v109, v13, v53
    v_dot2_f32_bf16 v53, v110, v14, v53
    v_dot2_f32_bf16 v53, v111, v15, v53
    v_add_f32_dpp v48, v48, v48 row_half_mirror row_mask:0xf bank_mask:0x5
    s_nop 1
    v_add_f32_dpp v48, v50, v50 row_half_mirror row_mask:0xf bank_mask:0xa
    s_waitcnt vmcnt(4)
    buffer_load_dwordx4 v[132:135], v1, s[44:47], s88 offen offset:3072 nt
    v_dot2_f32_bf16 v54, v112, v12, 0
    v_dot2_f32_bf16 v54, v113, v13, v54
    v_dot2_f32_bf16 v54, v114, v14, v54
    v_dot2_f32_bf16 v54, v115, v15, v54
    v_add_f32_dpp v52, v52, v52 row_ror:8 row_mask:0xf bank_mask:0x3
    s_nop 1
    v_add_f32_dpp v52, v53, v53 row_ror:8 row_mask:0xf bank_mask:0xc
    s_waitcnt vmcnt(4)
    s_add_u32 s89, s6, 458752
    buffer_load_dwordx4 v[136:139], v1, s[44:47], s89 offen offset:0 nt
    v_dot2_f32_bf16 v55, v116, v12, 0
    v_dot2_f32_bf16 v55, v117, v13, v55
    v_dot2_f32_bf16 v55, v118, v14, v55
    v_dot2_f32_bf16 v55, v119, v15, v55
    v_add_f32_dpp v44, v44, v44 quad_perm:[2,3,0,1] row_mask:0xf bank_mask:0xf
    v_add_f32_dpp v48, v48, v48 quad_perm:[2,3,0,1] row_mask:0xf bank_mask:0xf
    v_cndmask_b32 v44, v44, v48, s[92:93]
    s_waitcnt vmcnt(4)
    buffer_load_dwordx4 v[140:143], v1, s[44:47], s89 offen offset:1024 nt
    v_dot2_f32_bf16 v56, v120, v12, 0
    v_dot2_f32_bf16 v56, v121, v13, v56
    v_dot2_f32_bf16 v56, v122, v14, v56
    v_dot2_f32_bf16 v56, v123, v15, v56
    v_add_f32_dpp v54, v54, v54 row_ror:8 row_mask:0xf bank_mask:0x3
    s_nop 1
    v_add_f32_dpp v54, v55, v55 row_ror:8 row_mask:0xf bank_mask:0xc
    s_waitcnt vmcnt(4)
    buffer_load_dwordx4 v[144:147], v1, s[44:47], s89 offen offset:2048 nt
    v_dot2_f32_bf16 v57, v124, v12, 0
    v_dot2_f32_bf16 v57, v125, v13, v57
    v_dot2_f32_bf16 v57, v126, v14, v57
    v_dot2_f32_bf16 v57, v127, v15, v57
    v_add_f32_dpp v52, v52, v52 row_half_mirror row_mask:0xf bank_mask:0x5
    s_nop 1
    v_add_f32_dpp v52, v54, v54 row_half_mirror row_mask:0xf bank_mask:0xa
    s_waitcnt vmcnt(4)
    buffer_load_dwordx4 v[148:151], v1, s[44:47], s89 offen offset:3072 nt
    v_dot2_f32_bf16 v58, v128, v12, 0
    v_dot2_f32_bf16 v58, v129, v13, v58
    v_dot2_f32_bf16 v58, v130, v14, v58
    v_dot2_f32_bf16 v58, v131, v15, v58
    v_add_f32_dpp v56, v56, v56 row_ror:8 row_mask:0xf bank_mask:0x3
    s_nop 1
    v_add_f32_dpp v56, v57, v57 row_ror:8 row_mask:0xf bank_mask:0xc
    s_waitcnt vmcnt(4)
    s_add_u32 s90, s6, 475136
    buffer_load_dwordx4 v[152:155], v1, s[44:47], s90 offen offset:0 nt
    v_dot2_f32_bf16 v59, v132, v12, 0
    v_dot2_f32_bf16 v59, v133, v13, v59
    v_dot2_f32_bf16 v59, v134, v14, v59
    v_dot2_f32_bf16 v59, v135, v15, v59
    v_add_f32_dpp v58, v58, v58 row_ror:8 row_mask:0xf bank_mask:0x3
    s_nop 1
    v_add_f32_dpp v58, v59, v59 row_ror:8 row_mask:0xf bank_mask:0xc
    v_add_f32_dpp v56, v56, v56 row_half_mirror row_mask:0xf bank_mask:0x5
    s_nop 1
    v_add_f32_dpp v56, v58, v58 row_half_mirror row_mask:0xf bank_mask:0xa
    v_add_f32_dpp v52, v52, v52 quad_perm:[2,3,0,1] row_mask:0xf bank_mask:0xf
    s_nop 0
    v_add_f32_dpp v56, v56, v56 quad_perm:[2,3,0,1] row_mask:0xf bank_mask:0xf
    v_cndmask_b32 v52, v52, v56, s[92:93]
    v_add_f32_dpp v44, v44, v44 quad_perm:[1,0,3,2] row_mask:0xf bank_mask:0xf
    s_nop 0
    v_add_f32_dpp v52, v52, v52 quad_perm:[1,0,3,2] row_mask:0xf bank_mask:0xf
    v_cndmask_b32 v22, v44, v52, s[94:95]
    v_cvt_pk_bf16_f32 v22, v22, v22
    v_and_b32 v22, 0xffff0000, v22
    v_mul_f32 v22, 0x3db504f3, v22
    v_cvt_pk_bf16_f32 v22, v22, v22
    v_and_b32 v22, 0xffff0000, v22
    v_max_f32 v60, v60, v22
    s_waitcnt vmcnt(4)
    buffer_load_dwordx4 v[156:159], v1, s[44:47], s90 offen offset:1024 nt
    v_dot2_f32_bf16 v44, v136, v12, 0
    v_dot2_f32_bf16 v44, v137, v13, v44
    v_dot2_f32_bf16 v44, v138, v14, v44
    v_dot2_f32_bf16 v44, v139, v15, v44
    s_waitcnt vmcnt(4)
    buffer_load_dwordx4 v[160:163], v1, s[44:47], s90 offen offset:2048 nt
    v_dot2_f32_bf16 v45, v140, v12, 0
    v_dot2_f32_bf16 v45, v141, v13, v45
    v_dot2_f32_bf16 v45, v142, v14, v45
    v_dot2_f32_bf16 v45, v143, v15, v45
    s_waitcnt vmcnt(4)
    buffer_load_dwordx4 v[164:167], v1, s[44:47], s90 offen offset:3072 nt
    v_dot2_f32_bf16 v46, v144, v12, 0
    v_dot2_f32_bf16 v46, v145, v13, v46
    v_dot2_f32_bf16 v46, v146, v14, v46
    v_dot2_f32_bf16 v46, v147, v15, v46
    v_add_f32_dpp v44, v44, v44 row_ror:8 row_mask:0xf bank_mask:0x3
    s_nop 1
    v_add_f32_dpp v44, v45, v45 row_ror:8 row_mask:0xf bank_mask:0xc
    s_waitcnt vmcnt(4)
    s_add_u32 s91, s6, 491520
    buffer_load_dwordx4 v[168:171], v1, s[44:47], s91 offen offset:0 nt
    v_dot2_f32_bf16 v47, v148, v12, 0
    v_dot2_f32_bf16 v47, v149, v13, v47
    v_dot2_f32_bf16 v47, v150, v14, v47
    v_dot2_f32_bf16 v47, v151, v15, v47
    s_waitcnt vmcnt(4)
    buffer_load_dwordx4 v[172:175], v1, s[44:47], s91 offen offset:1024 nt
    v_dot2_f32_bf16 v48, v152, v12, 0
    v_dot2_f32_bf16 v48, v153, v13, v48
    v_dot2_f32_bf16 v48, v154, v14, v48
    v_dot2_f32_bf16 v48, v155, v15, v48
    v_add_f32_dpp v46, v46, v46 row_ror:8 row_mask:0xf bank_mask:0x3
    s_nop 1
    v_add_f32_dpp v46, v47, v47 row_ror:8 row_mask:0xf bank_mask:0xc
    s_waitcnt vmcnt(4)
    buffer_load_dwordx4 v[176:179], v1, s[44:47], s91 offen offset:2048 nt
    v_dot2_f32_bf16 v49, v156, v12, 0
    v_dot2_f32_bf16 v49, v157, v13, v49
    v_dot2_f32_bf16 v49, v158, v14, v49
    v_dot2_f32_bf16 v49, v159, v15, v49
    v_add_f32_dpp v44, v44, v44 row_half_mirror row_mask:0xf bank_mask:0x5
    s_nop 1
    v_add_f32_dpp v44, v46, v46 row_half_mirror row_mask:0xf bank_mask:0xa
    s_waitcnt vmcnt(4)
    buffer_load_dwordx4 v[180:183], v1, s[44:47], s91 offen offset:3072 nt
    v_dot2_f32_bf16 v50, v160, v12, 0
    v_dot2_f32_bf16 v50, v161, v13, v50
    v_dot2_f32_bf16 v50, v162, v14, v50
    v_dot2_f32_bf16 v50, v163, v15, v50
    v_add_f32_dpp v48, v48, v48 row_ror:8 row_mask:0xf bank_mask:0x3
    s_nop 1
    v_add_f32_dpp v48, v49, v49 row_ror:8 row_mask:0xf bank_mask:0xc
    s_waitcnt vmcnt(4)
    s_add_u32 s76, s6, 507904
    buffer_load_dwordx4 v[184:187], v1, s[44:47], s76 offen offset:0 nt
    v_dot2_f32_bf16 v51, v164, v12, 0
    v_dot2_f32_bf16 v51, v165, v13, v51
    v_dot2_f32_bf16 v51, v166, v14, v51
    v_dot2_f32_bf16 v51, v167, v15, v51
    s_waitcnt vmcnt(4)
    buffer_load_dwordx4 v[188:191], v1, s[44:47], s76 offen offset:1024 nt
    v_dot2_f32_bf16 v52, v168, v12, 0
    v_dot2_f32_bf16 v52, v169, v13, v52
    v_dot2_f32_bf16 v52, v170, v14, v52
    v_dot2_f32_bf16 v52, v171, v15, v52
    v_add_f32_dpp v50, v50, v50 row_ror:8 row_mask:0xf bank_mask:0x3
    s_nop 1
    v_add_f32_dpp v50, v51, v51 row_ror:8 row_mask:0xf bank_mask:0xc
    s_waitcnt vmcnt(4)
    buffer_load_dwordx4 v[192:195], v1, s[44:47], s76 offen offset:2048 nt
    v_dot2_f32_bf16 v53, v172, v12, 0
    v_dot2_f32_bf16 v53, v173, v13, v53
    v_dot2_f32_bf16 v53, v174, v14, v53
    v_dot2_f32_bf16 v53, v175, v15, v53
    v_add_f32_dpp v48, v48, v48 row_half_mirror row_mask:0xf bank_mask:0x5
    s_nop 1
    v_add_f32_dpp v48, v50, v50 row_half_mirror row_mask:0xf bank_mask:0xa
    s_waitcnt vmcnt(4)
    buffer_load_dwordx4 v[196:199], v1, s[44:47], s76 offen offset:3072 nt
    v_dot2_f32_bf16 v54, v176, v12, 0
    v_dot2_f32_bf16 v54, v177, v13, v54
    v_dot2_f32_bf16 v54, v178, v14, v54
    v_dot2_f32_bf16 v54, v179, v15, v54
    v_add_f32_dpp v52, v52, v52 row_ror:8 row_mask:0xf bank_mask:0x3
    s_nop 1
    v_add_f32_dpp v52, v53, v53 row_ror:8 row_mask:0xf bank_mask:0xc
    s_waitcnt vmcnt(4)
    s_add_u32 s77, s6, 524288
    buffer_load_dwordx4 v[200:203], v1, s[44:47], s77 offen offset:0 nt
    v_dot2_f32_bf16 v55, v180, v12, 0
    v_dot2_f32_bf16 v55, v181, v13, v55
    v_dot2_f32_bf16 v55, v182, v14, v55
    v_dot2_f32_bf16 v55, v183, v15, v55
    v_add_f32_dpp v44, v44, v44 quad_perm:[2,3,0,1] row_mask:0xf bank_mask:0xf
    v_add_f32_dpp v48, v48, v48 quad_perm:[2,3,0,1] row_mask:0xf bank_mask:0xf
    v_cndmask_b32 v44, v44, v48, s[92:93]
    s_waitcnt vmcnt(4)
    buffer_load_dwordx4 v[204:207], v1, s[44:47], s77 offen offset:1024 nt
    v_dot2_f32_bf16 v56, v184, v12, 0
    v_dot2_f32_bf16 v56, v185, v13, v56
    v_dot2_f32_bf16 v56, v186, v14, v56
    v_dot2_f32_bf16 v56, v187, v15, v56
    v_add_f32_dpp v54, v54, v54 row_ror:8 row_mask:0xf bank_mask:0x3
    s_nop 1
    v_add_f32_dpp v54, v55, v55 row_ror:8 row_mask:0xf bank_mask:0xc
    s_waitcnt vmcnt(4)
    buffer_load_dwordx4 v[208:211], v1, s[44:47], s77 offen offset:2048 nt
    v_dot2_f32_bf16 v57, v188, v12, 0
    v_dot2_f32_bf16 v57, v189, v13, v57
    v_dot2_f32_bf16 v57, v190, v14, v57
    v_dot2_f32_bf16 v57, v191, v15, v57
    v_add_f32_dpp v52, v52, v52 row_half_mirror row_mask:0xf bank_mask:0x5
    s_nop 1
    v_add_f32_dpp v52, v54, v54 row_half_mirror row_mask:0xf bank_mask:0xa
    s_waitcnt vmcnt(4)
    buffer_load_dwordx4 v[212:215], v1, s[44:47], s77 offen offset:3072 nt
    v_dot2_f32_bf16 v58, v192, v12, 0
    v_dot2_f32_bf16 v58, v193, v13, v58
    v_dot2_f32_bf16 v58, v194, v14, v58
    v_dot2_f32_bf16 v58, v195, v15, v58
    v_add_f32_dpp v56, v56, v56 row_ror:8 row_mask:0xf bank_mask:0x3
    s_nop 1
    v_add_f32_dpp v56, v57, v57 row_ror:8 row_mask:0xf bank_mask:0xc
    s_waitcnt vmcnt(4)
    s_add_u32 s78, s6, 540672
    buffer_load_dwordx4 v[216:219], v1, s[44:47], s78 offen offset:0 nt
    v_dot2_f32_bf16 v59, v196, v12, 0
    v_dot2_f32_bf16 v59, v197, v13, v59
    v_dot2_f32_bf16 v59, v198, v14, v59
    v_dot2_f32_bf16 v59, v199, v15, v59
    v_add_f32_dpp v58, v58, v58 row_ror:8 row_mask:0xf bank_mask:0x3
    s_nop 1
    v_add_f32_dpp v58, v59, v59 row_ror:8 row_mask:0xf bank_mask:0xc
    v_add_f32_dpp v56, v56, v56 row_half_mirror row_mask:0xf bank_mask:0x5
    s_nop 1
    v_add_f32_dpp v56, v58, v58 row_half_mirror row_mask:0xf bank_mask:0xa
    v_add_f32_dpp v52, v52, v52 quad_perm:[2,3,0,1] row_mask:0xf bank_mask:0xf
    s_nop 0
    v_add_f32_dpp v56, v56, v56 quad_perm:[2,3,0,1] row_mask:0xf bank_mask:0xf
    v_cndmask_b32 v52, v52, v56, s[92:93]
    v_add_f32_dpp v44, v44, v44 quad_perm:[1,0,3,2] row_mask:0xf bank_mask:0xf
    s_nop 0
    v_add_f32_dpp v52, v52, v52 quad_perm:[1,0,3,2] row_mask:0xf bank_mask:0xf
    v_cndmask_b32 v23, v44, v52, s[94:95]
    v_cvt_pk_bf16_f32 v23, v23, v23
    v_and_b32 v23, 0xffff0000, v23
    v_mul_f32 v23, 0x3db504f3, v23
    v_cvt_pk_bf16_f32 v23, v23, v23
    v_and_b32 v23, 0xffff0000, v23
    v_max_f32 v60, v60, v23
    s_waitcnt vmcnt(4)
    buffer_load_dwordx4 v[220:223], v1, s[44:47], s78 offen offset:1024 nt
    v_dot2_f32_bf16 v44, v200, v12, 0
    v_dot2_f32_bf16 v44, v201, v13, v44
    v_dot2_f32_bf16 v44, v202, v14, v44
    v_dot2_f32_bf16 v44, v203, v15, v44
    s_waitcnt vmcnt(4)
    buffer_load_dwordx4 v[224:227], v1, s[44:47], s78 offen offset:2048 nt
    v_dot2_f32_bf16 v45, v204, v12, 0
    v_dot2_f32_bf16 v45, v205, v13, v45
    v_dot2_f32_bf16 v45, v206, v14, v45
    v_dot2_f32_bf16 v45, v207, v15, v45
    s_waitcnt vmcnt(4)
    buffer_load_dwordx4 v[228:231], v1, s[44:47], s78 offen offset:3072 nt
    v_dot2_f32_bf16 v46, v208, v12, 0
    v_dot2_f32_bf16 v46, v209, v13, v46
    v_dot2_f32_bf16 v46, v210, v14, v46
    v_dot2_f32_bf16 v46, v211, v15, v46
    v_add_f32_dpp v44, v44, v44 row_ror:8 row_mask:0xf bank_mask:0x3
    s_nop 1
    v_add_f32_dpp v44, v45, v45 row_ror:8 row_mask:0xf bank_mask:0xc
    s_waitcnt vmcnt(4)
    s_add_u32 s79, s6, 557056
    buffer_load_dwordx4 v[232:235], v1, s[44:47], s79 offen offset:0 nt
    v_dot2_f32_bf16 v47, v212, v12, 0
    v_dot2_f32_bf16 v47, v213, v13, v47
    v_dot2_f32_bf16 v47, v214, v14, v47
    v_dot2_f32_bf16 v47, v215, v15, v47
    s_waitcnt vmcnt(4)
    buffer_load_dwordx4 v[236:239], v1, s[44:47], s79 offen offset:1024 nt
    v_dot2_f32_bf16 v48, v216, v12, 0
    v_dot2_f32_bf16 v48, v217, v13, v48
    v_dot2_f32_bf16 v48, v218, v14, v48
    v_dot2_f32_bf16 v48, v219, v15, v48
    v_add_f32_dpp v46, v46, v46 row_ror:8 row_mask:0xf bank_mask:0x3
    s_nop 1
    v_add_f32_dpp v46, v47, v47 row_ror:8 row_mask:0xf bank_mask:0xc
    s_waitcnt vmcnt(4)
    buffer_load_dwordx4 v[240:243], v1, s[44:47], s79 offen offset:2048 nt
    v_dot2_f32_bf16 v49, v220, v12, 0
    v_dot2_f32_bf16 v49, v221, v13, v49
    v_dot2_f32_bf16 v49, v222, v14, v49
    v_dot2_f32_bf16 v49, v223, v15, v49
    v_add_f32_dpp v44, v44, v44 row_half_mirror row_mask:0xf bank_mask:0x5
    s_nop 1
    v_add_f32_dpp v44, v46, v46 row_half_mirror row_mask:0xf bank_mask:0xa
    s_waitcnt vmcnt(4)
    buffer_load_dwordx4 v[244:247], v1, s[44:47], s79 offen offset:3072 nt
    v_dot2_f32_bf16 v50, v224, v12, 0
    v_dot2_f32_bf16 v50, v225, v13, v50
    v_dot2_f32_bf16 v50, v226, v14, v50
    v_dot2_f32_bf16 v50, v227, v15, v50
    v_add_f32_dpp v48, v48, v48 row_ror:8 row_mask:0xf bank_mask:0x3
    s_nop 1
    v_add_f32_dpp v48, v49, v49 row_ror:8 row_mask:0xf bank_mask:0xc
    s_waitcnt vmcnt(4)
    s_add_u32 s80, s6, 573440
    buffer_load_dwordx4 v[248:251], v1, s[44:47], s80 offen offset:0 nt
    v_dot2_f32_bf16 v51, v228, v12, 0
    v_dot2_f32_bf16 v51, v229, v13, v51
    v_dot2_f32_bf16 v51, v230, v14, v51
    v_dot2_f32_bf16 v51, v231, v15, v51
    s_waitcnt vmcnt(4)
    buffer_load_dwordx4 v[64:67], v1, s[44:47], s80 offen offset:1024 nt
    v_dot2_f32_bf16 v52, v232, v12, 0
    v_dot2_f32_bf16 v52, v233, v13, v52
    v_dot2_f32_bf16 v52, v234, v14, v52
    v_dot2_f32_bf16 v52, v235, v15, v52
    v_add_f32_dpp v50, v50, v50 row_ror:8 row_mask:0xf bank_mask:0x3
    s_nop 1
    v_add_f32_dpp v50, v51, v51 row_ror:8 row_mask:0xf bank_mask:0xc
    s_waitcnt vmcnt(4)
    buffer_load_dwordx4 v[68:71], v1, s[44:47], s80 offen offset:2048 nt
    v_dot2_f32_bf16 v53, v236, v12, 0
    v_dot2_f32_bf16 v53, v237, v13, v53
    v_dot2_f32_bf16 v53, v238, v14, v53
    v_dot2_f32_bf16 v53, v239, v15, v53
    v_add_f32_dpp v48, v48, v48 row_half_mirror row_mask:0xf bank_mask:0x5
    s_nop 1
    v_add_f32_dpp v48, v50, v50 row_half_mirror row_mask:0xf bank_mask:0xa
    s_waitcnt vmcnt(4)
    buffer_load_dwordx4 v[72:75], v1, s[44:47], s80 offen offset:3072 nt
    v_dot2_f32_bf16 v54, v240, v12, 0
    v_dot2_f32_bf16 v54, v241, v13, v54
    v_dot2_f32_bf16 v54, v242, v14, v54
    v_dot2_f32_bf16 v54, v243, v15, v54
    v_add_f32_dpp v52, v52, v52 row_ror:8 row_mask:0xf bank_mask:0x3
    s_nop 1
    v_add_f32_dpp v52, v53, v53 row_ror:8 row_mask:0xf bank_mask:0xc
    s_waitcnt vmcnt(4)
    s_add_u32 s81, s6, 589824
    buffer_load_dwordx4 v[76:79], v1, s[44:47], s81 offen offset:0 nt
    v_dot2_f32_bf16 v55, v244, v12, 0
    v_dot2_f32_bf16 v55, v245, v13, v55
    v_dot2_f32_bf16 v55, v246, v14, v55
    v_dot2_f32_bf16 v55, v247, v15, v55
    v_add_f32_dpp v44, v44, v44 quad_perm:[2,3,0,1] row_mask:0xf bank_mask:0xf
    v_add_f32_dpp v48, v48, v48 quad_perm:[2,3,0,1] row_mask:0xf bank_mask:0xf
    v_cndmask_b32 v44, v44, v48, s[92:93]
    s_waitcnt vmcnt(4)
    buffer_load_dwordx4 v[80:83], v1, s[44:47], s81 offen offset:1024 nt
    v_dot2_f32_bf16 v56, v248, v12, 0
    v_dot2_f32_bf16 v56, v249, v13, v56
    v_dot2_f32_bf16 v56, v250, v14, v56
    v_dot2_f32_bf16 v56, v251, v15, v56
    v_add_f32_dpp v54, v54, v54 row_ror:8 row_mask:0xf bank_mask:0x3
    s_nop 1
    v_add_f32_dpp v54, v55, v55 row_ror:8 row_mask:0xf bank_mask:0xc
    s_waitcnt vmcnt(4)
    buffer_load_dwordx4 v[84:87], v1, s[44:47], s81 offen offset:2048 nt
    v_dot2_f32_bf16 v57, v64, v12, 0
    v_dot2_f32_bf16 v57, v65, v13, v57
    v_dot2_f32_bf16 v57, v66, v14, v57
    v_dot2_f32_bf16 v57, v67, v15, v57
    v_add_f32_dpp v52, v52, v52 row_half_mirror row_mask:0xf bank_mask:0x5
    s_nop 1
    v_add_f32_dpp v52, v54, v54 row_half_mirror row_mask:0xf bank_mask:0xa
    s_waitcnt vmcnt(4)
    buffer_load_dwordx4 v[88:91], v1, s[44:47], s81 offen offset:3072 nt
    v_dot2_f32_bf16 v58, v68, v12, 0
    v_dot2_f32_bf16 v58, v69, v13, v58
    v_dot2_f32_bf16 v58, v70, v14, v58
    v_dot2_f32_bf16 v58, v71, v15, v58
    v_add_f32_dpp v56, v56, v56 row_ror:8 row_mask:0xf bank_mask:0x3
    s_nop 1
    v_add_f32_dpp v56, v57, v57 row_ror:8 row_mask:0xf bank_mask:0xc
    s_waitcnt vmcnt(4)
    s_add_u32 s82, s6, 606208
    buffer_load_dwordx4 v[92:95], v1, s[44:47], s82 offen offset:0 nt
    v_dot2_f32_bf16 v59, v72, v12, 0
    v_dot2_f32_bf16 v59, v73, v13, v59
    v_dot2_f32_bf16 v59, v74, v14, v59
    v_dot2_f32_bf16 v59, v75, v15, v59
    v_add_f32_dpp v58, v58, v58 row_ror:8 row_mask:0xf bank_mask:0x3
    s_nop 1
    v_add_f32_dpp v58, v59, v59 row_ror:8 row_mask:0xf bank_mask:0xc
    v_add_f32_dpp v56, v56, v56 row_half_mirror row_mask:0xf bank_mask:0x5
    s_nop 1
    v_add_f32_dpp v56, v58, v58 row_half_mirror row_mask:0xf bank_mask:0xa
    v_add_f32_dpp v52, v52, v52 quad_perm:[2,3,0,1] row_mask:0xf bank_mask:0xf
    s_nop 0
    v_add_f32_dpp v56, v56, v56 quad_perm:[2,3,0,1] row_mask:0xf bank_mask:0xf
    v_cndmask_b32 v52, v52, v56, s[92:93]
    v_add_f32_dpp v44, v44, v44 quad_perm:[1,0,3,2] row_mask:0xf bank_mask:0xf
    s_nop 0
    v_add_f32_dpp v52, v52, v52 quad_perm:[1,0,3,2] row_mask:0xf bank_mask:0xf
    v_cndmask_b32 v24, v44, v52, s[94:95]
    v_cvt_pk_bf16_f32 v24, v24, v24
    v_and_b32 v24, 0xffff0000, v24
    v_mul_f32 v24, 0x3db504f3, v24
    v_cvt_pk_bf16_f32 v24, v24, v24
    v_and_b32 v24, 0xffff0000, v24
    v_max_f32 v60, v60, v24
    s_waitcnt vmcnt(4)
    buffer_load_dwordx4 v[96:99], v1, s[44:47], s82 offen offset:1024 nt
    v_dot2_f32_bf16 v44, v76, v12, 0
    v_dot2_f32_bf16 v44, v77, v13, v44
    v_dot2_f32_bf16 v44, v78, v14, v44
    v_dot2_f32_bf16 v44, v79, v15, v44
    s_waitcnt vmcnt(4)
    buffer_load_dwordx4 v[100:103], v1, s[44:47], s82 offen offset:2048 nt
    v_dot2_f32_bf16 v45, v80, v12, 0
    v_dot2_f32_bf16 v45, v81, v13, v45
    v_dot2_f32_bf16 v45, v82, v14, v45
    v_dot2_f32_bf16 v45, v83, v15, v45
    s_waitcnt vmcnt(4)
    buffer_load_dwordx4 v[104:107], v1, s[44:47], s82 offen offset:3072 nt
    v_dot2_f32_bf16 v46, v84, v12, 0
    v_dot2_f32_bf16 v46, v85, v13, v46
    v_dot2_f32_bf16 v46, v86, v14, v46
    v_dot2_f32_bf16 v46, v87, v15, v46
    v_add_f32_dpp v44, v44, v44 row_ror:8 row_mask:0xf bank_mask:0x3
    s_nop 1
    v_add_f32_dpp v44, v45, v45 row_ror:8 row_mask:0xf bank_mask:0xc
    s_waitcnt vmcnt(4)
    s_add_u32 s83, s6, 622592
    buffer_load_dwordx4 v[108:111], v1, s[44:47], s83 offen offset:0 nt
    v_dot2_f32_bf16 v47, v88, v12, 0
    v_dot2_f32_bf16 v47, v89, v13, v47
    v_dot2_f32_bf16 v47, v90, v14, v47
    v_dot2_f32_bf16 v47, v91, v15, v47
    s_waitcnt vmcnt(4)
    buffer_load_dwordx4 v[112:115], v1, s[44:47], s83 offen offset:1024 nt
    v_dot2_f32_bf16 v48, v92, v12, 0
    v_dot2_f32_bf16 v48, v93, v13, v48
    v_dot2_f32_bf16 v48, v94, v14, v48
    v_dot2_f32_bf16 v48, v95, v15, v48
    v_add_f32_dpp v46, v46, v46 row_ror:8 row_mask:0xf bank_mask:0x3
    s_nop 1
    v_add_f32_dpp v46, v47, v47 row_ror:8 row_mask:0xf bank_mask:0xc
    s_waitcnt vmcnt(4)
    buffer_load_dwordx4 v[116:119], v1, s[44:47], s83 offen offset:2048 nt
    v_dot2_f32_bf16 v49, v96, v12, 0
    v_dot2_f32_bf16 v49, v97, v13, v49
    v_dot2_f32_bf16 v49, v98, v14, v49
    v_dot2_f32_bf16 v49, v99, v15, v49
    v_add_f32_dpp v44, v44, v44 row_half_mirror row_mask:0xf bank_mask:0x5
    s_nop 1
    v_add_f32_dpp v44, v46, v46 row_half_mirror row_mask:0xf bank_mask:0xa
    s_waitcnt vmcnt(4)
    buffer_load_dwordx4 v[120:123], v1, s[44:47], s83 offen offset:3072 nt
    v_dot2_f32_bf16 v50, v100, v12, 0
    v_dot2_f32_bf16 v50, v101, v13, v50
    v_dot2_f32_bf16 v50, v102, v14, v50
    v_dot2_f32_bf16 v50, v103, v15, v50
    v_add_f32_dpp v48, v48, v48 row_ror:8 row_mask:0xf bank_mask:0x3
    s_nop 1
    v_add_f32_dpp v48, v49, v49 row_ror:8 row_mask:0xf bank_mask:0xc
    s_waitcnt vmcnt(4)
    s_add_u32 s84, s6, 638976
    buffer_load_dwordx4 v[124:127], v1, s[44:47], s84 offen offset:0 nt
    v_dot2_f32_bf16 v51, v104, v12, 0
    v_dot2_f32_bf16 v51, v105, v13, v51
    v_dot2_f32_bf16 v51, v106, v14, v51
    v_dot2_f32_bf16 v51, v107, v15, v51
    s_waitcnt vmcnt(4)
    buffer_load_dwordx4 v[128:131], v1, s[44:47], s84 offen offset:1024 nt
    v_dot2_f32_bf16 v52, v108, v12, 0
    v_dot2_f32_bf16 v52, v109, v13, v52
    v_dot2_f32_bf16 v52, v110, v14, v52
    v_dot2_f32_bf16 v52, v111, v15, v52
    v_add_f32_dpp v50, v50, v50 row_ror:8 row_mask:0xf bank_mask:0x3
    s_nop 1
    v_add_f32_dpp v50, v51, v51 row_ror:8 row_mask:0xf bank_mask:0xc
    s_waitcnt vmcnt(4)
    buffer_load_dwordx4 v[132:135], v1, s[44:47], s84 offen offset:2048 nt
    v_dot2_f32_bf16 v53, v112, v12, 0
    v_dot2_f32_bf16 v53, v113, v13, v53
    v_dot2_f32_bf16 v53, v114, v14, v53
    v_dot2_f32_bf16 v53, v115, v15, v53
    v_add_f32_dpp v48, v48, v48 row_half_mirror row_mask:0xf bank_mask:0x5
    s_nop 1
    v_add_f32_dpp v48, v50, v50 row_half_mirror row_mask:0xf bank_mask:0xa
    s_waitcnt vmcnt(4)
    buffer_load_dwordx4 v[136:139], v1, s[44:47], s84 offen offset:3072 nt
    v_dot2_f32_bf16 v54, v116, v12, 0
    v_dot2_f32_bf16 v54, v117, v13, v54
    v_dot2_f32_bf16 v54, v118, v14, v54
    v_dot2_f32_bf16 v54, v119, v15, v54
    v_add_f32_dpp v52, v52, v52 row_ror:8 row_mask:0xf bank_mask:0x3
    s_nop 1
    v_add_f32_dpp v52, v53, v53 row_ror:8 row_mask:0xf bank_mask:0xc
    s_waitcnt vmcnt(4)
    s_add_u32 s85, s6, 655360
    buffer_load_dwordx4 v[140:143], v1, s[44:47], s85 offen offset:0 nt
    v_dot2_f32_bf16 v55, v120, v12, 0
    v_dot2_f32_bf16 v55, v121, v13, v55
    v_dot2_f32_bf16 v55, v122, v14, v55
    v_dot2_f32_bf16 v55, v123, v15, v55
    v_add_f32_dpp v44, v44, v44 quad_perm:[2,3,0,1] row_mask:0xf bank_mask:0xf
    v_add_f32_dpp v48, v48, v48 quad_perm:[2,3,0,1] row_mask:0xf bank_mask:0xf
    v_cndmask_b32 v44, v44, v48, s[92:93]
    s_waitcnt vmcnt(4)
    buffer_load_dwordx4 v[144:147], v1, s[44:47], s85 offen offset:1024 nt
    v_dot2_f32_bf16 v56, v124, v12, 0
    v_dot2_f32_bf16 v56, v125, v13, v56
    v_dot2_f32_bf16 v56, v126, v14, v56
    v_dot2_f32_bf16 v56, v127, v15, v56
    v_add_f32_dpp v54, v54, v54 row_ror:8 row_mask:0xf bank_mask:0x3
    s_nop 1
    v_add_f32_dpp v54, v55, v55 row_ror:8 row_mask:0xf bank_mask:0xc
    s_waitcnt vmcnt(4)
    buffer_load_dwordx4 v[148:151], v1, s[44:47], s85 offen offset:2048 nt
    v_dot2_f32_bf16 v57, v128, v12, 0
    v_dot2_f32_bf16 v57, v129, v13, v57
    v_dot2_f32_bf16 v57, v130, v14, v57
    v_dot2_f32_bf16 v57, v131, v15, v57
    v_add_f32_dpp v52, v52, v52 row_half_mirror row_mask:0xf bank_mask:0x5
    s_nop 1
    v_add_f32_dpp v52, v54, v54 row_half_mirror row_mask:0xf bank_mask:0xa
    s_waitcnt vmcnt(4)
    buffer_load_dwordx4 v[152:155], v1, s[44:47], s85 offen offset:3072 nt
    v_dot2_f32_bf16 v58, v132, v12, 0
    v_dot2_f32_bf16 v58, v133, v13, v58
    v_dot2_f32_bf16 v58, v134, v14, v58
    v_dot2_f32_bf16 v58, v135, v15, v58
    v_add_f32_dpp v56, v56, v56 row_ror:8 row_mask:0xf bank_mask:0x3
    s_nop 1
    v_add_f32_dpp v56, v57, v57 row_ror:8 row_mask:0xf bank_mask:0xc
    s_waitcnt vmcnt(4)
    s_add_u32 s86, s6, 671744
    buffer_load_dwordx4 v[156:159], v1, s[44:47], s86 offen offset:0 nt
    v_dot2_f32_bf16 v59, v136, v12, 0
    v_dot2_f32_bf16 v59, v137, v13, v59
    v_dot2_f32_bf16 v59, v138, v14, v59
    v_dot2_f32_bf16 v59, v139, v15, v59
    v_add_f32_dpp v58, v58, v58 row_ror:8 row_mask:0xf bank_mask:0x3
    s_nop 1
    v_add_f32_dpp v58, v59, v59 row_ror:8 row_mask:0xf bank_mask:0xc
    v_add_f32_dpp v56, v56, v56 row_half_mirror row_mask:0xf bank_mask:0x5
    s_nop 1
    v_add_f32_dpp v56, v58, v58 row_half_mirror row_mask:0xf bank_mask:0xa
    v_add_f32_dpp v52, v52, v52 quad_perm:[2,3,0,1] row_mask:0xf bank_mask:0xf
    s_nop 0
    v_add_f32_dpp v56, v56, v56 quad_perm:[2,3,0,1] row_mask:0xf bank_mask:0xf
    v_cndmask_b32 v52, v52, v56, s[92:93]
    v_add_f32_dpp v44, v44, v44 quad_perm:[1,0,3,2] row_mask:0xf bank_mask:0xf
    s_nop 0
    v_add_f32_dpp v52, v52, v52 quad_perm:[1,0,3,2] row_mask:0xf bank_mask:0xf
    v_cndmask_b32 v25, v44, v52, s[94:95]
    v_cvt_pk_bf16_f32 v25, v25, v25
    v_and_b32 v25, 0xffff0000, v25
    v_mul_f32 v25, 0x3db504f3, v25
    v_cvt_pk_bf16_f32 v25, v25, v25
    v_and_b32 v25, 0xffff0000, v25
    v_max_f32 v60, v60, v25
    s_waitcnt vmcnt(4)
    buffer_load_dwordx4 v[160:163], v1, s[44:47], s86 offen offset:1024 nt
    v_dot2_f32_bf16 v44, v140, v12, 0
    v_dot2_f32_bf16 v44, v141, v13, v44
    v_dot2_f32_bf16 v44, v142, v14, v44
    v_dot2_f32_bf16 v44, v143, v15, v44
    s_waitcnt vmcnt(4)
    buffer_load_dwordx4 v[164:167], v1, s[44:47], s86 offen offset:2048 nt
    v_dot2_f32_bf16 v45, v144, v12, 0
    v_dot2_f32_bf16 v45, v145, v13, v45
    v_dot2_f32_bf16 v45, v146, v14, v45
    v_dot2_f32_bf16 v45, v147, v15, v45
    s_waitcnt vmcnt(4)
    buffer_load_dwordx4 v[168:171], v1, s[44:47], s86 offen offset:3072 nt
    v_dot2_f32_bf16 v46, v148, v12, 0
    v_dot2_f32_bf16 v46, v149, v13, v46
    v_dot2_f32_bf16 v46, v150, v14, v46
    v_dot2_f32_bf16 v46, v151, v15, v46
    v_add_f32_dpp v44, v44, v44 row_ror:8 row_mask:0xf bank_mask:0x3
    s_nop 1
    v_add_f32_dpp v44, v45, v45 row_ror:8 row_mask:0xf bank_mask:0xc
    s_waitcnt vmcnt(4)
    s_add_u32 s87, s6, 688128
    buffer_load_dwordx4 v[172:175], v1, s[44:47], s87 offen offset:0 nt
    v_dot2_f32_bf16 v47, v152, v12, 0
    v_dot2_f32_bf16 v47, v153, v13, v47
    v_dot2_f32_bf16 v47, v154, v14, v47
    v_dot2_f32_bf16 v47, v155, v15, v47
    s_waitcnt vmcnt(4)
    buffer_load_dwordx4 v[176:179], v1, s[44:47], s87 offen offset:1024 nt
    v_dot2_f32_bf16 v48, v156, v12, 0
    v_dot2_f32_bf16 v48, v157, v13, v48
    v_dot2_f32_bf16 v48, v158, v14, v48
    v_dot2_f32_bf16 v48, v159, v15, v48
    v_add_f32_dpp v46, v46, v46 row_ror:8 row_mask:0xf bank_mask:0x3
    s_nop 1
    v_add_f32_dpp v46, v47, v47 row_ror:8 row_mask:0xf bank_mask:0xc
    s_waitcnt vmcnt(4)
    buffer_load_dwordx4 v[180:183], v1, s[44:47], s87 offen offset:2048 nt
    v_dot2_f32_bf16 v49, v160, v12, 0
    v_dot2_f32_bf16 v49, v161, v13, v49
    v_dot2_f32_bf16 v49, v162, v14, v49
    v_dot2_f32_bf16 v49, v163, v15, v49
    v_add_f32_dpp v44, v44, v44 row_half_mirror row_mask:0xf bank_mask:0x5
    s_nop 1
    v_add_f32_dpp v44, v46, v46 row_half_mirror row_mask:0xf bank_mask:0xa
    s_waitcnt vmcnt(4)
    buffer_load_dwordx4 v[184:187], v1, s[44:47], s87 offen offset:3072 nt
    v_dot2_f32_bf16 v50, v164, v12, 0
    v_dot2_f32_bf16 v50, v165, v13, v50
    v_dot2_f32_bf16 v50, v166, v14, v50
    v_dot2_f32_bf16 v50, v167, v15, v50
    v_add_f32_dpp v48, v48, v48 row_ror:8 row_mask:0xf bank_mask:0x3
    s_nop 1
    v_add_f32_dpp v48, v49, v49 row_ror:8 row_mask:0xf bank_mask:0xc
    s_waitcnt vmcnt(4)
    s_add_u32 s88, s6, 704512
    buffer_load_dwordx4 v[188:191], v1, s[44:47], s88 offen offset:0 nt
    v_dot2_f32_bf16 v51, v168, v12, 0
    v_dot2_f32_bf16 v51, v169, v13, v51
    v_dot2_f32_bf16 v51, v170, v14, v51
    v_dot2_f32_bf16 v51, v171, v15, v51
    s_waitcnt vmcnt(4)
    buffer_load_dwordx4 v[192:195], v1, s[44:47], s88 offen offset:1024 nt
    v_dot2_f32_bf16 v52, v172, v12, 0
    v_dot2_f32_bf16 v52, v173, v13, v52
    v_dot2_f32_bf16 v52, v174, v14, v52
    v_dot2_f32_bf16 v52, v175, v15, v52
    v_add_f32_dpp v50, v50, v50 row_ror:8 row_mask:0xf bank_mask:0x3
    s_nop 1
    v_add_f32_dpp v50, v51, v51 row_ror:8 row_mask:0xf bank_mask:0xc
    s_waitcnt vmcnt(4)
    buffer_load_dwordx4 v[196:199], v1, s[44:47], s88 offen offset:2048 nt
    v_dot2_f32_bf16 v53, v176, v12, 0
    v_dot2_f32_bf16 v53, v177, v13, v53
    v_dot2_f32_bf16 v53, v178, v14, v53
    v_dot2_f32_bf16 v53, v179, v15, v53
    v_add_f32_dpp v48, v48, v48 row_half_mirror row_mask:0xf bank_mask:0x5
    s_nop 1
    v_add_f32_dpp v48, v50, v50 row_half_mirror row_mask:0xf bank_mask:0xa
    s_waitcnt vmcnt(4)
    buffer_load_dwordx4 v[200:203], v1, s[44:47], s88 offen offset:3072 nt
    v_dot2_f32_bf16 v54, v180, v12, 0
    v_dot2_f32_bf16 v54, v181, v13, v54
    v_dot2_f32_bf16 v54, v182, v14, v54
    v_dot2_f32_bf16 v54, v183, v15, v54
    v_add_f32_dpp v52, v52, v52 row_ror:8 row_mask:0xf bank_mask:0x3
    s_nop 1
    v_add_f32_dpp v52, v53, v53 row_ror:8 row_mask:0xf bank_mask:0xc
    s_waitcnt vmcnt(4)
    s_add_u32 s89, s6, 720896
    buffer_load_dwordx4 v[204:207], v1, s[44:47], s89 offen offset:0 nt
    v_dot2_f32_bf16 v55, v184, v12, 0
    v_dot2_f32_bf16 v55, v185, v13, v55
    v_dot2_f32_bf16 v55, v186, v14, v55
    v_dot2_f32_bf16 v55, v187, v15, v55
    v_add_f32_dpp v44, v44, v44 quad_perm:[2,3,0,1] row_mask:0xf bank_mask:0xf
    v_add_f32_dpp v48, v48, v48 quad_perm:[2,3,0,1] row_mask:0xf bank_mask:0xf
    v_cndmask_b32 v44, v44, v48, s[92:93]
    s_waitcnt vmcnt(4)
    buffer_load_dwordx4 v[208:211], v1, s[44:47], s89 offen offset:1024 nt
    v_dot2_f32_bf16 v56, v188, v12, 0
    v_dot2_f32_bf16 v56, v189, v13, v56
    v_dot2_f32_bf16 v56, v190, v14, v56
    v_dot2_f32_bf16 v56, v191, v15, v56
    v_add_f32_dpp v54, v54, v54 row_ror:8 row_mask:0xf bank_mask:0x3
    s_nop 1
    v_add_f32_dpp v54, v55, v55 row_ror:8 row_mask:0xf bank_mask:0xc
    s_waitcnt vmcnt(4)
    buffer_load_dwordx4 v[212:215], v1, s[44:47], s89 offen offset:2048 nt
    v_dot2_f32_bf16 v57, v192, v12, 0
    v_dot2_f32_bf16 v57, v193, v13, v57
    v_dot2_f32_bf16 v57, v194, v14, v57
    v_dot2_f32_bf16 v57, v195, v15, v57
    v_add_f32_dpp v52, v52, v52 row_half_mirror row_mask:0xf bank_mask:0x5
    s_nop 1
    v_add_f32_dpp v52, v54, v54 row_half_mirror row_mask:0xf bank_mask:0xa
    s_waitcnt vmcnt(4)
    buffer_load_dwordx4 v[216:219], v1, s[44:47], s89 offen offset:3072 nt
    v_dot2_f32_bf16 v58, v196, v12, 0
    v_dot2_f32_bf16 v58, v197, v13, v58
    v_dot2_f32_bf16 v58, v198, v14, v58
    v_dot2_f32_bf16 v58, v199, v15, v58
    v_add_f32_dpp v56, v56, v56 row_ror:8 row_mask:0xf bank_mask:0x3
    s_nop 1
    v_add_f32_dpp v56, v57, v57 row_ror:8 row_mask:0xf bank_mask:0xc
    s_waitcnt vmcnt(4)
    s_add_u32 s90, s6, 737280
    buffer_load_dwordx4 v[220:223], v1, s[44:47], s90 offen offset:0 nt
    v_dot2_f32_bf16 v59, v200, v12, 0
    v_dot2_f32_bf16 v59, v201, v13, v59
    v_dot2_f32_bf16 v59, v202, v14, v59
    v_dot2_f32_bf16 v59, v203, v15, v59
    v_add_f32_dpp v58, v58, v58 row_ror:8 row_mask:0xf bank_mask:0x3
    s_nop 1
    v_add_f32_dpp v58, v59, v59 row_ror:8 row_mask:0xf bank_mask:0xc
    v_add_f32_dpp v56, v56, v56 row_half_mirror row_mask:0xf bank_mask:0x5
    s_nop 1
    v_add_f32_dpp v56, v58, v58 row_half_mirror row_mask:0xf bank_mask:0xa
    v_add_f32_dpp v52, v52, v52 quad_perm:[2,3,0,1] row_mask:0xf bank_mask:0xf
    s_nop 0
    v_add_f32_dpp v56, v56, v56 quad_perm:[2,3,0,1] row_mask:0xf bank_mask:0xf
    v_cndmask_b32 v52, v52, v56, s[92:93]
    v_add_f32_dpp v44, v44, v44 quad_perm:[1,0,3,2] row_mask:0xf bank_mask:0xf
    s_nop 0
    v_add_f32_dpp v52, v52, v52 quad_perm:[1,0,3,2] row_mask:0xf bank_mask:0xf
    v_cndmask_b32 v26, v44, v52, s[94:95]
    v_cvt_pk_bf16_f32 v26, v26, v26
    v_and_b32 v26, 0xffff0000, v26
    v_mul_f32 v26, 0x3db504f3, v26
    v_cvt_pk_bf16_f32 v26, v26, v26
    v_and_b32 v26, 0xffff0000, v26
    v_max_f32 v60, v60, v26
    s_waitcnt vmcnt(4)
    buffer_load_dwordx4 v[224:227], v1, s[44:47], s90 offen offset:1024 nt
    v_dot2_f32_bf16 v44, v204, v12, 0
    v_dot2_f32_bf16 v44, v205, v13, v44
    v_dot2_f32_bf16 v44, v206, v14, v44
    v_dot2_f32_bf16 v44, v207, v15, v44
    s_waitcnt vmcnt(4)
    buffer_load_dwordx4 v[228:231], v1, s[44:47], s90 offen offset:2048 nt
    v_dot2_f32_bf16 v45, v208, v12, 0
    v_dot2_f32_bf16 v45, v209, v13, v45
    v_dot2_f32_bf16 v45, v210, v14, v45
    v_dot2_f32_bf16 v45, v211, v15, v45
    s_waitcnt vmcnt(4)
    buffer_load_dwordx4 v[232:235], v1, s[44:47], s90 offen offset:3072 nt
    v_dot2_f32_bf16 v46, v212, v12, 0
    v_dot2_f32_bf16 v46, v213, v13, v46
    v_dot2_f32_bf16 v46, v214, v14, v46
    v_dot2_f32_bf16 v46, v215, v15, v46
    v_add_f32_dpp v44, v44, v44 row_ror:8 row_mask:0xf bank_mask:0x3
    s_nop 1
    v_add_f32_dpp v44, v45, v45 row_ror:8 row_mask:0xf bank_mask:0xc
    s_waitcnt vmcnt(4)
    s_add_u32 s91, s6, 753664
    buffer_load_dwordx4 v[236:239], v1, s[44:47], s91 offen offset:0 nt
    v_dot2_f32_bf16 v47, v216, v12, 0
    v_dot2_f32_bf16 v47, v217, v13, v47
    v_dot2_f32_bf16 v47, v218, v14, v47
    v_dot2_f32_bf16 v47, v219, v15, v47
    s_waitcnt vmcnt(4)
    buffer_load_dwordx4 v[240:243], v1, s[44:47], s91 offen offset:1024 nt
    v_dot2_f32_bf16 v48, v220, v12, 0
    v_dot2_f32_bf16 v48, v221, v13, v48
    v_dot2_f32_bf16 v48, v222, v14, v48
    v_dot2_f32_bf16 v48, v223, v15, v48
    v_add_f32_dpp v46, v46, v46 row_ror:8 row_mask:0xf bank_mask:0x3
    s_nop 1
    v_add_f32_dpp v46, v47, v47 row_ror:8 row_mask:0xf bank_mask:0xc
    s_waitcnt vmcnt(4)
    buffer_load_dwordx4 v[244:247], v1, s[44:47], s91 offen offset:2048 nt
    v_dot2_f32_bf16 v49, v224, v12, 0
    v_dot2_f32_bf16 v49, v225, v13, v49
    v_dot2_f32_bf16 v49, v226, v14, v49
    v_dot2_f32_bf16 v49, v227, v15, v49
    v_add_f32_dpp v44, v44, v44 row_half_mirror row_mask:0xf bank_mask:0x5
    s_nop 1
    v_add_f32_dpp v44, v46, v46 row_half_mirror row_mask:0xf bank_mask:0xa
    s_waitcnt vmcnt(4)
    buffer_load_dwordx4 v[248:251], v1, s[44:47], s91 offen offset:3072 nt
    v_dot2_f32_bf16 v50, v228, v12, 0
    v_dot2_f32_bf16 v50, v229, v13, v50
    v_dot2_f32_bf16 v50, v230, v14, v50
    v_dot2_f32_bf16 v50, v231, v15, v50
    v_add_f32_dpp v48, v48, v48 row_ror:8 row_mask:0xf bank_mask:0x3
    s_nop 1
    v_add_f32_dpp v48, v49, v49 row_ror:8 row_mask:0xf bank_mask:0xc
    s_waitcnt vmcnt(4)
    s_add_u32 s76, s6, 770048
    buffer_load_dwordx4 v[64:67], v1, s[44:47], s76 offen offset:0 nt
    v_dot2_f32_bf16 v51, v232, v12, 0
    v_dot2_f32_bf16 v51, v233, v13, v51
    v_dot2_f32_bf16 v51, v234, v14, v51
    v_dot2_f32_bf16 v51, v235, v15, v51
    s_waitcnt vmcnt(4)
    buffer_load_dwordx4 v[68:71], v1, s[44:47], s76 offen offset:1024 nt
    v_dot2_f32_bf16 v52, v236, v12, 0
    v_dot2_f32_bf16 v52, v237, v13, v52
    v_dot2_f32_bf16 v52, v238, v14, v52
    v_dot2_f32_bf16 v52, v239, v15, v52
    v_add_f32_dpp v50, v50, v50 row_ror:8 row_mask:0xf bank_mask:0x3
    s_nop 1
    v_add_f32_dpp v50, v51, v51 row_ror:8 row_mask:0xf bank_mask:0xc
    s_waitcnt vmcnt(4)
    buffer_load_dwordx4 v[72:75], v1, s[44:47], s76 offen offset:2048 nt
    v_dot2_f32_bf16 v53, v240, v12, 0
    v_dot2_f32_bf16 v53, v241, v13, v53
    v_dot2_f32_bf16 v53, v242, v14, v53
    v_dot2_f32_bf16 v53, v243, v15, v53
    v_add_f32_dpp v48, v48, v48 row_half_mirror row_mask:0xf bank_mask:0x5
    s_nop 1
    v_add_f32_dpp v48, v50, v50 row_half_mirror row_mask:0xf bank_mask:0xa
    s_waitcnt vmcnt(4)
    buffer_load_dwordx4 v[76:79], v1, s[44:47], s76 offen offset:3072 nt
    v_dot2_f32_bf16 v54, v244, v12, 0
    v_dot2_f32_bf16 v54, v245, v13, v54
    v_dot2_f32_bf16 v54, v246, v14, v54
    v_dot2_f32_bf16 v54, v247, v15, v54
    v_add_f32_dpp v52, v52, v52 row_ror:8 row_mask:0xf bank_mask:0x3
    s_nop 1
    v_add_f32_dpp v52, v53, v53 row_ror:8 row_mask:0xf bank_mask:0xc
    s_waitcnt vmcnt(4)
    s_add_u32 s77, s6, 786432
    buffer_load_dwordx4 v[80:83], v1, s[44:47], s77 offen offset:0 nt
    v_dot2_f32_bf16 v55, v248, v12, 0
    v_dot2_f32_bf16 v55, v249, v13, v55
    v_dot2_f32_bf16 v55, v250, v14, v55
    v_dot2_f32_bf16 v55, v251, v15, v55
    v_add_f32_dpp v44, v44, v44 quad_perm:[2,3,0,1] row_mask:0xf bank_mask:0xf
    v_add_f32_dpp v48, v48, v48 quad_perm:[2,3,0,1] row_mask:0xf bank_mask:0xf
    v_cndmask_b32 v44, v44, v48, s[92:93]
    s_waitcnt vmcnt(4)
    buffer_load_dwordx4 v[84:87], v1, s[44:47], s77 offen offset:1024 nt
    v_dot2_f32_bf16 v56, v64, v12, 0
    v_dot2_f32_bf16 v56, v65, v13, v56
    v_dot2_f32_bf16 v56, v66, v14, v56
    v_dot2_f32_bf16 v56, v67, v15, v56
    v_add_f32_dpp v54, v54, v54 row_ror:8 row_mask:0xf bank_mask:0x3
    s_nop 1
    v_add_f32_dpp v54, v55, v55 row_ror:8 row_mask:0xf bank_mask:0xc
    s_waitcnt vmcnt(4)
    buffer_load_dwordx4 v[88:91], v1, s[44:47], s77 offen offset:2048 nt
    v_dot2_f32_bf16 v57, v68, v12, 0
    v_dot2_f32_bf16 v57, v69, v13, v57
    v_dot2_f32_bf16 v57, v70, v14, v57
    v_dot2_f32_bf16 v57, v71, v15, v57
    v_add_f32_dpp v52, v52, v52 row_half_mirror row_mask:0xf bank_mask:0x5
    s_nop 1
    v_add_f32_dpp v52, v54, v54 row_half_mirror row_mask:0xf bank_mask:0xa
    s_waitcnt vmcnt(4)
    buffer_load_dwordx4 v[92:95], v1, s[44:47], s77 offen offset:3072 nt
    v_dot2_f32_bf16 v58, v72, v12, 0
    v_dot2_f32_bf16 v58, v73, v13, v58
    v_dot2_f32_bf16 v58, v74, v14, v58
    v_dot2_f32_bf16 v58, v75, v15, v58
    v_add_f32_dpp v56, v56, v56 row_ror:8 row_mask:0xf bank_mask:0x3
    s_nop 1
    v_add_f32_dpp v56, v57, v57 row_ror:8 row_mask:0xf bank_mask:0xc
    s_waitcnt vmcnt(4)
    s_add_u32 s78, s6, 802816
    buffer_load_dwordx4 v[96:99], v1, s[44:47], s78 offen offset:0 nt
    v_dot2_f32_bf16 v59, v76, v12, 0
    v_dot2_f32_bf16 v59, v77, v13, v59
    v_dot2_f32_bf16 v59, v78, v14, v59
    v_dot2_f32_bf16 v59, v79, v15, v59
    v_add_f32_dpp v58, v58, v58 row_ror:8 row_mask:0xf bank_mask:0x3
    s_nop 1
    v_add_f32_dpp v58, v59, v59 row_ror:8 row_mask:0xf bank_mask:0xc
    v_add_f32_dpp v56, v56, v56 row_half_mirror row_mask:0xf bank_mask:0x5
    s_nop 1
    v_add_f32_dpp v56, v58, v58 row_half_mirror row_mask:0xf bank_mask:0xa
    v_add_f32_dpp v52, v52, v52 quad_perm:[2,3,0,1] row_mask:0xf bank_mask:0xf
    s_nop 0
    v_add_f32_dpp v56, v56, v56 quad_perm:[2,3,0,1] row_mask:0xf bank_mask:0xf
    v_cndmask_b32 v52, v52, v56, s[92:93]
    v_add_f32_dpp v44, v44, v44 quad_perm:[1,0,3,2] row_mask:0xf bank_mask:0xf
    s_nop 0
    v_add_f32_dpp v52, v52, v52 quad_perm:[1,0,3,2] row_mask:0xf bank_mask:0xf
    v_cndmask_b32 v27, v44, v52, s[94:95]
    v_cvt_pk_bf16_f32 v27, v27, v27
    v_and_b32 v27, 0xffff0000, v27
    v_mul_f32 v27, 0x3db504f3, v27
    v_cvt_pk_bf16_f32 v27, v27, v27
    v_and_b32 v27, 0xffff0000, v27
    v_max_f32 v60, v60, v27
    s_waitcnt vmcnt(4)
    buffer_load_dwordx4 v[100:103], v1, s[44:47], s78 offen offset:1024 nt
    v_dot2_f32_bf16 v44, v80, v12, 0
    v_dot2_f32_bf16 v44, v81, v13, v44
    v_dot2_f32_bf16 v44, v82, v14, v44
    v_dot2_f32_bf16 v44, v83, v15, v44
    s_waitcnt vmcnt(4)
    buffer_load_dwordx4 v[104:107], v1, s[44:47], s78 offen offset:2048 nt
    v_dot2_f32_bf16 v45, v84, v12, 0
    v_dot2_f32_bf16 v45, v85, v13, v45
    v_dot2_f32_bf16 v45, v86, v14, v45
    v_dot2_f32_bf16 v45, v87, v15, v45
    s_waitcnt vmcnt(4)
    buffer_load_dwordx4 v[108:111], v1, s[44:47], s78 offen offset:3072 nt
    v_dot2_f32_bf16 v46, v88, v12, 0
    v_dot2_f32_bf16 v46, v89, v13, v46
    v_dot2_f32_bf16 v46, v90, v14, v46
    v_dot2_f32_bf16 v46, v91, v15, v46
    v_add_f32_dpp v44, v44, v44 row_ror:8 row_mask:0xf bank_mask:0x3
    s_nop 1
    v_add_f32_dpp v44, v45, v45 row_ror:8 row_mask:0xf bank_mask:0xc
    s_waitcnt vmcnt(4)
    s_add_u32 s79, s6, 819200
    buffer_load_dwordx4 v[112:115], v1, s[44:47], s79 offen offset:0 nt
    v_dot2_f32_bf16 v47, v92, v12, 0
    v_dot2_f32_bf16 v47, v93, v13, v47
    v_dot2_f32_bf16 v47, v94, v14, v47
    v_dot2_f32_bf16 v47, v95, v15, v47
    s_waitcnt vmcnt(4)
    buffer_load_dwordx4 v[116:119], v1, s[44:47], s79 offen offset:1024 nt
    v_dot2_f32_bf16 v48, v96, v12, 0
    v_dot2_f32_bf16 v48, v97, v13, v48
    v_dot2_f32_bf16 v48, v98, v14, v48
    v_dot2_f32_bf16 v48, v99, v15, v48
    v_add_f32_dpp v46, v46, v46 row_ror:8 row_mask:0xf bank_mask:0x3
    s_nop 1
    v_add_f32_dpp v46, v47, v47 row_ror:8 row_mask:0xf bank_mask:0xc
    s_waitcnt vmcnt(4)
    buffer_load_dwordx4 v[120:123], v1, s[44:47], s79 offen offset:2048 nt
    v_dot2_f32_bf16 v49, v100, v12, 0
    v_dot2_f32_bf16 v49, v101, v13, v49
    v_dot2_f32_bf16 v49, v102, v14, v49
    v_dot2_f32_bf16 v49, v103, v15, v49
    v_add_f32_dpp v44, v44, v44 row_half_mirror row_mask:0xf bank_mask:0x5
    s_nop 1
    v_add_f32_dpp v44, v46, v46 row_half_mirror row_mask:0xf bank_mask:0xa
    s_waitcnt vmcnt(4)
    buffer_load_dwordx4 v[124:127], v1, s[44:47], s79 offen offset:3072 nt
    v_dot2_f32_bf16 v50, v104, v12, 0
    v_dot2_f32_bf16 v50, v105, v13, v50
    v_dot2_f32_bf16 v50, v106, v14, v50
    v_dot2_f32_bf16 v50, v107, v15, v50
    v_add_f32_dpp v48, v48, v48 row_ror:8 row_mask:0xf bank_mask:0x3
    s_nop 1
    v_add_f32_dpp v48, v49, v49 row_ror:8 row_mask:0xf bank_mask:0xc
    s_waitcnt vmcnt(4)
    s_add_u32 s80, s6, 835584
    buffer_load_dwordx4 v[128:131], v1, s[44:47], s80 offen offset:0 nt
    v_dot2_f32_bf16 v51, v108, v12, 0
    v_dot2_f32_bf16 v51, v109, v13, v51
    v_dot2_f32_bf16 v51, v110, v14, v51
    v_dot2_f32_bf16 v51, v111, v15, v51
    s_waitcnt vmcnt(4)
    buffer_load_dwordx4 v[132:135], v1, s[44:47], s80 offen offset:1024 nt
    v_dot2_f32_bf16 v52, v112, v12, 0
    v_dot2_f32_bf16 v52, v113, v13, v52
    v_dot2_f32_bf16 v52, v114, v14, v52
    v_dot2_f32_bf16 v52, v115, v15, v52
    v_add_f32_dpp v50, v50, v50 row_ror:8 row_mask:0xf bank_mask:0x3
    s_nop 1
    v_add_f32_dpp v50, v51, v51 row_ror:8 row_mask:0xf bank_mask:0xc
    s_waitcnt vmcnt(4)
    buffer_load_dwordx4 v[136:139], v1, s[44:47], s80 offen offset:2048 nt
    v_dot2_f32_bf16 v53, v116, v12, 0
    v_dot2_f32_bf16 v53, v117, v13, v53
    v_dot2_f32_bf16 v53, v118, v14, v53
    v_dot2_f32_bf16 v53, v119, v15, v53
    v_add_f32_dpp v48, v48, v48 row_half_mirror row_mask:0xf bank_mask:0x5
    s_nop 1
    v_add_f32_dpp v48, v50, v50 row_half_mirror row_mask:0xf bank_mask:0xa
    s_waitcnt vmcnt(4)
    buffer_load_dwordx4 v[140:143], v1, s[44:47], s80 offen offset:3072 nt
    v_dot2_f32_bf16 v54, v120, v12, 0
    v_dot2_f32_bf16 v54, v121, v13, v54
    v_dot2_f32_bf16 v54, v122, v14, v54
    v_dot2_f32_bf16 v54, v123, v15, v54
    v_add_f32_dpp v52, v52, v52 row_ror:8 row_mask:0xf bank_mask:0x3
    s_nop 1
    v_add_f32_dpp v52, v53, v53 row_ror:8 row_mask:0xf bank_mask:0xc
    s_waitcnt vmcnt(4)
    s_add_u32 s81, s6, 851968
    buffer_load_dwordx4 v[144:147], v1, s[44:47], s81 offen offset:0 nt
    v_dot2_f32_bf16 v55, v124, v12, 0
    v_dot2_f32_bf16 v55, v125, v13, v55
    v_dot2_f32_bf16 v55, v126, v14, v55
    v_dot2_f32_bf16 v55, v127, v15, v55
    v_add_f32_dpp v44, v44, v44 quad_perm:[2,3,0,1] row_mask:0xf bank_mask:0xf
    v_add_f32_dpp v48, v48, v48 quad_perm:[2,3,0,1] row_mask:0xf bank_mask:0xf
    v_cndmask_b32 v44, v44, v48, s[92:93]
    s_waitcnt vmcnt(4)
    buffer_load_dwordx4 v[148:151], v1, s[44:47], s81 offen offset:1024 nt
    v_dot2_f32_bf16 v56, v128, v12, 0
    v_dot2_f32_bf16 v56, v129, v13, v56
    v_dot2_f32_bf16 v56, v130, v14, v56
    v_dot2_f32_bf16 v56, v131, v15, v56
    v_add_f32_dpp v54, v54, v54 row_ror:8 row_mask:0xf bank_mask:0x3
    s_nop 1
    v_add_f32_dpp v54, v55, v55 row_ror:8 row_mask:0xf bank_mask:0xc
    s_waitcnt vmcnt(4)
    buffer_load_dwordx4 v[152:155], v1, s[44:47], s81 offen offset:2048 nt
    v_dot2_f32_bf16 v57, v132, v12, 0
    v_dot2_f32_bf16 v57, v133, v13, v57
    v_dot2_f32_bf16 v57, v134, v14, v57
    v_dot2_f32_bf16 v57, v135, v15, v57
    v_add_f32_dpp v52, v52, v52 row_half_mirror row_mask:0xf bank_mask:0x5
    s_nop 1
    v_add_f32_dpp v52, v54, v54 row_half_mirror row_mask:0xf bank_mask:0xa
    s_waitcnt vmcnt(4)
    buffer_load_dwordx4 v[156:159], v1, s[44:47], s81 offen offset:3072 nt
    v_dot2_f32_bf16 v58, v136, v12, 0
    v_dot2_f32_bf16 v58, v137, v13, v58
    v_dot2_f32_bf16 v58, v138, v14, v58
    v_dot2_f32_bf16 v58, v139, v15, v58
    v_add_f32_dpp v56, v56, v56 row_ror:8 row_mask:0xf bank_mask:0x3
    s_nop 1
    v_add_f32_dpp v56, v57, v57 row_ror:8 row_mask:0xf bank_mask:0xc
    s_waitcnt vmcnt(4)
    s_add_u32 s82, s6, 868352
    buffer_load_dwordx4 v[160:163], v1, s[44:47], s82 offen offset:0 nt
    v_dot2_f32_bf16 v59, v140, v12, 0
    v_dot2_f32_bf16 v59, v141, v13, v59
    v_dot2_f32_bf16 v59, v142, v14, v59
    v_dot2_f32_bf16 v59, v143, v15, v59
    v_add_f32_dpp v58, v58, v58 row_ror:8 row_mask:0xf bank_mask:0x3
    s_nop 1
    v_add_f32_dpp v58, v59, v59 row_ror:8 row_mask:0xf bank_mask:0xc
    v_add_f32_dpp v56, v56, v56 row_half_mirror row_mask:0xf bank_mask:0x5
    s_nop 1
    v_add_f32_dpp v56, v58, v58 row_half_mirror row_mask:0xf bank_mask:0xa
    v_add_f32_dpp v52, v52, v52 quad_perm:[2,3,0,1] row_mask:0xf bank_mask:0xf
    s_nop 0
    v_add_f32_dpp v56, v56, v56 quad_perm:[2,3,0,1] row_mask:0xf bank_mask:0xf
    v_cndmask_b32 v52, v52, v56, s[92:93]
    v_add_f32_dpp v44, v44, v44 quad_perm:[1,0,3,2] row_mask:0xf bank_mask:0xf
    s_nop 0
    v_add_f32_dpp v52, v52, v52 quad_perm:[1,0,3,2] row_mask:0xf bank_mask:0xf
    v_cndmask_b32 v28, v44, v52, s[94:95]
    v_cvt_pk_bf16_f32 v28, v28, v28
    v_and_b32 v28, 0xffff0000, v28
    v_mul_f32 v28, 0x3db504f3, v28
    v_cvt_pk_bf16_f32 v28, v28, v28
    v_and_b32 v28, 0xffff0000, v28
    v_max_f32 v60, v60, v28
    s_waitcnt vmcnt(4)
    buffer_load_dwordx4 v[164:167], v1, s[44:47], s82 offen offset:1024 nt
    v_dot2_f32_bf16 v44, v144, v12, 0
    v_dot2_f32_bf16 v44, v145, v13, v44
    v_dot2_f32_bf16 v44, v146, v14, v44
    v_dot2_f32_bf16 v44, v147, v15, v44
    s_waitcnt vmcnt(4)
    buffer_load_dwordx4 v[168:171], v1, s[44:47], s82 offen offset:2048 nt
    v_dot2_f32_bf16 v45, v148, v12, 0
    v_dot2_f32_bf16 v45, v149, v13, v45
    v_dot2_f32_bf16 v45, v150, v14, v45
    v_dot2_f32_bf16 v45, v151, v15, v45
    s_waitcnt vmcnt(4)
    buffer_load_dwordx4 v[172:175], v1, s[44:47], s82 offen offset:3072 nt
    v_dot2_f32_bf16 v46, v152, v12, 0
    v_dot2_f32_bf16 v46, v153, v13, v46
    v_dot2_f32_bf16 v46, v154, v14, v46
    v_dot2_f32_bf16 v46, v155, v15, v46
    v_add_f32_dpp v44, v44, v44 row_ror:8 row_mask:0xf bank_mask:0x3
    s_nop 1
    v_add_f32_dpp v44, v45, v45 row_ror:8 row_mask:0xf bank_mask:0xc
    s_waitcnt vmcnt(4)
    s_add_u32 s83, s6, 884736
    buffer_load_dwordx4 v[176:179], v1, s[44:47], s83 offen offset:0 nt
    v_dot2_f32_bf16 v47, v156, v12, 0
    v_dot2_f32_bf16 v47, v157, v13, v47
    v_dot2_f32_bf16 v47, v158, v14, v47
    v_dot2_f32_bf16 v47, v159, v15, v47
    s_waitcnt vmcnt(4)
    buffer_load_dwordx4 v[180:183], v1, s[44:47], s83 offen offset:1024 nt
    v_dot2_f32_bf16 v48, v160, v12, 0
    v_dot2_f32_bf16 v48, v161, v13, v48
    v_dot2_f32_bf16 v48, v162, v14, v48
    v_dot2_f32_bf16 v48, v163, v15, v48
    v_add_f32_dpp v46, v46, v46 row_ror:8 row_mask:0xf bank_mask:0x3
    s_nop 1
    v_add_f32_dpp v46, v47, v47 row_ror:8 row_mask:0xf bank_mask:0xc
    s_waitcnt vmcnt(4)
    buffer_load_dwordx4 v[184:187], v1, s[44:47], s83 offen offset:2048 nt
    v_dot2_f32_bf16 v49, v164, v12, 0
    v_dot2_f32_bf16 v49, v165, v13, v49
    v_dot2_f32_bf16 v49, v166, v14, v49
    v_dot2_f32_bf16 v49, v167, v15, v49
    v_add_f32_dpp v44, v44, v44 row_half_mirror row_mask:0xf bank_mask:0x5
    s_nop 1
    v_add_f32_dpp v44, v46, v46 row_half_mirror row_mask:0xf bank_mask:0xa
    s_waitcnt vmcnt(4)
    buffer_load_dwordx4 v[188:191], v1, s[44:47], s83 offen offset:3072 nt
    v_dot2_f32_bf16 v50, v168, v12, 0
    v_dot2_f32_bf16 v50, v169, v13, v50
    v_dot2_f32_bf16 v50, v170, v14, v50
    v_dot2_f32_bf16 v50, v171, v15, v50
    v_add_f32_dpp v48, v48, v48 row_ror:8 row_mask:0xf bank_mask:0x3
    s_nop 1
    v_add_f32_dpp v48, v49, v49 row_ror:8 row_mask:0xf bank_mask:0xc
    s_waitcnt vmcnt(4)
    s_add_u32 s84, s6, 901120
    buffer_load_dwordx4 v[192:195], v1, s[44:47], s84 offen offset:0 nt
    v_dot2_f32_bf16 v51, v172, v12, 0
    v_dot2_f32_bf16 v51, v173, v13, v51
    v_dot2_f32_bf16 v51, v174, v14, v51
    v_dot2_f32_bf16 v51, v175, v15, v51
    s_waitcnt vmcnt(4)
    buffer_load_dwordx4 v[196:199], v1, s[44:47], s84 offen offset:1024 nt
    v_dot2_f32_bf16 v52, v176, v12, 0
    v_dot2_f32_bf16 v52, v177, v13, v52
    v_dot2_f32_bf16 v52, v178, v14, v52
    v_dot2_f32_bf16 v52, v179, v15, v52
    v_add_f32_dpp v50, v50, v50 row_ror:8 row_mask:0xf bank_mask:0x3
    s_nop 1
    v_add_f32_dpp v50, v51, v51 row_ror:8 row_mask:0xf bank_mask:0xc
    s_waitcnt vmcnt(4)
    buffer_load_dwordx4 v[200:203], v1, s[44:47], s84 offen offset:2048 nt
    v_dot2_f32_bf16 v53, v180, v12, 0
    v_dot2_f32_bf16 v53, v181, v13, v53
    v_dot2_f32_bf16 v53, v182, v14, v53
    v_dot2_f32_bf16 v53, v183, v15, v53
    v_add_f32_dpp v48, v48, v48 row_half_mirror row_mask:0xf bank_mask:0x5
    s_nop 1
    v_add_f32_dpp v48, v50, v50 row_half_mirror row_mask:0xf bank_mask:0xa
    s_waitcnt vmcnt(4)
    buffer_load_dwordx4 v[204:207], v1, s[44:47], s84 offen offset:3072 nt
    v_dot2_f32_bf16 v54, v184, v12, 0
    v_dot2_f32_bf16 v54, v185, v13, v54
    v_dot2_f32_bf16 v54, v186, v14, v54
    v_dot2_f32_bf16 v54, v187, v15, v54
    v_add_f32_dpp v52, v52, v52 row_ror:8 row_mask:0xf bank_mask:0x3
    s_nop 1
    v_add_f32_dpp v52, v53, v53 row_ror:8 row_mask:0xf bank_mask:0xc
    s_waitcnt vmcnt(4)
    s_add_u32 s85, s6, 917504
    buffer_load_dwordx4 v[208:211], v1, s[44:47], s85 offen offset:0 nt
    v_dot2_f32_bf16 v55, v188, v12, 0
    v_dot2_f32_bf16 v55, v189, v13, v55
    v_dot2_f32_bf16 v55, v190, v14, v55
    v_dot2_f32_bf16 v55, v191, v15, v55
    v_add_f32_dpp v44, v44, v44 quad_perm:[2,3,0,1] row_mask:0xf bank_mask:0xf
    v_add_f32_dpp v48, v48, v48 quad_perm:[2,3,0,1] row_mask:0xf bank_mask:0xf
    v_cndmask_b32 v44, v44, v48, s[92:93]
    s_waitcnt vmcnt(4)
    buffer_load_dwordx4 v[212:215], v1, s[44:47], s85 offen offset:1024 nt
    v_dot2_f32_bf16 v56, v192, v12, 0
    v_dot2_f32_bf16 v56, v193, v13, v56
    v_dot2_f32_bf16 v56, v194, v14, v56
    v_dot2_f32_bf16 v56, v195, v15, v56
    v_add_f32_dpp v54, v54, v54 row_ror:8 row_mask:0xf bank_mask:0x3
    s_nop 1
    v_add_f32_dpp v54, v55, v55 row_ror:8 row_mask:0xf bank_mask:0xc
    s_waitcnt vmcnt(4)
    buffer_load_dwordx4 v[216:219], v1, s[44:47], s85 offen offset:2048 nt
    v_dot2_f32_bf16 v57, v196, v12, 0
    v_dot2_f32_bf16 v57, v197, v13, v57
    v_dot2_f32_bf16 v57, v198, v14, v57
    v_dot2_f32_bf16 v57, v199, v15, v57
    v_add_f32_dpp v52, v52, v52 row_half_mirror row_mask:0xf bank_mask:0x5
    s_nop 1
    v_add_f32_dpp v52, v54, v54 row_half_mirror row_mask:0xf bank_mask:0xa
    s_waitcnt vmcnt(4)
    buffer_load_dwordx4 v[220:223], v1, s[44:47], s85 offen offset:3072 nt
    v_dot2_f32_bf16 v58, v200, v12, 0
    v_dot2_f32_bf16 v58, v201, v13, v58
    v_dot2_f32_bf16 v58, v202, v14, v58
    v_dot2_f32_bf16 v58, v203, v15, v58
    v_add_f32_dpp v56, v56, v56 row_ror:8 row_mask:0xf bank_mask:0x3
    s_nop 1
    v_add_f32_dpp v56, v57, v57 row_ror:8 row_mask:0xf bank_mask:0xc
    s_waitcnt vmcnt(4)
    s_add_u32 s86, s6, 933888
    buffer_load_dwordx4 v[224:227], v1, s[44:47], s86 offen offset:0 nt
    v_dot2_f32_bf16 v59, v204, v12, 0
    v_dot2_f32_bf16 v59, v205, v13, v59
    v_dot2_f32_bf16 v59, v206, v14, v59
    v_dot2_f32_bf16 v59, v207, v15, v59
    v_add_f32_dpp v58, v58, v58 row_ror:8 row_mask:0xf bank_mask:0x3
    s_nop 1
    v_add_f32_dpp v58, v59, v59 row_ror:8 row_mask:0xf bank_mask:0xc
    v_add_f32_dpp v56, v56, v56 row_half_mirror row_mask:0xf bank_mask:0x5
    s_nop 1
    v_add_f32_dpp v56, v58, v58 row_half_mirror row_mask:0xf bank_mask:0xa
    v_add_f32_dpp v52, v52, v52 quad_perm:[2,3,0,1] row_mask:0xf bank_mask:0xf
    s_nop 0
    v_add_f32_dpp v56, v56, v56 quad_perm:[2,3,0,1] row_mask:0xf bank_mask:0xf
    v_cndmask_b32 v52, v52, v56, s[92:93]
    v_add_f32_dpp v44, v44, v44 quad_perm:[1,0,3,2] row_mask:0xf bank_mask:0xf
    s_nop 0
    v_add_f32_dpp v52, v52, v52 quad_perm:[1,0,3,2] row_mask:0xf bank_mask:0xf
    v_cndmask_b32 v29, v44, v52, s[94:95]
    v_cvt_pk_bf16_f32 v29, v29, v29
    v_and_b32 v29, 0xffff0000, v29
    v_mul_f32 v29, 0x3db504f3, v29
    v_cvt_pk_bf16_f32 v29, v29, v29
    v_and_b32 v29, 0xffff0000, v29
    v_max_f32 v60, v60, v29
    s_waitcnt vmcnt(4)
    buffer_load_dwordx4 v[228:231], v1, s[44:47], s86 offen offset:1024 nt
    v_dot2_f32_bf16 v44, v208, v12, 0
    v_dot2_f32_bf16 v44, v209, v13, v44
    v_dot2_f32_bf16 v44, v210, v14, v44
    v_dot2_f32_bf16 v44, v211, v15, v44
    s_waitcnt vmcnt(4)
    buffer_load_dwordx4 v[232:235], v1, s[44:47], s86 offen offset:2048 nt
    v_dot2_f32_bf16 v45, v212, v12, 0
    v_dot2_f32_bf16 v45, v213, v13, v45
    v_dot2_f32_bf16 v45, v214, v14, v45
    v_dot2_f32_bf16 v45, v215, v15, v45
    s_waitcnt vmcnt(4)
    buffer_load_dwordx4 v[236:239], v1, s[44:47], s86 offen offset:3072 nt
    v_dot2_f32_bf16 v46, v216, v12, 0
    v_dot2_f32_bf16 v46, v217, v13, v46
    v_dot2_f32_bf16 v46, v218, v14, v46
    v_dot2_f32_bf16 v46, v219, v15, v46
    v_add_f32_dpp v44, v44, v44 row_ror:8 row_mask:0xf bank_mask:0x3
    s_nop 1
    v_add_f32_dpp v44, v45, v45 row_ror:8 row_mask:0xf bank_mask:0xc
    s_waitcnt vmcnt(4)
    s_add_u32 s87, s6, 950272
    buffer_load_dwordx4 v[240:243], v1, s[44:47], s87 offen offset:0 nt
    v_dot2_f32_bf16 v47, v220, v12, 0
    v_dot2_f32_bf16 v47, v221, v13, v47
    v_dot2_f32_bf16 v47, v222, v14, v47
    v_dot2_f32_bf16 v47, v223, v15, v47
    s_waitcnt vmcnt(4)
    buffer_load_dwordx4 v[244:247], v1, s[44:47], s87 offen offset:1024 nt
    v_dot2_f32_bf16 v48, v224, v12, 0
    v_dot2_f32_bf16 v48, v225, v13, v48
    v_dot2_f32_bf16 v48, v226, v14, v48
    v_dot2_f32_bf16 v48, v227, v15, v48
    v_add_f32_dpp v46, v46, v46 row_ror:8 row_mask:0xf bank_mask:0x3
    s_nop 1
    v_add_f32_dpp v46, v47, v47 row_ror:8 row_mask:0xf bank_mask:0xc
    s_waitcnt vmcnt(4)
    buffer_load_dwordx4 v[248:251], v1, s[44:47], s87 offen offset:2048 nt
    v_dot2_f32_bf16 v49, v228, v12, 0
    v_dot2_f32_bf16 v49, v229, v13, v49
    v_dot2_f32_bf16 v49, v230, v14, v49
    v_dot2_f32_bf16 v49, v231, v15, v49
    v_add_f32_dpp v44, v44, v44 row_half_mirror row_mask:0xf bank_mask:0x5
    s_nop 1
    v_add_f32_dpp v44, v46, v46 row_half_mirror row_mask:0xf bank_mask:0xa
    s_waitcnt vmcnt(4)
    buffer_load_dwordx4 v[64:67], v1, s[44:47], s87 offen offset:3072 nt
    v_dot2_f32_bf16 v50, v232, v12, 0
    v_dot2_f32_bf16 v50, v233, v13, v50
    v_dot2_f32_bf16 v50, v234, v14, v50
    v_dot2_f32_bf16 v50, v235, v15, v50
    v_add_f32_dpp v48, v48, v48 row_ror:8 row_mask:0xf bank_mask:0x3
    s_nop 1
    v_add_f32_dpp v48, v49, v49 row_ror:8 row_mask:0xf bank_mask:0xc
    s_waitcnt vmcnt(4)
    s_add_u32 s88, s6, 966656
    buffer_load_dwordx4 v[68:71], v1, s[44:47], s88 offen offset:0 nt
    v_dot2_f32_bf16 v51, v236, v12, 0
    v_dot2_f32_bf16 v51, v237, v13, v51
    v_dot2_f32_bf16 v51, v238, v14, v51
    v_dot2_f32_bf16 v51, v239, v15, v51
    s_waitcnt vmcnt(4)
    buffer_load_dwordx4 v[72:75], v1, s[44:47], s88 offen offset:1024 nt
    v_dot2_f32_bf16 v52, v240, v12, 0
    v_dot2_f32_bf16 v52, v241, v13, v52
    v_dot2_f32_bf16 v52, v242, v14, v52
    v_dot2_f32_bf16 v52, v243, v15, v52
    v_add_f32_dpp v50, v50, v50 row_ror:8 row_mask:0xf bank_mask:0x3
    s_nop 1
    v_add_f32_dpp v50, v51, v51 row_ror:8 row_mask:0xf bank_mask:0xc
    s_waitcnt vmcnt(4)
    buffer_load_dwordx4 v[76:79], v1, s[44:47], s88 offen offset:2048 nt
    v_dot2_f32_bf16 v53, v244, v12, 0
    v_dot2_f32_bf16 v53, v245, v13, v53
    v_dot2_f32_bf16 v53, v246, v14, v53
    v_dot2_f32_bf16 v53, v247, v15, v53
    v_add_f32_dpp v48, v48, v48 row_half_mirror row_mask:0xf bank_mask:0x5
    s_nop 1
    v_add_f32_dpp v48, v50, v50 row_half_mirror row_mask:0xf bank_mask:0xa
    s_waitcnt vmcnt(4)
    buffer_load_dwordx4 v[80:83], v1, s[44:47], s88 offen offset:3072 nt
    v_dot2_f32_bf16 v54, v248, v12, 0
    v_dot2_f32_bf16 v54, v249, v13, v54
    v_dot2_f32_bf16 v54, v250, v14, v54
    v_dot2_f32_bf16 v54, v251, v15, v54
    v_add_f32_dpp v52, v52, v52 row_ror:8 row_mask:0xf bank_mask:0x3
    s_nop 1
    v_add_f32_dpp v52, v53, v53 row_ror:8 row_mask:0xf bank_mask:0xc
    s_waitcnt vmcnt(4)
    s_add_u32 s89, s6, 983040
    buffer_load_dwordx4 v[84:87], v1, s[44:47], s89 offen offset:0 nt
    v_dot2_f32_bf16 v55, v64, v12, 0
    v_dot2_f32_bf16 v55, v65, v13, v55
    v_dot2_f32_bf16 v55, v66, v14, v55
    v_dot2_f32_bf16 v55, v67, v15, v55
    v_add_f32_dpp v44, v44, v44 quad_perm:[2,3,0,1] row_mask:0xf bank_mask:0xf
    v_add_f32_dpp v48, v48, v48 quad_perm:[2,3,0,1] row_mask:0xf bank_mask:0xf
    v_cndmask_b32 v44, v44, v48, s[92:93]
    s_waitcnt vmcnt(4)
    buffer_load_dwordx4 v[88:91], v1, s[44:47], s89 offen offset:1024 nt
    v_dot2_f32_bf16 v56, v68, v12, 0
    v_dot2_f32_bf16 v56, v69, v13, v56
    v_dot2_f32_bf16 v56, v70, v14, v56
    v_dot2_f32_bf16 v56, v71, v15, v56
    v_add_f32_dpp v54, v54, v54 row_ror:8 row_mask:0xf bank_mask:0x3
    s_nop 1
    v_add_f32_dpp v54, v55, v55 row_ror:8 row_mask:0xf bank_mask:0xc
    s_waitcnt vmcnt(4)
    buffer_load_dwordx4 v[92:95], v1, s[44:47], s89 offen offset:2048 nt
    v_dot2_f32_bf16 v57, v72, v12, 0
    v_dot2_f32_bf16 v57, v73, v13, v57
    v_dot2_f32_bf16 v57, v74, v14, v57
    v_dot2_f32_bf16 v57, v75, v15, v57
    v_add_f32_dpp v52, v52, v52 row_half_mirror row_mask:0xf bank_mask:0x5
    s_nop 1
    v_add_f32_dpp v52, v54, v54 row_half_mirror row_mask:0xf bank_mask:0xa
    s_waitcnt vmcnt(4)
    buffer_load_dwordx4 v[96:99], v1, s[44:47], s89 offen offset:3072 nt
    v_dot2_f32_bf16 v58, v76, v12, 0
    v_dot2_f32_bf16 v58, v77, v13, v58
    v_dot2_f32_bf16 v58, v78, v14, v58
    v_dot2_f32_bf16 v58, v79, v15, v58
    v_add_f32_dpp v56, v56, v56 row_ror:8 row_mask:0xf bank_mask:0x3
    s_nop 1
    v_add_f32_dpp v56, v57, v57 row_ror:8 row_mask:0xf bank_mask:0xc
    s_waitcnt vmcnt(4)
    s_add_u32 s90, s6, 999424
    buffer_load_dwordx4 v[100:103], v1, s[44:47], s90 offen offset:0 nt
    v_dot2_f32_bf16 v59, v80, v12, 0
    v_dot2_f32_bf16 v59, v81, v13, v59
    v_dot2_f32_bf16 v59, v82, v14, v59
    v_dot2_f32_bf16 v59, v83, v15, v59
    v_add_f32_dpp v58, v58, v58 row_ror:8 row_mask:0xf bank_mask:0x3
    s_nop 1
    v_add_f32_dpp v58, v59, v59 row_ror:8 row_mask:0xf bank_mask:0xc
    v_add_f32_dpp v56, v56, v56 row_half_mirror row_mask:0xf bank_mask:0x5
    s_nop 1
    v_add_f32_dpp v56, v58, v58 row_half_mirror row_mask:0xf bank_mask:0xa
    v_add_f32_dpp v52, v52, v52 quad_perm:[2,3,0,1] row_mask:0xf bank_mask:0xf
    s_nop 0
    v_add_f32_dpp v56, v56, v56 quad_perm:[2,3,0,1] row_mask:0xf bank_mask:0xf
    v_cndmask_b32 v52, v52, v56, s[92:93]
    v_add_f32_dpp v44, v44, v44 quad_perm:[1,0,3,2] row_mask:0xf bank_mask:0xf
    s_nop 0
    v_add_f32_dpp v52, v52, v52 quad_perm:[1,0,3,2] row_mask:0xf bank_mask:0xf
    v_cndmask_b32 v30, v44, v52, s[94:95]
    v_cvt_pk_bf16_f32 v30, v30, v30
    v_and_b32 v30, 0xffff0000, v30
    v_mul_f32 v30, 0x3db504f3, v30
    v_cvt_pk_bf16_f32 v30, v30, v30
    v_and_b32 v30, 0xffff0000, v30
    v_max_f32 v60, v60, v30
    s_waitcnt vmcnt(4)
    buffer_load_dwordx4 v[104:107], v1, s[44:47], s90 offen offset:1024 nt
    v_dot2_f32_bf16 v44, v84, v12, 0
    v_dot2_f32_bf16 v44, v85, v13, v44
    v_dot2_f32_bf16 v44, v86, v14, v44
    v_dot2_f32_bf16 v44, v87, v15, v44
    s_waitcnt vmcnt(4)
    buffer_load_dwordx4 v[108:111], v1, s[44:47], s90 offen offset:2048 nt
    v_dot2_f32_bf16 v45, v88, v12, 0
    v_dot2_f32_bf16 v45, v89, v13, v45
    v_dot2_f32_bf16 v45, v90, v14, v45
    v_dot2_f32_bf16 v45, v91, v15, v45
    s_waitcnt vmcnt(4)
    buffer_load_dwordx4 v[112:115], v1, s[44:47], s90 offen offset:3072 nt
    v_dot2_f32_bf16 v46, v92, v12, 0
    v_dot2_f32_bf16 v46, v93, v13, v46
    v_dot2_f32_bf16 v46, v94, v14, v46
    v_dot2_f32_bf16 v46, v95, v15, v46
    v_add_f32_dpp v44, v44, v44 row_ror:8 row_mask:0xf bank_mask:0x3
    s_nop 1
    v_add_f32_dpp v44, v45, v45 row_ror:8 row_mask:0xf bank_mask:0xc
    s_waitcnt vmcnt(4)
    s_add_u32 s91, s6, 1015808
    buffer_load_dwordx4 v[116:119], v1, s[44:47], s91 offen offset:0 nt
    v_dot2_f32_bf16 v47, v96, v12, 0
    v_dot2_f32_bf16 v47, v97, v13, v47
    v_dot2_f32_bf16 v47, v98, v14, v47
    v_dot2_f32_bf16 v47, v99, v15, v47
    s_waitcnt vmcnt(4)
    buffer_load_dwordx4 v[120:123], v1, s[44:47], s91 offen offset:1024 nt
    v_dot2_f32_bf16 v48, v100, v12, 0
    v_dot2_f32_bf16 v48, v101, v13, v48
    v_dot2_f32_bf16 v48, v102, v14, v48
    v_dot2_f32_bf16 v48, v103, v15, v48
    v_add_f32_dpp v46, v46, v46 row_ror:8 row_mask:0xf bank_mask:0x3
    s_nop 1
    v_add_f32_dpp v46, v47, v47 row_ror:8 row_mask:0xf bank_mask:0xc
    s_waitcnt vmcnt(4)
    buffer_load_dwordx4 v[124:127], v1, s[44:47], s91 offen offset:2048 nt
    v_dot2_f32_bf16 v49, v104, v12, 0
    v_dot2_f32_bf16 v49, v105, v13, v49
    v_dot2_f32_bf16 v49, v106, v14, v49
    v_dot2_f32_bf16 v49, v107, v15, v49
    v_add_f32_dpp v44, v44, v44 row_half_mirror row_mask:0xf bank_mask:0x5
    s_nop 1
    v_add_f32_dpp v44, v46, v46 row_half_mirror row_mask:0xf bank_mask:0xa
    s_waitcnt vmcnt(4)
    buffer_load_dwordx4 v[128:131], v1, s[44:47], s91 offen offset:3072 nt
    v_dot2_f32_bf16 v50, v108, v12, 0
    v_dot2_f32_bf16 v50, v109, v13, v50
    v_dot2_f32_bf16 v50, v110, v14, v50
    v_dot2_f32_bf16 v50, v111, v15, v50
    v_add_f32_dpp v48, v48, v48 row_ror:8 row_mask:0xf bank_mask:0x3
    s_nop 1
    v_add_f32_dpp v48, v49, v49 row_ror:8 row_mask:0xf bank_mask:0xc
    s_waitcnt vmcnt(4)
    s_add_u32 s76, s6, 1032192
    buffer_load_dwordx4 v[132:135], v1, s[44:47], s76 offen offset:0 nt
    v_dot2_f32_bf16 v51, v112, v12, 0
    v_dot2_f32_bf16 v51, v113, v13, v51
    v_dot2_f32_bf16 v51, v114, v14, v51
    v_dot2_f32_bf16 v51, v115, v15, v51
    s_waitcnt vmcnt(4)
    buffer_load_dwordx4 v[136:139], v1, s[44:47], s76 offen offset:1024 nt
    v_dot2_f32_bf16 v52, v116, v12, 0
    v_dot2_f32_bf16 v52, v117, v13, v52
    v_dot2_f32_bf16 v52, v118, v14, v52
    v_dot2_f32_bf16 v52, v119, v15, v52
    v_add_f32_dpp v50, v50, v50 row_ror:8 row_mask:0xf bank_mask:0x3
    s_nop 1
    v_add_f32_dpp v50, v51, v51 row_ror:8 row_mask:0xf bank_mask:0xc
    s_waitcnt vmcnt(4)
    buffer_load_dwordx4 v[140:143], v1, s[44:47], s76 offen offset:2048 nt
    v_dot2_f32_bf16 v53, v120, v12, 0
    v_dot2_f32_bf16 v53, v121, v13, v53
    v_dot2_f32_bf16 v53, v122, v14, v53
    v_dot2_f32_bf16 v53, v123, v15, v53
    v_add_f32_dpp v48, v48, v48 row_half_mirror row_mask:0xf bank_mask:0x5
    s_nop 1
    v_add_f32_dpp v48, v50, v50 row_half_mirror row_mask:0xf bank_mask:0xa
    s_waitcnt vmcnt(4)
    buffer_load_dwordx4 v[144:147], v1, s[44:47], s76 offen offset:3072 nt
    v_dot2_f32_bf16 v54, v124, v12, 0
    v_dot2_f32_bf16 v54, v125, v13, v54
    v_dot2_f32_bf16 v54, v126, v14, v54
    v_dot2_f32_bf16 v54, v127, v15, v54
    v_add_f32_dpp v52, v52, v52 row_ror:8 row_mask:0xf bank_mask:0x3
    s_nop 1
    v_add_f32_dpp v52, v53, v53 row_ror:8 row_mask:0xf bank_mask:0xc
    s_waitcnt vmcnt(4)
    s_add_u32 s77, s6, 0
    buffer_load_dwordx4 v[148:151], v1, s[48:51], s77 offen offset:0 nt
    v_dot2_f32_bf16 v55, v128, v12, 0
    v_dot2_f32_bf16 v55, v129, v13, v55
    v_dot2_f32_bf16 v55, v130, v14, v55
    v_dot2_f32_bf16 v55, v131, v15, v55
    v_add_f32_dpp v44, v44, v44 quad_perm:[2,3,0,1] row_mask:0xf bank_mask:0xf
    v_add_f32_dpp v48, v48, v48 quad_perm:[2,3,0,1] row_mask:0xf bank_mask:0xf
    v_cndmask_b32 v44, v44, v48, s[92:93]
    s_waitcnt vmcnt(4)
    buffer_load_dwordx4 v[152:155], v1, s[48:51], s77 offen offset:1024 nt
    v_dot2_f32_bf16 v56, v132, v12, 0
    v_dot2_f32_bf16 v56, v133, v13, v56
    v_dot2_f32_bf16 v56, v134, v14, v56
    v_dot2_f32_bf16 v56, v135, v15, v56
    v_add_f32_dpp v54, v54, v54 row_ror:8 row_mask:0xf bank_mask:0x3
    s_nop 1
    v_add_f32_dpp v54, v55, v55 row_ror:8 row_mask:0xf bank_mask:0xc
    s_waitcnt vmcnt(4)
    buffer_load_dwordx4 v[156:159], v1, s[48:51], s77 offen offset:2048 nt
    v_dot2_f32_bf16 v57, v136, v12, 0
    v_dot2_f32_bf16 v57, v137, v13, v57
    v_dot2_f32_bf16 v57, v138, v14, v57
    v_dot2_f32_bf16 v57, v139, v15, v57
    v_add_f32_dpp v52, v52, v52 row_half_mirror row_mask:0xf bank_mask:0x5
    s_nop 1
    v_add_f32_dpp v52, v54, v54 row_half_mirror row_mask:0xf bank_mask:0xa
    s_waitcnt vmcnt(4)
    buffer_load_dwordx4 v[160:163], v1, s[48:51], s77 offen offset:3072 nt
    v_dot2_f32_bf16 v58, v140, v12, 0
    v_dot2_f32_bf16 v58, v141, v13, v58
    v_dot2_f32_bf16 v58, v142, v14, v58
    v_dot2_f32_bf16 v58, v143, v15, v58
    v_add_f32_dpp v56, v56, v56 row_ror:8 row_mask:0xf bank_mask:0x3
    s_nop 1
    v_add_f32_dpp v56, v57, v57 row_ror:8 row_mask:0xf bank_mask:0xc
    s_waitcnt vmcnt(4)
    s_add_u32 s78, s6, 16384
    buffer_load_dwordx4 v[164:167], v1, s[48:51], s78 offen offset:0 nt
    v_dot2_f32_bf16 v59, v144, v12, 0
    v_dot2_f32_bf16 v59, v145, v13, v59
    v_dot2_f32_bf16 v59, v146, v14, v59
    v_dot2_f32_bf16 v59, v147, v15, v59
    v_add_f32_dpp v58, v58, v58 row_ror:8 row_mask:0xf bank_mask:0x3
    s_nop 1
    v_add_f32_dpp v58, v59, v59 row_ror:8 row_mask:0xf bank_mask:0xc
    v_add_f32_dpp v56, v56, v56 row_half_mirror row_mask:0xf bank_mask:0x5
    s_nop 1
    v_add_f32_dpp v56, v58, v58 row_half_mirror row_mask:0xf bank_mask:0xa
    v_add_f32_dpp v52, v52, v52 quad_perm:[2,3,0,1] row_mask:0xf bank_mask:0xf
    s_nop 0
    v_add_f32_dpp v56, v56, v56 quad_perm:[2,3,0,1] row_mask:0xf bank_mask:0xf
    v_cndmask_b32 v52, v52, v56, s[92:93]
    v_add_f32_dpp v44, v44, v44 quad_perm:[1,0,3,2] row_mask:0xf bank_mask:0xf
    s_nop 0
    v_add_f32_dpp v52, v52, v52 quad_perm:[1,0,3,2] row_mask:0xf bank_mask:0xf
    v_cndmask_b32 v31, v44, v52, s[94:95]
    v_cvt_pk_bf16_f32 v31, v31, v31
    v_and_b32 v31, 0xffff0000, v31
    v_mul_f32 v31, 0x3db504f3, v31
    v_cvt_pk_bf16_f32 v31, v31, v31
    v_and_b32 v31, 0xffff0000, v31
    v_max_f32 v60, v60, v31
    s_nop 1
    v_max_f32_dpp v60, v60, v60 quad_perm:[1,0,3,2] row_mask:0xf bank_mask:0xf
    s_nop 1
    v_max_f32_dpp v60, v60, v60 quad_perm:[2,3,0,1] row_mask:0xf bank_mask:0xf
    s_nop 1
    v_max_f32_dpp v60, v60, v60 row_half_mirror row_mask:0xf bank_mask:0xf
    s_nop 1
    v_max_f32_dpp v60, v60, v60 row_mirror row_mask:0xf bank_mask:0xf
    v_mov_b32 v61, v60
    s_nop 1
    v_permlane16_swap_b32 v60, v61
    v_max_f32 v60, v60, v61
    v_mov_b32 v61, v60
    s_nop 1
    v_permlane32_swap_b32 v60, v61
    v_max_f32 v60, v60, v61
    s_waitcnt vmcnt(4)
    buffer_load_dwordx4 v[168:171], v1, s[48:51], s78 offen offset:1024 nt
    v_sub_f32 v44, v16, v60
    v_mul_f32 v44, 0x3fb8aa3b, v44
    v_exp_f32 v44, v44
    v_sub_f32 v45, v17, v60
    v_mul_f32 v45, 0x3fb8aa3b, v45
    v_exp_f32 v45, v45
    v_sub_f32 v46, v18, v60
    v_mul_f32 v46, 0x3fb8aa3b, v46
    v_exp_f32 v46, v46
    v_sub_f32 v47, v19, v60
    v_mul_f32 v47, 0x3fb8aa3b, v47
    v_exp_f32 v47, v47
    v_sub_f32 v48, v20, v60
    v_mul_f32 v48, 0x3fb8aa3b, v48
    v_exp_f32 v48, v48
    v_sub_f32 v49, v21, v60
    v_mul_f32 v49, 0x3fb8aa3b, v49
    v_exp_f32 v49, v49
    v_sub_f32 v50, v22, v60
    v_mul_f32 v50, 0x3fb8aa3b, v50
    v_exp_f32 v50, v50
    v_sub_f32 v51, v23, v60
    v_mul_f32 v51, 0x3fb8aa3b, v51
    v_exp_f32 v51, v51
    v_sub_f32 v52, v24, v60
    v_mul_f32 v52, 0x3fb8aa3b, v52
    v_exp_f32 v52, v52
    v_sub_f32 v53, v25, v60
    v_mul_f32 v53, 0x3fb8aa3b, v53
    v_exp_f32 v53, v53
    v_sub_f32 v54, v26, v60
    v_mul_f32 v54, 0x3fb8aa3b, v54
    v_exp_f32 v54, v54
    v_sub_f32 v55, v27, v60
    v_mul_f32 v55, 0x3fb8aa3b, v55
    v_exp_f32 v55, v55
    v_sub_f32 v56, v28, v60
    v_mul_f32 v56, 0x3fb8aa3b, v56
    v_exp_f32 v56, v56
    v_sub_f32 v57, v29, v60
    v_mul_f32 v57, 0x3fb8aa3b, v57
    v_exp_f32 v57, v57
    v_sub_f32 v58, v30, v60
    v_mul_f32 v58, 0x3fb8aa3b, v58
    v_exp_f32 v58, v58
    v_sub_f32 v59, v31, v60
    v_mul_f32 v59, 0x3fb8aa3b, v59
    v_exp_f32 v59, v59
    s_waitcnt vmcnt(4)
    buffer_load_dwordx4 v[172:175], v1, s[48:51], s78 offen offset:2048 nt
    v_add_f32 v44, v44, v45
    v_add_f32 v46, v46, v47
    v_add_f32 v48, v48, v49
    v_add_f32 v50, v50, v51
    v_add_f32 v52, v52, v53
    v_add_f32 v54, v54, v55
    v_add_f32 v56, v56, v57
    v_add_f32 v58, v58, v59
    v_add_f32 v44, v44, v46
    v_add_f32 v48, v48, v50
    v_add_f32 v52, v52, v54
    v_add_f32 v56, v56, v58
    v_add_f32 v44, v44, v48
    v_add_f32 v52, v52, v56
    v_add_f32 v44, v44, v52
    v_mov_b32 v61, v44
    s_nop 1
    v_add_f32_dpp v61, v61, v61 quad_perm:[1,0,3,2] row_mask:0xf bank_mask:0xf
    s_nop 1
    v_add_f32_dpp v61, v61, v61 quad_perm:[2,3,0,1] row_mask:0xf bank_mask:0xf
    s_nop 1
    v_add_f32_dpp v61, v61, v61 row_half_mirror row_mask:0xf bank_mask:0xf
    s_nop 1
    v_add_f32_dpp v61, v61, v61 row_mirror row_mask:0xf bank_mask:0xf
    v_mov_b32 v62, v61
    s_nop 1
    v_permlane16_swap_b32 v61, v62
    v_add_f32 v61, v61, v62
    v_mov_b32 v62, v61
    s_nop 1
    v_permlane32_swap_b32 v61, v62
    v_add_f32 v61, v61, v62
    s_mov_b64 exec, 1
    ds_write_b64 v6, v[60:61] offset:6144
    s_mov_b64 exec, -1
    s_waitcnt vmcnt(4)
    buffer_load_dwordx4 v[176:179], v1, s[48:51], s78 offen offset:3072 nt
    s_waitcnt vmcnt(4)
    s_add_u32 s79, s6, 32768
    buffer_load_dwordx4 v[180:183], v1, s[48:51], s79 offen offset:0 nt
    s_waitcnt vmcnt(4)
    buffer_load_dwordx4 v[184:187], v1, s[48:51], s79 offen offset:1024 nt
    s_waitcnt lgkmcnt(0)
    s_barrier
    ds_read_b64 v[60:61], v5 offset:6144
    s_waitcnt lgkmcnt(0)
    v_mov_b32 v62, v60
    s_nop 1
    v_max_f32_dpp v62, v62, v62 quad_perm:[1,0,3,2] row_mask:0xf bank_mask:0xf
    s_nop 1
    v_max_f32_dpp v62, v62, v62 quad_perm:[2,3,0,1] row_mask:0xf bank_mask:0xf
    v_sub_f32 v60, v60, v62
    v_mul_f32 v60, 0x3fb8aa3b, v60
    v_exp_f32 v60, v60
    s_nop 0
    v_mul_f32 v61, v61, v60
    s_nop 1
    v_add_f32_dpp v61, v61, v61 quad_perm:[1,0,3,2] row_mask:0xf bank_mask:0xf
    s_nop 1
    v_add_f32_dpp v61, v61, v61 quad_perm:[2,3,0,1] row_mask:0xf bank_mask:0xf
    v_rcp_f32 v61, v61
    s_waitcnt vmcnt(4)
    buffer_load_dwordx4 v[188:191], v1, s[48:51], s79 offen offset:2048 nt
    v_sub_f32 v16, v16, v62
    v_mul_f32 v16, 0x3fb8aa3b, v16
    v_exp_f32 v16, v16
    v_sub_f32 v17, v17, v62
    v_mul_f32 v17, 0x3fb8aa3b, v17
    v_exp_f32 v17, v17
    v_sub_f32 v18, v18, v62
    v_mul_f32 v18, 0x3fb8aa3b, v18
    v_exp_f32 v18, v18
    v_sub_f32 v19, v19, v62
    v_mul_f32 v19, 0x3fb8aa3b, v19
    v_exp_f32 v19, v19
    v_mul_f32 v16, v16, v61
    v_cvt_pk_bf16_f32 v16, v16, v16
    v_mul_f32 v17, v17, v61
    v_cvt_pk_bf16_f32 v17, v17, v17
    v_mul_f32 v18, v18, v61
    v_cvt_pk_bf16_f32 v18, v18, v18
    v_mul_f32 v19, v19, v61
    v_cvt_pk_bf16_f32 v19, v19, v19
    v_and_b32_dpp v32, v16, v8 row_newbcast:0 row_mask:0xf bank_mask:0xf
    v_and_b32_dpp v33, v16, v9 row_newbcast:0 row_mask:0xf bank_mask:0xf
    v_and_b32_dpp v34, v16, v10 row_newbcast:0 row_mask:0xf bank_mask:0xf
    v_and_b32_dpp v35, v16, v11 row_newbcast:0 row_mask:0xf bank_mask:0xf
    v_and_b32_dpp v36, v16, v8 row_newbcast:8 row_mask:0xf bank_mask:0xf
    v_and_b32_dpp v37, v16, v9 row_newbcast:8 row_mask:0xf bank_mask:0xf
    v_and_b32_dpp v38, v16, v10 row_newbcast:8 row_mask:0xf bank_mask:0xf
    v_and_b32_dpp v39, v16, v11 row_newbcast:8 row_mask:0xf bank_mask:0xf
    v_mfma_f32_16x16x32_bf16 v[40:43], v[148:151], v[32:35], 0
    v_and_b32_dpp v32, v16, v8 row_newbcast:4 row_mask:0xf bank_mask:0xf
    v_and_b32_dpp v33, v16, v9 row_newbcast:4 row_mask:0xf bank_mask:0xf
    v_and_b32_dpp v34, v16, v10 row_newbcast:4 row_mask:0xf bank_mask:0xf
    v_and_b32_dpp v35, v16, v11 row_newbcast:4 row_mask:0xf bank_mask:0xf
    v_mfma_f32_16x16x32_bf16 v[40:43], v[152:155], v[36:39], v[40:43]
    v_sub_f32 v20, v20, v62
    v_mul_f32 v20, 0x3fb8aa3b, v20
    v_exp_f32 v20, v20
    v_sub_f32 v21, v21, v62
    v_mul_f32 v21, 0x3fb8aa3b, v21
    v_exp_f32 v21, v21
    v_sub_f32 v22, v22, v62
    v_mul_f32 v22, 0x3fb8aa3b, v22
    v_exp_f32 v22, v22
    v_sub_f32 v23, v23, v62
    v_mul_f32 v23, 0x3fb8aa3b, v23
    v_exp_f32 v23, v23
    v_mul_f32 v20, v20, v61
    v_cvt_pk_bf16_f32 v20, v20, v20
    v_mul_f32 v21, v21, v61
    v_cvt_pk_bf16_f32 v21, v21, v21
    v_mul_f32 v22, v22, v61
    v_cvt_pk_bf16_f32 v22, v22, v22
    v_mul_f32 v23, v23, v61
    v_cvt_pk_bf16_f32 v23, v23, v23
    s_waitcnt vmcnt(4)
    buffer_load_dwordx4 v[192:195], v1, s[48:51], s79 offen offset:3072 nt
    v_and_b32_dpp v36, v16, v8 row_newbcast:12 row_mask:0xf bank_mask:0xf
    v_and_b32_dpp v37, v16, v9 row_newbcast:12 row_mask:0xf bank_mask:0xf
    v_and_b32_dpp v38, v16, v10 row_newbcast:12 row_mask:0xf bank_mask:0xf
    v_and_b32_dpp v39, v16, v11 row_newbcast:12 row_mask:0xf bank_mask:0xf
    v_mfma_f32_16x16x32_bf16 v[40:43], v[156:159], v[32:35], v[40:43]
    v_and_b32_dpp v32, v16, v8 row_newbcast:2 row_mask:0xf bank_mask:0xf
    v_and_b32_dpp v33, v16, v9 row_newbcast:2 row_mask:0xf bank_mask:0xf
    v_and_b32_dpp v34, v16, v10 row_newbcast:2 row_mask:0xf bank_mask:0xf
    v_and_b32_dpp v35, v16, v11 row_newbcast:2 row_mask:0xf bank_mask:0xf
    v_mfma_f32_16x16x32_bf16 v[40:43], v[160:163], v[36:39], v[40:43]
    v_sub_f32 v24, v24, v62
    v_mul_f32 v24, 0x3fb8aa3b, v24
    v_exp_f32 v24, v24
    v_sub_f32 v25, v25, v62
    v_mul_f32 v25, 0x3fb8aa3b, v25
    v_exp_f32 v25, v25
    v_sub_f32 v26, v26, v62
    v_mul_f32 v26, 0x3fb8aa3b, v26
    v_exp_f32 v26, v26
    v_sub_f32 v27, v27, v62
    v_mul_f32 v27, 0x3fb8aa3b, v27
    v_exp_f32 v27, v27
    v_mul_f32 v24, v24, v61
    v_cvt_pk_bf16_f32 v24, v24, v24
    v_mul_f32 v25, v25, v61
    v_cvt_pk_bf16_f32 v25, v25, v25
    v_mul_f32 v26, v26, v61
    v_cvt_pk_bf16_f32 v26, v26, v26
    v_mul_f32 v27, v27, v61
    v_cvt_pk_bf16_f32 v27, v27, v27
    v_and_b32_dpp v36, v16, v8 row_newbcast:10 row_mask:0xf bank_mask:0xf
    v_and_b32_dpp v37, v16, v9 row_newbcast:10 row_mask:0xf bank_mask:0xf
    v_and_b32_dpp v38, v16, v10 row_newbcast:10 row_mask:0xf bank_mask:0xf
    v_and_b32_dpp v39, v16, v11 row_newbcast:10 row_mask:0xf bank_mask:0xf
    v_mfma_f32_16x16x32_bf16 v[40:43], v[164:167], v[32:35], v[40:43]
    v_and_b32_dpp v32, v16, v8 row_newbcast:6 row_mask:0xf bank_mask:0xf
    v_and_b32_dpp v33, v16, v9 row_newbcast:6 row_mask:0xf bank_mask:0xf
    v_and_b32_dpp v34, v16, v10 row_newbcast:6 row_mask:0xf bank_mask:0xf
    v_and_b32_dpp v35, v16, v11 row_newbcast:6 row_mask:0xf bank_mask:0xf
    v_mfma_f32_16x16x32_bf16 v[40:43], v[168:171], v[36:39], v[40:43]
    s_waitcnt vmcnt(4)
    s_add_u32 s80, s6, 49152
    buffer_load_dwordx4 v[196:199], v1, s[48:51], s80 offen offset:0 nt
    v_sub_f32 v28, v28, v62
    v_mul_f32 v28, 0x3fb8aa3b, v28
    v_exp_f32 v28, v28
    v_sub_f32 v29, v29, v62
    v_mul_f32 v29, 0x3fb8aa3b, v29
    v_exp_f32 v29, v29
    v_sub_f32 v30, v30, v62
    v_mul_f32 v30, 0x3fb8aa3b, v30
    v_exp_f32 v30, v30
    v_sub_f32 v31, v31, v62
    v_mul_f32 v31, 0x3fb8aa3b, v31
    v_exp_f32 v31, v31
    v_mul_f32 v28, v28, v61
    v_cvt_pk_bf16_f32 v28, v28, v28
    v_mul_f32 v29, v29, v61
    v_cvt_pk_bf16_f32 v29, v29, v29
    v_mul_f32 v30, v30, v61
    v_cvt_pk_bf16_f32 v30, v30, v30
    v_mul_f32 v31, v31, v61
    v_cvt_pk_bf16_f32 v31, v31, v31
    v_and_b32_dpp v36, v16, v8 row_newbcast:14 row_mask:0xf bank_mask:0xf
    v_and_b32_dpp v37, v16, v9 row_newbcast:14 row_mask:0xf bank_mask:0xf
    v_and_b32_dpp v38, v16, v10 row_newbcast:14 row_mask:0xf bank_mask:0xf
    v_and_b32_dpp v39, v16, v11 row_newbcast:14 row_mask:0xf bank_mask:0xf
    v_mfma_f32_16x16x32_bf16 v[40:43], v[172:175], v[32:35], v[40:43]
    v_and_b32_dpp v32, v16, v8 row_newbcast:1 row_mask:0xf bank_mask:0xf
    v_and_b32_dpp v33, v16, v9 row_newbcast:1 row_mask:0xf bank_mask:0xf
    v_and_b32_dpp v34, v16, v10 row_newbcast:1 row_mask:0xf bank_mask:0xf
    v_and_b32_dpp v35, v16, v11 row_newbcast:1 row_mask:0xf bank_mask:0xf
    v_mfma_f32_16x16x32_bf16 v[40:43], v[176:179], v[36:39], v[40:43]
    s_waitcnt vmcnt(4)
    buffer_load_dwordx4 v[200:203], v1, s[48:51], s80 offen offset:1024 nt
    v_and_b32_dpp v36, v16, v8 row_newbcast:9 row_mask:0xf bank_mask:0xf
    v_and_b32_dpp v37, v16, v9 row_newbcast:9 row_mask:0xf bank_mask:0xf
    v_and_b32_dpp v38, v16, v10 row_newbcast:9 row_mask:0xf bank_mask:0xf
    v_and_b32_dpp v39, v16, v11 row_newbcast:9 row_mask:0xf bank_mask:0xf
    v_mfma_f32_16x16x32_bf16 v[40:43], v[180:183], v[32:35], v[40:43]
    s_waitcnt vmcnt(4)
    buffer_load_dwordx4 v[204:207], v1, s[48:51], s80 offen offset:2048 nt
    v_and_b32_dpp v32, v16, v8 row_newbcast:5 row_mask:0xf bank_mask:0xf
    v_and_b32_dpp v33, v16, v9 row_newbcast:5 row_mask:0xf bank_mask:0xf
    v_and_b32_dpp v34, v16, v10 row_newbcast:5 row_mask:0xf bank_mask:0xf
    v_and_b32_dpp v35, v16, v11 row_newbcast:5 row_mask:0xf bank_mask:0xf
    v_mfma_f32_16x16x32_bf16 v[40:43], v[184:187], v[36:39], v[40:43]
    s_waitcnt vmcnt(4)
    buffer_load_dwordx4 v[208:211], v1, s[48:51], s80 offen offset:3072 nt
    v_and_b32_dpp v36, v16, v8 row_newbcast:13 row_mask:0xf bank_mask:0xf
    v_and_b32_dpp v37, v16, v9 row_newbcast:13 row_mask:0xf bank_mask:0xf
    v_and_b32_dpp v38, v16, v10 row_newbcast:13 row_mask:0xf bank_mask:0xf
    v_and_b32_dpp v39, v16, v11 row_newbcast:13 row_mask:0xf bank_mask:0xf
    v_mfma_f32_16x16x32_bf16 v[40:43], v[188:191], v[32:35], v[40:43]
    s_waitcnt vmcnt(4)
    s_add_u32 s81, s6, 65536
    buffer_load_dwordx4 v[212:215], v1, s[48:51], s81 offen offset:0 nt
    v_and_b32_dpp v32, v16, v8 row_newbcast:3 row_mask:0xf bank_mask:0xf
    v_and_b32_dpp v33, v16, v9 row_newbcast:3 row_mask:0xf bank_mask:0xf
    v_and_b32_dpp v34, v16, v10 row_newbcast:3 row_mask:0xf bank_mask:0xf
    v_and_b32_dpp v35, v16, v11 row_newbcast:3 row_mask:0xf bank_mask:0xf
    v_mfma_f32_16x16x32_bf16 v[40:43], v[192:195], v[36:39], v[40:43]
    s_waitcnt vmcnt(4)
    buffer_load_dwordx4 v[216:219], v1, s[48:51], s81 offen offset:1024 nt
    v_and_b32_dpp v36, v16, v8 row_newbcast:11 row_mask:0xf bank_mask:0xf
    v_and_b32_dpp v37, v16, v9 row_newbcast:11 row_mask:0xf bank_mask:0xf
    v_and_b32_dpp v38, v16, v10 row_newbcast:11 row_mask:0xf bank_mask:0xf
    v_and_b32_dpp v39, v16, v11 row_newbcast:11 row_mask:0xf bank_mask:0xf
    v_mfma_f32_16x16x32_bf16 v[40:43], v[196:199], v[32:35], v[40:43]
    s_waitcnt vmcnt(4)
    buffer_load_dwordx4 v[220:223], v1, s[48:51], s81 offen offset:2048 nt
    v_and_b32_dpp v32, v16, v8 row_newbcast:7 row_mask:0xf bank_mask:0xf
    v_and_b32_dpp v33, v16, v9 row_newbcast:7 row_mask:0xf bank_mask:0xf
    v_and_b32_dpp v34, v16, v10 row_newbcast:7 row_mask:0xf bank_mask:0xf
    v_and_b32_dpp v35, v16, v11 row_newbcast:7 row_mask:0xf bank_mask:0xf
    v_mfma_f32_16x16x32_bf16 v[40:43], v[200:203], v[36:39], v[40:43]
    s_waitcnt vmcnt(4)
    buffer_load_dwordx4 v[224:227], v1, s[48:51], s81 offen offset:3072 nt
    v_and_b32_dpp v36, v16, v8 row_newbcast:15 row_mask:0xf bank_mask:0xf
    v_and_b32_dpp v37, v16, v9 row_newbcast:15 row_mask:0xf bank_mask:0xf
    v_and_b32_dpp v38, v16, v10 row_newbcast:15 row_mask:0xf bank_mask:0xf
    v_and_b32_dpp v39, v16, v11 row_newbcast:15 row_mask:0xf bank_mask:0xf
    v_mfma_f32_16x16x32_bf16 v[40:43], v[204:207], v[32:35], v[40:43]
    s_waitcnt vmcnt(4)
    s_add_u32 s82, s6, 81920
    buffer_load_dwordx4 v[228:231], v1, s[48:51], s82 offen offset:0 nt
    v_and_b32_dpp v32, v17, v8 row_newbcast:0 row_mask:0xf bank_mask:0xf
    v_and_b32_dpp v33, v17, v9 row_newbcast:0 row_mask:0xf bank_mask:0xf
    v_and_b32_dpp v34, v17, v10 row_newbcast:0 row_mask:0xf bank_mask:0xf
    v_and_b32_dpp v35, v17, v11 row_newbcast:0 row_mask:0xf bank_mask:0xf
    v_mfma_f32_16x16x32_bf16 v[40:43], v[208:211], v[36:39], v[40:43]
    s_waitcnt vmcnt(4)
    buffer_load_dwordx4 v[232:235], v1, s[48:51], s82 offen offset:1024 nt
    v_and_b32_dpp v36, v17, v8 row_newbcast:8 row_mask:0xf bank_mask:0xf
    v_and_b32_dpp v37, v17, v9 row_newbcast:8 row_mask:0xf bank_mask:0xf
    v_and_b32_dpp v38, v17, v10 row_newbcast:8 row_mask:0xf bank_mask:0xf
    v_and_b32_dpp v39, v17, v11 row_newbcast:8 row_mask:0xf bank_mask:0xf
    v_mfma_f32_16x16x32_bf16 v[40:43], v[212:215], v[32:35], v[40:43]
    s_waitcnt vmcnt(4)
    buffer_load_dwordx4 v[236:239], v1, s[48:51], s82 offen offset:2048 nt
    v_and_b32_dpp v32, v17, v8 row_newbcast:4 row_mask:0xf bank_mask:0xf
    v_and_b32_dpp v33, v17, v9 row_newbcast:4 row_mask:0xf bank_mask:0xf
    v_and_b32_dpp v34, v17, v10 row_newbcast:4 row_mask:0xf bank_mask:0xf
    v_and_b32_dpp v35, v17, v11 row_newbcast:4 row_mask:0xf bank_mask:0xf
    v_mfma_f32_16x16x32_bf16 v[40:43], v[216:219], v[36:39], v[40:43]
    s_waitcnt vmcnt(4)
    buffer_load_dwordx4 v[240:243], v1, s[48:51], s82 offen offset:3072 nt
    v_and_b32_dpp v36, v17, v8 row_newbcast:12 row_mask:0xf bank_mask:0xf
    v_and_b32_dpp v37, v17, v9 row_newbcast:12 row_mask:0xf bank_mask:0xf
    v_and_b32_dpp v38, v17, v10 row_newbcast:12 row_mask:0xf bank_mask:0xf
    v_and_b32_dpp v39, v17, v11 row_newbcast:12 row_mask:0xf bank_mask:0xf
    v_mfma_f32_16x16x32_bf16 v[40:43], v[220:223], v[32:35], v[40:43]
    s_waitcnt vmcnt(4)
    s_add_u32 s83, s6, 98304
    buffer_load_dwordx4 v[244:247], v1, s[48:51], s83 offen offset:0 nt
    v_and_b32_dpp v32, v17, v8 row_newbcast:2 row_mask:0xf bank_mask:0xf
    v_and_b32_dpp v33, v17, v9 row_newbcast:2 row_mask:0xf bank_mask:0xf
    v_and_b32_dpp v34, v17, v10 row_newbcast:2 row_mask:0xf bank_mask:0xf
    v_and_b32_dpp v35, v17, v11 row_newbcast:2 row_mask:0xf bank_mask:0xf
    v_mfma_f32_16x16x32_bf16 v[40:43], v[224:227], v[36:39], v[40:43]
    s_waitcnt vmcnt(4)
    buffer_load_dwordx4 v[248:251], v1, s[48:51], s83 offen offset:1024 nt
    v_and_b32_dpp v36, v17, v8 row_newbcast:10 row_mask:0xf bank_mask:0xf
    v_and_b32_dpp v37, v17, v9 row_newbcast:10 row_mask:0xf bank_mask:0xf
    v_and_b32_dpp v38, v17, v10 row_newbcast:10 row_mask:0xf bank_mask:0xf
    v_and_b32_dpp v39, v17, v11 row_newbcast:10 row_mask:0xf bank_mask:0xf
    v_mfma_f32_16x16x32_bf16 v[40:43], v[228:231], v[32:35], v[40:43]
    s_waitcnt vmcnt(4)
    buffer_load_dwordx4 v[64:67], v1, s[48:51], s83 offen offset:2048 nt
    v_and_b32_dpp v32, v17, v8 row_newbcast:6 row_mask:0xf bank_mask:0xf
    v_and_b32_dpp v33, v17, v9 row_newbcast:6 row_mask:0xf bank_mask:0xf
    v_and_b32_dpp v34, v17, v10 row_newbcast:6 row_mask:0xf bank_mask:0xf
    v_and_b32_dpp v35, v17, v11 row_newbcast:6 row_mask:0xf bank_mask:0xf
    v_mfma_f32_16x16x32_bf16 v[40:43], v[232:235], v[36:39], v[40:43]
    s_waitcnt vmcnt(4)
    buffer_load_dwordx4 v[68:71], v1, s[48:51], s83 offen offset:3072 nt
    v_and_b32_dpp v36, v17, v8 row_newbcast:14 row_mask:0xf bank_mask:0xf
    v_and_b32_dpp v37, v17, v9 row_newbcast:14 row_mask:0xf bank_mask:0xf
    v_and_b32_dpp v38, v17, v10 row_newbcast:14 row_mask:0xf bank_mask:0xf
    v_and_b32_dpp v39, v17, v11 row_newbcast:14 row_mask:0xf bank_mask:0xf
    v_mfma_f32_16x16x32_bf16 v[40:43], v[236:239], v[32:35], v[40:43]
    s_waitcnt vmcnt(4)
    s_add_u32 s84, s6, 114688
    buffer_load_dwordx4 v[72:75], v1, s[48:51], s84 offen offset:0 nt
    v_and_b32_dpp v32, v17, v8 row_newbcast:1 row_mask:0xf bank_mask:0xf
    v_and_b32_dpp v33, v17, v9 row_newbcast:1 row_mask:0xf bank_mask:0xf
    v_and_b32_dpp v34, v17, v10 row_newbcast:1 row_mask:0xf bank_mask:0xf
    v_and_b32_dpp v35, v17, v11 row_newbcast:1 row_mask:0xf bank_mask:0xf
    v_mfma_f32_16x16x32_bf16 v[40:43], v[240:243], v[36:39], v[40:43]
    s_waitcnt vmcnt(4)
    buffer_load_dwordx4 v[76:79], v1, s[48:51], s84 offen offset:1024 nt
    v_and_b32_dpp v36, v17, v8 row_newbcast:9 row_mask:0xf bank_mask:0xf
    v_and_b32_dpp v37, v17, v9 row_newbcast:9 row_mask:0xf bank_mask:0xf
    v_and_b32_dpp v38, v17, v10 row_newbcast:9 row_mask:0xf bank_mask:0xf
    v_and_b32_dpp v39, v17, v11 row_newbcast:9 row_mask:0xf bank_mask:0xf
    v_mfma_f32_16x16x32_bf16 v[40:43], v[244:247], v[32:35], v[40:43]
    s_waitcnt vmcnt(4)
    buffer_load_dwordx4 v[80:83], v1, s[48:51], s84 offen offset:2048 nt
    v_and_b32_dpp v32, v17, v8 row_newbcast:5 row_mask:0xf bank_mask:0xf
    v_and_b32_dpp v33, v17, v9 row_newbcast:5 row_mask:0xf bank_mask:0xf
    v_and_b32_dpp v34, v17, v10 row_newbcast:5 row_mask:0xf bank_mask:0xf
    v_and_b32_dpp v35, v17, v11 row_newbcast:5 row_mask:0xf bank_mask:0xf
    v_mfma_f32_16x16x32_bf16 v[40:43], v[248:251], v[36:39], v[40:43]
    s_waitcnt vmcnt(4)
    buffer_load_dwordx4 v[84:87], v1, s[48:51], s84 offen offset:3072 nt
    v_and_b32_dpp v36, v17, v8 row_newbcast:13 row_mask:0xf bank_mask:0xf
    v_and_b32_dpp v37, v17, v9 row_newbcast:13 row_mask:0xf bank_mask:0xf
    v_and_b32_dpp v38, v17, v10 row_newbcast:13 row_mask:0xf bank_mask:0xf
    v_and_b32_dpp v39, v17, v11 row_newbcast:13 row_mask:0xf bank_mask:0xf
    v_mfma_f32_16x16x32_bf16 v[40:43], v[64:67], v[32:35], v[40:43]
    s_waitcnt vmcnt(4)
    s_add_u32 s85, s6, 131072
    buffer_load_dwordx4 v[88:91], v1, s[48:51], s85 offen offset:0 nt
    v_and_b32_dpp v32, v17, v8 row_newbcast:3 row_mask:0xf bank_mask:0xf
    v_and_b32_dpp v33, v17, v9 row_newbcast:3 row_mask:0xf bank_mask:0xf
    v_and_b32_dpp v34, v17, v10 row_newbcast:3 row_mask:0xf bank_mask:0xf
    v_and_b32_dpp v35, v17, v11 row_newbcast:3 row_mask:0xf bank_mask:0xf
    v_mfma_f32_16x16x32_bf16 v[40:43], v[68:71], v[36:39], v[40:43]
    s_waitcnt vmcnt(4)
    buffer_load_dwordx4 v[92:95], v1, s[48:51], s85 offen offset:1024 nt
    v_and_b32_dpp v36, v17, v8 row_newbcast:11 row_mask:0xf bank_mask:0xf
    v_and_b32_dpp v37, v17, v9 row_newbcast:11 row_mask:0xf bank_mask:0xf
    v_and_b32_dpp v38, v17, v10 row_newbcast:11 row_mask:0xf bank_mask:0xf
    v_and_b32_dpp v39, v17, v11 row_newbcast:11 row_mask:0xf bank_mask:0xf
    v_mfma_f32_16x16x32_bf16 v[40:43], v[72:75], v[32:35], v[40:43]
    s_waitcnt vmcnt(4)
    buffer_load_dwordx4 v[96:99], v1, s[48:51], s85 offen offset:2048 nt
    v_and_b32_dpp v32, v17, v8 row_newbcast:7 row_mask:0xf bank_mask:0xf
    v_and_b32_dpp v33, v17, v9 row_newbcast:7 row_mask:0xf bank_mask:0xf
    v_and_b32_dpp v34, v17, v10 row_newbcast:7 row_mask:0xf bank_mask:0xf
    v_and_b32_dpp v35, v17, v11 row_newbcast:7 row_mask:0xf bank_mask:0xf
    v_mfma_f32_16x16x32_bf16 v[40:43], v[76:79], v[36:39], v[40:43]
    s_waitcnt vmcnt(4)
    buffer_load_dwordx4 v[100:103], v1, s[48:51], s85 offen offset:3072 nt
    v_and_b32_dpp v36, v17, v8 row_newbcast:15 row_mask:0xf bank_mask:0xf
    v_and_b32_dpp v37, v17, v9 row_newbcast:15 row_mask:0xf bank_mask:0xf
    v_and_b32_dpp v38, v17, v10 row_newbcast:15 row_mask:0xf bank_mask:0xf
    v_and_b32_dpp v39, v17, v11 row_newbcast:15 row_mask:0xf bank_mask:0xf
    v_mfma_f32_16x16x32_bf16 v[40:43], v[80:83], v[32:35], v[40:43]
    s_waitcnt vmcnt(4)
    s_add_u32 s86, s6, 147456
    buffer_load_dwordx4 v[104:107], v1, s[48:51], s86 offen offset:0 nt
    v_and_b32_dpp v32, v18, v8 row_newbcast:0 row_mask:0xf bank_mask:0xf
    v_and_b32_dpp v33, v18, v9 row_newbcast:0 row_mask:0xf bank_mask:0xf
    v_and_b32_dpp v34, v18, v10 row_newbcast:0 row_mask:0xf bank_mask:0xf
    v_and_b32_dpp v35, v18, v11 row_newbcast:0 row_mask:0xf bank_mask:0xf
    v_mfma_f32_16x16x32_bf16 v[40:43], v[84:87], v[36:39], v[40:43]
    s_waitcnt vmcnt(4)
    buffer_load_dwordx4 v[108:111], v1, s[48:51], s86 offen offset:1024 nt
    v_and_b32_dpp v36, v18, v8 row_newbcast:8 row_mask:0xf bank_mask:0xf
    v_and_b32_dpp v37, v18, v9 row_newbcast:8 row_mask:0xf bank_mask:0xf
    v_and_b32_dpp v38, v18, v10 row_newbcast:8 row_mask:0xf bank_mask:0xf
    v_and_b32_dpp v39, v18, v11 row_newbcast:8 row_mask:0xf bank_mask:0xf
    v_mfma_f32_16x16x32_bf16 v[40:43], v[88:91], v[32:35], v[40:43]
    s_waitcnt vmcnt(4)
    buffer_load_dwordx4 v[112:115], v1, s[48:51], s86 offen offset:2048 nt
    v_and_b32_dpp v32, v18, v8 row_newbcast:4 row_mask:0xf bank_mask:0xf
    v_and_b32_dpp v33, v18, v9 row_newbcast:4 row_mask:0xf bank_mask:0xf
    v_and_b32_dpp v34, v18, v10 row_newbcast:4 row_mask:0xf bank_mask:0xf
    v_and_b32_dpp v35, v18, v11 row_newbcast:4 row_mask:0xf bank_mask:0xf
    v_mfma_f32_16x16x32_bf16 v[40:43], v[92:95], v[36:39], v[40:43]
    s_waitcnt vmcnt(4)
    buffer_load_dwordx4 v[116:119], v1, s[48:51], s86 offen offset:3072 nt
    v_and_b32_dpp v36, v18, v8 row_newbcast:12 row_mask:0xf bank_mask:0xf
    v_and_b32_dpp v37, v18, v9 row_newbcast:12 row_mask:0xf bank_mask:0xf
    v_and_b32_dpp v38, v18, v10 row_newbcast:12 row_mask:0xf bank_mask:0xf
    v_and_b32_dpp v39, v18, v11 row_newbcast:12 row_mask:0xf bank_mask:0xf
    v_mfma_f32_16x16x32_bf16 v[40:43], v[96:99], v[32:35], v[40:43]
    s_waitcnt vmcnt(4)
    s_add_u32 s87, s6, 163840
    buffer_load_dwordx4 v[120:123], v1, s[48:51], s87 offen offset:0 nt
    v_and_b32_dpp v32, v18, v8 row_newbcast:2 row_mask:0xf bank_mask:0xf
    v_and_b32_dpp v33, v18, v9 row_newbcast:2 row_mask:0xf bank_mask:0xf
    v_and_b32_dpp v34, v18, v10 row_newbcast:2 row_mask:0xf bank_mask:0xf
    v_and_b32_dpp v35, v18, v11 row_newbcast:2 row_mask:0xf bank_mask:0xf
    v_mfma_f32_16x16x32_bf16 v[40:43], v[100:103], v[36:39], v[40:43]
    s_waitcnt vmcnt(4)
    buffer_load_dwordx4 v[124:127], v1, s[48:51], s87 offen offset:1024 nt
    v_and_b32_dpp v36, v18, v8 row_newbcast:10 row_mask:0xf bank_mask:0xf
    v_and_b32_dpp v37, v18, v9 row_newbcast:10 row_mask:0xf bank_mask:0xf
    v_and_b32_dpp v38, v18, v10 row_newbcast:10 row_mask:0xf bank_mask:0xf
    v_and_b32_dpp v39, v18, v11 row_newbcast:10 row_mask:0xf bank_mask:0xf
    v_mfma_f32_16x16x32_bf16 v[40:43], v[104:107], v[32:35], v[40:43]
    s_waitcnt vmcnt(4)
    buffer_load_dwordx4 v[128:131], v1, s[48:51], s87 offen offset:2048 nt
    v_and_b32_dpp v32, v18, v8 row_newbcast:6 row_mask:0xf bank_mask:0xf
    v_and_b32_dpp v33, v18, v9 row_newbcast:6 row_mask:0xf bank_mask:0xf
    v_and_b32_dpp v34, v18, v10 row_newbcast:6 row_mask:0xf bank_mask:0xf
    v_and_b32_dpp v35, v18, v11 row_newbcast:6 row_mask:0xf bank_mask:0xf
    v_mfma_f32_16x16x32_bf16 v[40:43], v[108:111], v[36:39], v[40:43]
    s_waitcnt vmcnt(4)
    buffer_load_dwordx4 v[132:135], v1, s[48:51], s87 offen offset:3072 nt
    v_and_b32_dpp v36, v18, v8 row_newbcast:14 row_mask:0xf bank_mask:0xf
    v_and_b32_dpp v37, v18, v9 row_newbcast:14 row_mask:0xf bank_mask:0xf
    v_and_b32_dpp v38, v18, v10 row_newbcast:14 row_mask:0xf bank_mask:0xf
    v_and_b32_dpp v39, v18, v11 row_newbcast:14 row_mask:0xf bank_mask:0xf
    v_mfma_f32_16x16x32_bf16 v[40:43], v[112:115], v[32:35], v[40:43]
    s_waitcnt vmcnt(4)
    s_add_u32 s88, s6, 180224
    buffer_load_dwordx4 v[136:139], v1, s[48:51], s88 offen offset:0 nt
    v_and_b32_dpp v32, v18, v8 row_newbcast:1 row_mask:0xf bank_mask:0xf
    v_and_b32_dpp v33, v18, v9 row_newbcast:1 row_mask:0xf bank_mask:0xf
    v_and_b32_dpp v34, v18, v10 row_newbcast:1 row_mask:0xf bank_mask:0xf
    v_and_b32_dpp v35, v18, v11 row_newbcast:1 row_mask:0xf bank_mask:0xf
    v_mfma_f32_16x16x32_bf16 v[40:43], v[116:119], v[36:39], v[40:43]
    s_waitcnt vmcnt(4)
    buffer_load_dwordx4 v[140:143], v1, s[48:51], s88 offen offset:1024 nt
    v_and_b32_dpp v36, v18, v8 row_newbcast:9 row_mask:0xf bank_mask:0xf
    v_and_b32_dpp v37, v18, v9 row_newbcast:9 row_mask:0xf bank_mask:0xf
    v_and_b32_dpp v38, v18, v10 row_newbcast:9 row_mask:0xf bank_mask:0xf
    v_and_b32_dpp v39, v18, v11 row_newbcast:9 row_mask:0xf bank_mask:0xf
    v_mfma_f32_16x16x32_bf16 v[40:43], v[120:123], v[32:35], v[40:43]
    s_waitcnt vmcnt(4)
    buffer_load_dwordx4 v[144:147], v1, s[48:51], s88 offen offset:2048 nt
    v_and_b32_dpp v32, v18, v8 row_newbcast:5 row_mask:0xf bank_mask:0xf
    v_and_b32_dpp v33, v18, v9 row_newbcast:5 row_mask:0xf bank_mask:0xf
    v_and_b32_dpp v34, v18, v10 row_newbcast:5 row_mask:0xf bank_mask:0xf
    v_and_b32_dpp v35, v18, v11 row_newbcast:5 row_mask:0xf bank_mask:0xf
    v_mfma_f32_16x16x32_bf16 v[40:43], v[124:127], v[36:39], v[40:43]
    s_waitcnt vmcnt(4)
    buffer_load_dwordx4 v[148:151], v1, s[48:51], s88 offen offset:3072 nt
    v_and_b32_dpp v36, v18, v8 row_newbcast:13 row_mask:0xf bank_mask:0xf
    v_and_b32_dpp v37, v18, v9 row_newbcast:13 row_mask:0xf bank_mask:0xf
    v_and_b32_dpp v38, v18, v10 row_newbcast:13 row_mask:0xf bank_mask:0xf
    v_and_b32_dpp v39, v18, v11 row_newbcast:13 row_mask:0xf bank_mask:0xf
    v_mfma_f32_16x16x32_bf16 v[40:43], v[128:131], v[32:35], v[40:43]
    s_waitcnt vmcnt(4)
    s_add_u32 s89, s6, 196608
    buffer_load_dwordx4 v[152:155], v1, s[48:51], s89 offen offset:0 nt
    v_and_b32_dpp v32, v18, v8 row_newbcast:3 row_mask:0xf bank_mask:0xf
    v_and_b32_dpp v33, v18, v9 row_newbcast:3 row_mask:0xf bank_mask:0xf
    v_and_b32_dpp v34, v18, v10 row_newbcast:3 row_mask:0xf bank_mask:0xf
    v_and_b32_dpp v35, v18, v11 row_newbcast:3 row_mask:0xf bank_mask:0xf
    v_mfma_f32_16x16x32_bf16 v[40:43], v[132:135], v[36:39], v[40:43]
    s_waitcnt vmcnt(4)
    buffer_load_dwordx4 v[156:159], v1, s[48:51], s89 offen offset:1024 nt
    v_and_b32_dpp v36, v18, v8 row_newbcast:11 row_mask:0xf bank_mask:0xf
    v_and_b32_dpp v37, v18, v9 row_newbcast:11 row_mask:0xf bank_mask:0xf
    v_and_b32_dpp v38, v18, v10 row_newbcast:11 row_mask:0xf bank_mask:0xf
    v_and_b32_dpp v39, v18, v11 row_newbcast:11 row_mask:0xf bank_mask:0xf
    v_mfma_f32_16x16x32_bf16 v[40:43], v[136:139], v[32:35], v[40:43]
    s_waitcnt vmcnt(4)
    buffer_load_dwordx4 v[160:163], v1, s[48:51], s89 offen offset:2048 nt
    v_and_b32_dpp v32, v18, v8 row_newbcast:7 row_mask:0xf bank_mask:0xf
    v_and_b32_dpp v33, v18, v9 row_newbcast:7 row_mask:0xf bank_mask:0xf
    v_and_b32_dpp v34, v18, v10 row_newbcast:7 row_mask:0xf bank_mask:0xf
    v_and_b32_dpp v35, v18, v11 row_newbcast:7 row_mask:0xf bank_mask:0xf
    v_mfma_f32_16x16x32_bf16 v[40:43], v[140:143], v[36:39], v[40:43]
    s_waitcnt vmcnt(4)
    buffer_load_dwordx4 v[164:167], v1, s[48:51], s89 offen offset:3072 nt
    v_and_b32_dpp v36, v18, v8 row_newbcast:15 row_mask:0xf bank_mask:0xf
    v_and_b32_dpp v37, v18, v9 row_newbcast:15 row_mask:0xf bank_mask:0xf
    v_and_b32_dpp v38, v18, v10 row_newbcast:15 row_mask:0xf bank_mask:0xf
    v_and_b32_dpp v39, v18, v11 row_newbcast:15 row_mask:0xf bank_mask:0xf
    v_mfma_f32_16x16x32_bf16 v[40:43], v[144:147], v[32:35], v[40:43]
    s_waitcnt vmcnt(4)
    s_add_u32 s90, s6, 212992
    buffer_load_dwordx4 v[168:171], v1, s[48:51], s90 offen offset:0 nt
    v_and_b32_dpp v32, v19, v8 row_newbcast:0 row_mask:0xf bank_mask:0xf
    v_and_b32_dpp v33, v19, v9 row_newbcast:0 row_mask:0xf bank_mask:0xf
    v_and_b32_dpp v34, v19, v10 row_newbcast:0 row_mask:0xf bank_mask:0xf
    v_and_b32_dpp v35, v19, v11 row_newbcast:0 row_mask:0xf bank_mask:0xf
    v_mfma_f32_16x16x32_bf16 v[40:43], v[148:151], v[36:39], v[40:43]
    s_waitcnt vmcnt(4)
    buffer_load_dwordx4 v[172:175], v1, s[48:51], s90 offen offset:1024 nt
    v_and_b32_dpp v36, v19, v8 row_newbcast:8 row_mask:0xf bank_mask:0xf
    v_and_b32_dpp v37, v19, v9 row_newbcast:8 row_mask:0xf bank_mask:0xf
    v_and_b32_dpp v38, v19, v10 row_newbcast:8 row_mask:0xf bank_mask:0xf
    v_and_b32_dpp v39, v19, v11 row_newbcast:8 row_mask:0xf bank_mask:0xf
    v_mfma_f32_16x16x32_bf16 v[40:43], v[152:155], v[32:35], v[40:43]
    s_waitcnt vmcnt(4)
    buffer_load_dwordx4 v[176:179], v1, s[48:51], s90 offen offset:2048 nt
    v_and_b32_dpp v32, v19, v8 row_newbcast:4 row_mask:0xf bank_mask:0xf
    v_and_b32_dpp v33, v19, v9 row_newbcast:4 row_mask:0xf bank_mask:0xf
    v_and_b32_dpp v34, v19, v10 row_newbcast:4 row_mask:0xf bank_mask:0xf
    v_and_b32_dpp v35, v19, v11 row_newbcast:4 row_mask:0xf bank_mask:0xf
    v_mfma_f32_16x16x32_bf16 v[40:43], v[156:159], v[36:39], v[40:43]
    s_waitcnt vmcnt(4)
    buffer_load_dwordx4 v[180:183], v1, s[48:51], s90 offen offset:3072 nt
    v_and_b32_dpp v36, v19, v8 row_newbcast:12 row_mask:0xf bank_mask:0xf
    v_and_b32_dpp v37, v19, v9 row_newbcast:12 row_mask:0xf bank_mask:0xf
    v_and_b32_dpp v38, v19, v10 row_newbcast:12 row_mask:0xf bank_mask:0xf
    v_and_b32_dpp v39, v19, v11 row_newbcast:12 row_mask:0xf bank_mask:0xf
    v_mfma_f32_16x16x32_bf16 v[40:43], v[160:163], v[32:35], v[40:43]
    s_waitcnt vmcnt(4)
    s_add_u32 s91, s6, 229376
    buffer_load_dwordx4 v[184:187], v1, s[48:51], s91 offen offset:0 nt
    v_and_b32_dpp v32, v19, v8 row_newbcast:2 row_mask:0xf bank_mask:0xf
    v_and_b32_dpp v33, v19, v9 row_newbcast:2 row_mask:0xf bank_mask:0xf
    v_and_b32_dpp v34, v19, v10 row_newbcast:2 row_mask:0xf bank_mask:0xf
    v_and_b32_dpp v35, v19, v11 row_newbcast:2 row_mask:0xf bank_mask:0xf
    v_mfma_f32_16x16x32_bf16 v[40:43], v[164:167], v[36:39], v[40:43]
    s_waitcnt vmcnt(4)
    buffer_load_dwordx4 v[188:191], v1, s[48:51], s91 offen offset:1024 nt
    v_and_b32_dpp v36, v19, v8 row_newbcast:10 row_mask:0xf bank_mask:0xf
    v_and_b32_dpp v37, v19, v9 row_newbcast:10 row_mask:0xf bank_mask:0xf
    v_and_b32_dpp v38, v19, v10 row_newbcast:10 row_mask:0xf bank_mask:0xf
    v_and_b32_dpp v39, v19, v11 row_newbcast:10 row_mask:0xf bank_mask:0xf
    v_mfma_f32_16x16x32_bf16 v[40:43], v[168:171], v[32:35], v[40:43]
    s_waitcnt vmcnt(4)
    buffer_load_dwordx4 v[192:195], v1, s[48:51], s91 offen offset:2048 nt
    v_and_b32_dpp v32, v19, v8 row_newbcast:6 row_mask:0xf bank_mask:0xf
    v_and_b32_dpp v33, v19, v9 row_newbcast:6 row_mask:0xf bank_mask:0xf
    v_and_b32_dpp v34, v19, v10 row_newbcast:6 row_mask:0xf bank_mask:0xf
    v_and_b32_dpp v35, v19, v11 row_newbcast:6 row_mask:0xf bank_mask:0xf
    v_mfma_f32_16x16x32_bf16 v[40:43], v[172:175], v[36:39], v[40:43]
    s_waitcnt vmcnt(4)
    buffer_load_dwordx4 v[196:199], v1, s[48:51], s91 offen offset:3072 nt
    v_and_b32_dpp v36, v19, v8 row_newbcast:14 row_mask:0xf bank_mask:0xf
    v_and_b32_dpp v37, v19, v9 row_newbcast:14 row_mask:0xf bank_mask:0xf
    v_and_b32_dpp v38, v19, v10 row_newbcast:14 row_mask:0xf bank_mask:0xf
    v_and_b32_dpp v39, v19, v11 row_newbcast:14 row_mask:0xf bank_mask:0xf
    v_mfma_f32_16x16x32_bf16 v[40:43], v[176:179], v[32:35], v[40:43]
    s_waitcnt vmcnt(4)
    s_add_u32 s76, s6, 245760
    buffer_load_dwordx4 v[200:203], v1, s[48:51], s76 offen offset:0 nt
    v_and_b32_dpp v32, v19, v8 row_newbcast:1 row_mask:0xf bank_mask:0xf
    v_and_b32_dpp v33, v19, v9 row_newbcast:1 row_mask:0xf bank_mask:0xf
    v_and_b32_dpp v34, v19, v10 row_newbcast:1 row_mask:0xf bank_mask:0xf
    v_and_b32_dpp v35, v19, v11 row_newbcast:1 row_mask:0xf bank_mask:0xf
    v_mfma_f32_16x16x32_bf16 v[40:43], v[180:183], v[36:39], v[40:43]
    s_waitcnt vmcnt(4)
    buffer_load_dwordx4 v[204:207], v1, s[48:51], s76 offen offset:1024 nt
    v_and_b32_dpp v36, v19, v8 row_newbcast:9 row_mask:0xf bank_mask:0xf
    v_and_b32_dpp v37, v19, v9 row_newbcast:9 row_mask:0xf bank_mask:0xf
    v_and_b32_dpp v38, v19, v10 row_newbcast:9 row_mask:0xf bank_mask:0xf
    v_and_b32_dpp v39, v19, v11 row_newbcast:9 row_mask:0xf bank_mask:0xf
    v_mfma_f32_16x16x32_bf16 v[40:43], v[184:187], v[32:35], v[40:43]
    s_waitcnt vmcnt(4)
    buffer_load_dwordx4 v[208:211], v1, s[48:51], s76 offen offset:2048 nt
    v_and_b32_dpp v32, v19, v8 row_newbcast:5 row_mask:0xf bank_mask:0xf
    v_and_b32_dpp v33, v19, v9 row_newbcast:5 row_mask:0xf bank_mask:0xf
    v_and_b32_dpp v34, v19, v10 row_newbcast:5 row_mask:0xf bank_mask:0xf
    v_and_b32_dpp v35, v19, v11 row_newbcast:5 row_mask:0xf bank_mask:0xf
    v_mfma_f32_16x16x32_bf16 v[40:43], v[188:191], v[36:39], v[40:43]
    s_waitcnt vmcnt(4)
    buffer_load_dwordx4 v[212:215], v1, s[48:51], s76 offen offset:3072 nt
    v_and_b32_dpp v36, v19, v8 row_newbcast:13 row_mask:0xf bank_mask:0xf
    v_and_b32_dpp v37, v19, v9 row_newbcast:13 row_mask:0xf bank_mask:0xf
    v_and_b32_dpp v38, v19, v10 row_newbcast:13 row_mask:0xf bank_mask:0xf
    v_and_b32_dpp v39, v19, v11 row_newbcast:13 row_mask:0xf bank_mask:0xf
    v_mfma_f32_16x16x32_bf16 v[40:43], v[192:195], v[32:35], v[40:43]
    s_waitcnt vmcnt(4)
    s_add_u32 s77, s6, 262144
    buffer_load_dwordx4 v[216:219], v1, s[48:51], s77 offen offset:0 nt
    v_and_b32_dpp v32, v19, v8 row_newbcast:3 row_mask:0xf bank_mask:0xf
    v_and_b32_dpp v33, v19, v9 row_newbcast:3 row_mask:0xf bank_mask:0xf
    v_and_b32_dpp v34, v19, v10 row_newbcast:3 row_mask:0xf bank_mask:0xf
    v_and_b32_dpp v35, v19, v11 row_newbcast:3 row_mask:0xf bank_mask:0xf
    v_mfma_f32_16x16x32_bf16 v[40:43], v[196:199], v[36:39], v[40:43]
    s_waitcnt vmcnt(4)
    buffer_load_dwordx4 v[220:223], v1, s[48:51], s77 offen offset:1024 nt
    v_and_b32_dpp v36, v19, v8 row_newbcast:11 row_mask:0xf bank_mask:0xf
    v_and_b32_dpp v37, v19, v9 row_newbcast:11 row_mask:0xf bank_mask:0xf
    v_and_b32_dpp v38, v19, v10 row_newbcast:11 row_mask:0xf bank_mask:0xf
    v_and_b32_dpp v39, v19, v11 row_newbcast:11 row_mask:0xf bank_mask:0xf
    v_mfma_f32_16x16x32_bf16 v[40:43], v[200:203], v[32:35], v[40:43]
    s_waitcnt vmcnt(4)
    buffer_load_dwordx4 v[224:227], v1, s[48:51], s77 offen offset:2048 nt
    v_and_b32_dpp v32, v19, v8 row_newbcast:7 row_mask:0xf bank_mask:0xf
    v_and_b32_dpp v33, v19, v9 row_newbcast:7 row_mask:0xf bank_mask:0xf
    v_and_b32_dpp v34, v19, v10 row_newbcast:7 row_mask:0xf bank_mask:0xf
    v_and_b32_dpp v35, v19, v11 row_newbcast:7 row_mask:0xf bank_mask:0xf
    v_mfma_f32_16x16x32_bf16 v[40:43], v[204:207], v[36:39], v[40:43]
    s_waitcnt vmcnt(4)
    buffer_load_dwordx4 v[228:231], v1, s[48:51], s77 offen offset:3072 nt
    v_and_b32_dpp v36, v19, v8 row_newbcast:15 row_mask:0xf bank_mask:0xf
    v_and_b32_dpp v37, v19, v9 row_newbcast:15 row_mask:0xf bank_mask:0xf
    v_and_b32_dpp v38, v19, v10 row_newbcast:15 row_mask:0xf bank_mask:0xf
    v_and_b32_dpp v39, v19, v11 row_newbcast:15 row_mask:0xf bank_mask:0xf
    v_mfma_f32_16x16x32_bf16 v[40:43], v[208:211], v[32:35], v[40:43]
    s_waitcnt vmcnt(4)
    s_add_u32 s78, s6, 278528
    buffer_load_dwordx4 v[232:235], v1, s[48:51], s78 offen offset:0 nt
    v_and_b32_dpp v32, v20, v8 row_newbcast:0 row_mask:0xf bank_mask:0xf
    v_and_b32_dpp v33, v20, v9 row_newbcast:0 row_mask:0xf bank_mask:0xf
    v_and_b32_dpp v34, v20, v10 row_newbcast:0 row_mask:0xf bank_mask:0xf
    v_and_b32_dpp v35, v20, v11 row_newbcast:0 row_mask:0xf bank_mask:0xf
    v_mfma_f32_16x16x32_bf16 v[40:43], v[212:215], v[36:39], v[40:43]
    s_waitcnt vmcnt(4)
    buffer_load_dwordx4 v[236:239], v1, s[48:51], s78 offen offset:1024 nt
    v_and_b32_dpp v36, v20, v8 row_newbcast:8 row_mask:0xf bank_mask:0xf
    v_and_b32_dpp v37, v20, v9 row_newbcast:8 row_mask:0xf bank_mask:0xf
    v_and_b32_dpp v38, v20, v10 row_newbcast:8 row_mask:0xf bank_mask:0xf
    v_and_b32_dpp v39, v20, v11 row_newbcast:8 row_mask:0xf bank_mask:0xf
    v_mfma_f32_16x16x32_bf16 v[40:43], v[216:219], v[32:35], v[40:43]
    s_waitcnt vmcnt(4)
    buffer_load_dwordx4 v[240:243], v1, s[48:51], s78 offen offset:2048 nt
    v_and_b32_dpp v32, v20, v8 row_newbcast:4 row_mask:0xf bank_mask:0xf
    v_and_b32_dpp v33, v20, v9 row_newbcast:4 row_mask:0xf bank_mask:0xf
    v_and_b32_dpp v34, v20, v10 row_newbcast:4 row_mask:0xf bank_mask:0xf
    v_and_b32_dpp v35, v20, v11 row_newbcast:4 row_mask:0xf bank_mask:0xf
    v_mfma_f32_16x16x32_bf16 v[40:43], v[220:223], v[36:39], v[40:43]
    s_waitcnt vmcnt(4)
    buffer_load_dwordx4 v[244:247], v1, s[48:51], s78 offen offset:3072 nt
    v_and_b32_dpp v36, v20, v8 row_newbcast:12 row_mask:0xf bank_mask:0xf
    v_and_b32_dpp v37, v20, v9 row_newbcast:12 row_mask:0xf bank_mask:0xf
    v_and_b32_dpp v38, v20, v10 row_newbcast:12 row_mask:0xf bank_mask:0xf
    v_and_b32_dpp v39, v20, v11 row_newbcast:12 row_mask:0xf bank_mask:0xf
    v_mfma_f32_16x16x32_bf16 v[40:43], v[224:227], v[32:35], v[40:43]
    s_waitcnt vmcnt(4)
    s_add_u32 s79, s6, 294912
    buffer_load_dwordx4 v[248:251], v1, s[48:51], s79 offen offset:0 nt
    v_and_b32_dpp v32, v20, v8 row_newbcast:2 row_mask:0xf bank_mask:0xf
    v_and_b32_dpp v33, v20, v9 row_newbcast:2 row_mask:0xf bank_mask:0xf
    v_and_b32_dpp v34, v20, v10 row_newbcast:2 row_mask:0xf bank_mask:0xf
    v_and_b32_dpp v35, v20, v11 row_newbcast:2 row_mask:0xf bank_mask:0xf
    v_mfma_f32_16x16x32_bf16 v[40:43], v[228:231], v[36:39], v[40:43]
    s_waitcnt vmcnt(4)
    buffer_load_dwordx4 v[64:67], v1, s[48:51], s79 offen offset:1024 nt
    v_and_b32_dpp v36, v20, v8 row_newbcast:10 row_mask:0xf bank_mask:0xf
    v_and_b32_dpp v37, v20, v9 row_newbcast:10 row_mask:0xf bank_mask:0xf
    v_and_b32_dpp v38, v20, v10 row_newbcast:10 row_mask:0xf bank_mask:0xf
    v_and_b32_dpp v39, v20, v11 row_newbcast:10 row_mask:0xf bank_mask:0xf
    v_mfma_f32_16x16x32_bf16 v[40:43], v[232:235], v[32:35], v[40:43]
    s_waitcnt vmcnt(4)
    buffer_load_dwordx4 v[68:71], v1, s[48:51], s79 offen offset:2048 nt
    v_and_b32_dpp v32, v20, v8 row_newbcast:6 row_mask:0xf bank_mask:0xf
    v_and_b32_dpp v33, v20, v9 row_newbcast:6 row_mask:0xf bank_mask:0xf
    v_and_b32_dpp v34, v20, v10 row_newbcast:6 row_mask:0xf bank_mask:0xf
    v_and_b32_dpp v35, v20, v11 row_newbcast:6 row_mask:0xf bank_mask:0xf
    v_mfma_f32_16x16x32_bf16 v[40:43], v[236:239], v[36:39], v[40:43]
    s_waitcnt vmcnt(4)
    buffer_load_dwordx4 v[72:75], v1, s[48:51], s79 offen offset:3072 nt
    v_and_b32_dpp v36, v20, v8 row_newbcast:14 row_mask:0xf bank_mask:0xf
    v_and_b32_dpp v37, v20, v9 row_newbcast:14 row_mask:0xf bank_mask:0xf
    v_and_b32_dpp v38, v20, v10 row_newbcast:14 row_mask:0xf bank_mask:0xf
    v_and_b32_dpp v39, v20, v11 row_newbcast:14 row_mask:0xf bank_mask:0xf
    v_mfma_f32_16x16x32_bf16 v[40:43], v[240:243], v[32:35], v[40:43]
    s_waitcnt vmcnt(4)
    s_add_u32 s80, s6, 311296
    buffer_load_dwordx4 v[76:79], v1, s[48:51], s80 offen offset:0 nt
    v_and_b32_dpp v32, v20, v8 row_newbcast:1 row_mask:0xf bank_mask:0xf
    v_and_b32_dpp v33, v20, v9 row_newbcast:1 row_mask:0xf bank_mask:0xf
    v_and_b32_dpp v34, v20, v10 row_newbcast:1 row_mask:0xf bank_mask:0xf
    v_and_b32_dpp v35, v20, v11 row_newbcast:1 row_mask:0xf bank_mask:0xf
    v_mfma_f32_16x16x32_bf16 v[40:43], v[244:247], v[36:39], v[40:43]
    s_waitcnt vmcnt(4)
    buffer_load_dwordx4 v[80:83], v1, s[48:51], s80 offen offset:1024 nt
    v_and_b32_dpp v36, v20, v8 row_newbcast:9 row_mask:0xf bank_mask:0xf
    v_and_b32_dpp v37, v20, v9 row_newbcast:9 row_mask:0xf bank_mask:0xf
    v_and_b32_dpp v38, v20, v10 row_newbcast:9 row_mask:0xf bank_mask:0xf
    v_and_b32_dpp v39, v20, v11 row_newbcast:9 row_mask:0xf bank_mask:0xf
    v_mfma_f32_16x16x32_bf16 v[40:43], v[248:251], v[32:35], v[40:43]
    s_waitcnt vmcnt(4)
    buffer_load_dwordx4 v[84:87], v1, s[48:51], s80 offen offset:2048 nt
    v_and_b32_dpp v32, v20, v8 row_newbcast:5 row_mask:0xf bank_mask:0xf
    v_and_b32_dpp v33, v20, v9 row_newbcast:5 row_mask:0xf bank_mask:0xf
    v_and_b32_dpp v34, v20, v10 row_newbcast:5 row_mask:0xf bank_mask:0xf
    v_and_b32_dpp v35, v20, v11 row_newbcast:5 row_mask:0xf bank_mask:0xf
    v_mfma_f32_16x16x32_bf16 v[40:43], v[64:67], v[36:39], v[40:43]
    s_waitcnt vmcnt(4)
    buffer_load_dwordx4 v[88:91], v1, s[48:51], s80 offen offset:3072 nt
    v_and_b32_dpp v36, v20, v8 row_newbcast:13 row_mask:0xf bank_mask:0xf
    v_and_b32_dpp v37, v20, v9 row_newbcast:13 row_mask:0xf bank_mask:0xf
    v_and_b32_dpp v38, v20, v10 row_newbcast:13 row_mask:0xf bank_mask:0xf
    v_and_b32_dpp v39, v20, v11 row_newbcast:13 row_mask:0xf bank_mask:0xf
    v_mfma_f32_16x16x32_bf16 v[40:43], v[68:71], v[32:35], v[40:43]
    s_waitcnt vmcnt(4)
    s_add_u32 s81, s6, 327680
    buffer_load_dwordx4 v[92:95], v1, s[48:51], s81 offen offset:0 nt
    v_and_b32_dpp v32, v20, v8 row_newbcast:3 row_mask:0xf bank_mask:0xf
    v_and_b32_dpp v33, v20, v9 row_newbcast:3 row_mask:0xf bank_mask:0xf
    v_and_b32_dpp v34, v20, v10 row_newbcast:3 row_mask:0xf bank_mask:0xf
    v_and_b32_dpp v35, v20, v11 row_newbcast:3 row_mask:0xf bank_mask:0xf
    v_mfma_f32_16x16x32_bf16 v[40:43], v[72:75], v[36:39], v[40:43]
    s_waitcnt vmcnt(4)
    buffer_load_dwordx4 v[96:99], v1, s[48:51], s81 offen offset:1024 nt
    v_and_b32_dpp v36, v20, v8 row_newbcast:11 row_mask:0xf bank_mask:0xf
    v_and_b32_dpp v37, v20, v9 row_newbcast:11 row_mask:0xf bank_mask:0xf
    v_and_b32_dpp v38, v20, v10 row_newbcast:11 row_mask:0xf bank_mask:0xf
    v_and_b32_dpp v39, v20, v11 row_newbcast:11 row_mask:0xf bank_mask:0xf
    v_mfma_f32_16x16x32_bf16 v[40:43], v[76:79], v[32:35], v[40:43]
    s_waitcnt vmcnt(4)
    buffer_load_dwordx4 v[100:103], v1, s[48:51], s81 offen offset:2048 nt
    v_and_b32_dpp v32, v20, v8 row_newbcast:7 row_mask:0xf bank_mask:0xf
    v_and_b32_dpp v33, v20, v9 row_newbcast:7 row_mask:0xf bank_mask:0xf
    v_and_b32_dpp v34, v20, v10 row_newbcast:7 row_mask:0xf bank_mask:0xf
    v_and_b32_dpp v35, v20, v11 row_newbcast:7 row_mask:0xf bank_mask:0xf
    v_mfma_f32_16x16x32_bf16 v[40:43], v[80:83], v[36:39], v[40:43]
    s_waitcnt vmcnt(4)
    buffer_load_dwordx4 v[104:107], v1, s[48:51], s81 offen offset:3072 nt
    v_and_b32_dpp v36, v20, v8 row_newbcast:15 row_mask:0xf bank_mask:0xf
    v_and_b32_dpp v37, v20, v9 row_newbcast:15 row_mask:0xf bank_mask:0xf
    v_and_b32_dpp v38, v20, v10 row_newbcast:15 row_mask:0xf bank_mask:0xf
    v_and_b32_dpp v39, v20, v11 row_newbcast:15 row_mask:0xf bank_mask:0xf
    v_mfma_f32_16x16x32_bf16 v[40:43], v[84:87], v[32:35], v[40:43]
    s_waitcnt vmcnt(4)
    s_add_u32 s82, s6, 344064
    buffer_load_dwordx4 v[108:111], v1, s[48:51], s82 offen offset:0 nt
    v_and_b32_dpp v32, v21, v8 row_newbcast:0 row_mask:0xf bank_mask:0xf
    v_and_b32_dpp v33, v21, v9 row_newbcast:0 row_mask:0xf bank_mask:0xf
    v_and_b32_dpp v34, v21, v10 row_newbcast:0 row_mask:0xf bank_mask:0xf
    v_and_b32_dpp v35, v21, v11 row_newbcast:0 row_mask:0xf bank_mask:0xf
    v_mfma_f32_16x16x32_bf16 v[40:43], v[88:91], v[36:39], v[40:43]
    s_waitcnt vmcnt(4)
    buffer_load_dwordx4 v[112:115], v1, s[48:51], s82 offen offset:1024 nt
    v_and_b32_dpp v36, v21, v8 row_newbcast:8 row_mask:0xf bank_mask:0xf
    v_and_b32_dpp v37, v21, v9 row_newbcast:8 row_mask:0xf bank_mask:0xf
    v_and_b32_dpp v38, v21, v10 row_newbcast:8 row_mask:0xf bank_mask:0xf
    v_and_b32_dpp v39, v21, v11 row_newbcast:8 row_mask:0xf bank_mask:0xf
    v_mfma_f32_16x16x32_bf16 v[40:43], v[92:95], v[32:35], v[40:43]
    s_waitcnt vmcnt(4)
    buffer_load_dwordx4 v[116:119], v1, s[48:51], s82 offen offset:2048 nt
    v_and_b32_dpp v32, v21, v8 row_newbcast:4 row_mask:0xf bank_mask:0xf
    v_and_b32_dpp v33, v21, v9 row_newbcast:4 row_mask:0xf bank_mask:0xf
    v_and_b32_dpp v34, v21, v10 row_newbcast:4 row_mask:0xf bank_mask:0xf
    v_and_b32_dpp v35, v21, v11 row_newbcast:4 row_mask:0xf bank_mask:0xf
    v_mfma_f32_16x16x32_bf16 v[40:43], v[96:99], v[36:39], v[40:43]
    s_waitcnt vmcnt(4)
    buffer_load_dwordx4 v[120:123], v1, s[48:51], s82 offen offset:3072 nt
    v_and_b32_dpp v36, v21, v8 row_newbcast:12 row_mask:0xf bank_mask:0xf
    v_and_b32_dpp v37, v21, v9 row_newbcast:12 row_mask:0xf bank_mask:0xf
    v_and_b32_dpp v38, v21, v10 row_newbcast:12 row_mask:0xf bank_mask:0xf
    v_and_b32_dpp v39, v21, v11 row_newbcast:12 row_mask:0xf bank_mask:0xf
    v_mfma_f32_16x16x32_bf16 v[40:43], v[100:103], v[32:35], v[40:43]
    s_waitcnt vmcnt(4)
    s_add_u32 s83, s6, 360448
    buffer_load_dwordx4 v[124:127], v1, s[48:51], s83 offen offset:0 nt
    v_and_b32_dpp v32, v21, v8 row_newbcast:2 row_mask:0xf bank_mask:0xf
    v_and_b32_dpp v33, v21, v9 row_newbcast:2 row_mask:0xf bank_mask:0xf
    v_and_b32_dpp v34, v21, v10 row_newbcast:2 row_mask:0xf bank_mask:0xf
    v_and_b32_dpp v35, v21, v11 row_newbcast:2 row_mask:0xf bank_mask:0xf
    v_mfma_f32_16x16x32_bf16 v[40:43], v[104:107], v[36:39], v[40:43]
    s_waitcnt vmcnt(4)
    buffer_load_dwordx4 v[128:131], v1, s[48:51], s83 offen offset:1024 nt
    v_and_b32_dpp v36, v21, v8 row_newbcast:10 row_mask:0xf bank_mask:0xf
    v_and_b32_dpp v37, v21, v9 row_newbcast:10 row_mask:0xf bank_mask:0xf
    v_and_b32_dpp v38, v21, v10 row_newbcast:10 row_mask:0xf bank_mask:0xf
    v_and_b32_dpp v39, v21, v11 row_newbcast:10 row_mask:0xf bank_mask:0xf
    v_mfma_f32_16x16x32_bf16 v[40:43], v[108:111], v[32:35], v[40:43]
    s_waitcnt vmcnt(4)
    buffer_load_dwordx4 v[132:135], v1, s[48:51], s83 offen offset:2048 nt
    v_and_b32_dpp v32, v21, v8 row_newbcast:6 row_mask:0xf bank_mask:0xf
    v_and_b32_dpp v33, v21, v9 row_newbcast:6 row_mask:0xf bank_mask:0xf
    v_and_b32_dpp v34, v21, v10 row_newbcast:6 row_mask:0xf bank_mask:0xf
    v_and_b32_dpp v35, v21, v11 row_newbcast:6 row_mask:0xf bank_mask:0xf
    v_mfma_f32_16x16x32_bf16 v[40:43], v[112:115], v[36:39], v[40:43]
    s_waitcnt vmcnt(4)
    buffer_load_dwordx4 v[136:139], v1, s[48:51], s83 offen offset:3072 nt
    v_and_b32_dpp v36, v21, v8 row_newbcast:14 row_mask:0xf bank_mask:0xf
    v_and_b32_dpp v37, v21, v9 row_newbcast:14 row_mask:0xf bank_mask:0xf
    v_and_b32_dpp v38, v21, v10 row_newbcast:14 row_mask:0xf bank_mask:0xf
    v_and_b32_dpp v39, v21, v11 row_newbcast:14 row_mask:0xf bank_mask:0xf
    v_mfma_f32_16x16x32_bf16 v[40:43], v[116:119], v[32:35], v[40:43]
    s_waitcnt vmcnt(4)
    s_add_u32 s84, s6, 376832
    buffer_load_dwordx4 v[140:143], v1, s[48:51], s84 offen offset:0 nt
    v_and_b32_dpp v32, v21, v8 row_newbcast:1 row_mask:0xf bank_mask:0xf
    v_and_b32_dpp v33, v21, v9 row_newbcast:1 row_mask:0xf bank_mask:0xf
    v_and_b32_dpp v34, v21, v10 row_newbcast:1 row_mask:0xf bank_mask:0xf
    v_and_b32_dpp v35, v21, v11 row_newbcast:1 row_mask:0xf bank_mask:0xf
    v_mfma_f32_16x16x32_bf16 v[40:43], v[120:123], v[36:39], v[40:43]
    s_waitcnt vmcnt(4)
    buffer_load_dwordx4 v[144:147], v1, s[48:51], s84 offen offset:1024 nt
    v_and_b32_dpp v36, v21, v8 row_newbcast:9 row_mask:0xf bank_mask:0xf
    v_and_b32_dpp v37, v21, v9 row_newbcast:9 row_mask:0xf bank_mask:0xf
    v_and_b32_dpp v38, v21, v10 row_newbcast:9 row_mask:0xf bank_mask:0xf
    v_and_b32_dpp v39, v21, v11 row_newbcast:9 row_mask:0xf bank_mask:0xf
    v_mfma_f32_16x16x32_bf16 v[40:43], v[124:127], v[32:35], v[40:43]
    s_waitcnt vmcnt(4)
    buffer_load_dwordx4 v[148:151], v1, s[48:51], s84 offen offset:2048 nt
    v_and_b32_dpp v32, v21, v8 row_newbcast:5 row_mask:0xf bank_mask:0xf
    v_and_b32_dpp v33, v21, v9 row_newbcast:5 row_mask:0xf bank_mask:0xf
    v_and_b32_dpp v34, v21, v10 row_newbcast:5 row_mask:0xf bank_mask:0xf
    v_and_b32_dpp v35, v21, v11 row_newbcast:5 row_mask:0xf bank_mask:0xf
    v_mfma_f32_16x16x32_bf16 v[40:43], v[128:131], v[36:39], v[40:43]
    s_waitcnt vmcnt(4)
    buffer_load_dwordx4 v[152:155], v1, s[48:51], s84 offen offset:3072 nt
    v_and_b32_dpp v36, v21, v8 row_newbcast:13 row_mask:0xf bank_mask:0xf
    v_and_b32_dpp v37, v21, v9 row_newbcast:13 row_mask:0xf bank_mask:0xf
    v_and_b32_dpp v38, v21, v10 row_newbcast:13 row_mask:0xf bank_mask:0xf
    v_and_b32_dpp v39, v21, v11 row_newbcast:13 row_mask:0xf bank_mask:0xf
    v_mfma_f32_16x16x32_bf16 v[40:43], v[132:135], v[32:35], v[40:43]
    s_waitcnt vmcnt(4)
    s_add_u32 s85, s6, 393216
    buffer_load_dwordx4 v[156:159], v1, s[48:51], s85 offen offset:0 nt
    v_and_b32_dpp v32, v21, v8 row_newbcast:3 row_mask:0xf bank_mask:0xf
    v_and_b32_dpp v33, v21, v9 row_newbcast:3 row_mask:0xf bank_mask:0xf
    v_and_b32_dpp v34, v21, v10 row_newbcast:3 row_mask:0xf bank_mask:0xf
    v_and_b32_dpp v35, v21, v11 row_newbcast:3 row_mask:0xf bank_mask:0xf
    v_mfma_f32_16x16x32_bf16 v[40:43], v[136:139], v[36:39], v[40:43]
    s_waitcnt vmcnt(4)
    buffer_load_dwordx4 v[160:163], v1, s[48:51], s85 offen offset:1024 nt
    v_and_b32_dpp v36, v21, v8 row_newbcast:11 row_mask:0xf bank_mask:0xf
    v_and_b32_dpp v37, v21, v9 row_newbcast:11 row_mask:0xf bank_mask:0xf
    v_and_b32_dpp v38, v21, v10 row_newbcast:11 row_mask:0xf bank_mask:0xf
    v_and_b32_dpp v39, v21, v11 row_newbcast:11 row_mask:0xf bank_mask:0xf
    v_mfma_f32_16x16x32_bf16 v[40:43], v[140:143], v[32:35], v[40:43]
    s_waitcnt vmcnt(4)
    buffer_load_dwordx4 v[164:167], v1, s[48:51], s85 offen offset:2048 nt
    v_and_b32_dpp v32, v21, v8 row_newbcast:7 row_mask:0xf bank_mask:0xf
    v_and_b32_dpp v33, v21, v9 row_newbcast:7 row_mask:0xf bank_mask:0xf
    v_and_b32_dpp v34, v21, v10 row_newbcast:7 row_mask:0xf bank_mask:0xf
    v_and_b32_dpp v35, v21, v11 row_newbcast:7 row_mask:0xf bank_mask:0xf
    v_mfma_f32_16x16x32_bf16 v[40:43], v[144:147], v[36:39], v[40:43]
    s_waitcnt vmcnt(4)
    buffer_load_dwordx4 v[168:171], v1, s[48:51], s85 offen offset:3072 nt
    v_and_b32_dpp v36, v21, v8 row_newbcast:15 row_mask:0xf bank_mask:0xf
    v_and_b32_dpp v37, v21, v9 row_newbcast:15 row_mask:0xf bank_mask:0xf
    v_and_b32_dpp v38, v21, v10 row_newbcast:15 row_mask:0xf bank_mask:0xf
    v_and_b32_dpp v39, v21, v11 row_newbcast:15 row_mask:0xf bank_mask:0xf
    v_mfma_f32_16x16x32_bf16 v[40:43], v[148:151], v[32:35], v[40:43]
    s_waitcnt vmcnt(4)
    s_add_u32 s86, s6, 409600
    buffer_load_dwordx4 v[172:175], v1, s[48:51], s86 offen offset:0 nt
    v_and_b32_dpp v32, v22, v8 row_newbcast:0 row_mask:0xf bank_mask:0xf
    v_and_b32_dpp v33, v22, v9 row_newbcast:0 row_mask:0xf bank_mask:0xf
    v_and_b32_dpp v34, v22, v10 row_newbcast:0 row_mask:0xf bank_mask:0xf
    v_and_b32_dpp v35, v22, v11 row_newbcast:0 row_mask:0xf bank_mask:0xf
    v_mfma_f32_16x16x32_bf16 v[40:43], v[152:155], v[36:39], v[40:43]
    s_waitcnt vmcnt(4)
    buffer_load_dwordx4 v[176:179], v1, s[48:51], s86 offen offset:1024 nt
    v_and_b32_dpp v36, v22, v8 row_newbcast:8 row_mask:0xf bank_mask:0xf
    v_and_b32_dpp v37, v22, v9 row_newbcast:8 row_mask:0xf bank_mask:0xf
    v_and_b32_dpp v38, v22, v10 row_newbcast:8 row_mask:0xf bank_mask:0xf
    v_and_b32_dpp v39, v22, v11 row_newbcast:8 row_mask:0xf bank_mask:0xf
    v_mfma_f32_16x16x32_bf16 v[40:43], v[156:159], v[32:35], v[40:43]
    s_waitcnt vmcnt(4)
    buffer_load_dwordx4 v[180:183], v1, s[48:51], s86 offen offset:2048 nt
    v_and_b32_dpp v32, v22, v8 row_newbcast:4 row_mask:0xf bank_mask:0xf
    v_and_b32_dpp v33, v22, v9 row_newbcast:4 row_mask:0xf bank_mask:0xf
    v_and_b32_dpp v34, v22, v10 row_newbcast:4 row_mask:0xf bank_mask:0xf
    v_and_b32_dpp v35, v22, v11 row_newbcast:4 row_mask:0xf bank_mask:0xf
    v_mfma_f32_16x16x32_bf16 v[40:43], v[160:163], v[36:39], v[40:43]
    s_waitcnt vmcnt(4)
    buffer_load_dwordx4 v[184:187], v1, s[48:51], s86 offen offset:3072 nt
    v_and_b32_dpp v36, v22, v8 row_newbcast:12 row_mask:0xf bank_mask:0xf
    v_and_b32_dpp v37, v22, v9 row_newbcast:12 row_mask:0xf bank_mask:0xf
    v_and_b32_dpp v38, v22, v10 row_newbcast:12 row_mask:0xf bank_mask:0xf
    v_and_b32_dpp v39, v22, v11 row_newbcast:12 row_mask:0xf bank_mask:0xf
    v_mfma_f32_16x16x32_bf16 v[40:43], v[164:167], v[32:35], v[40:43]
    s_waitcnt vmcnt(4)
    s_add_u32 s87, s6, 425984
    buffer_load_dwordx4 v[188:191], v1, s[48:51], s87 offen offset:0 nt
    v_and_b32_dpp v32, v22, v8 row_newbcast:2 row_mask:0xf bank_mask:0xf
    v_and_b32_dpp v33, v22, v9 row_newbcast:2 row_mask:0xf bank_mask:0xf
    v_and_b32_dpp v34, v22, v10 row_newbcast:2 row_mask:0xf bank_mask:0xf
    v_and_b32_dpp v35, v22, v11 row_newbcast:2 row_mask:0xf bank_mask:0xf
    v_mfma_f32_16x16x32_bf16 v[40:43], v[168:171], v[36:39], v[40:43]
    s_waitcnt vmcnt(4)
    buffer_load_dwordx4 v[192:195], v1, s[48:51], s87 offen offset:1024 nt
    v_and_b32_dpp v36, v22, v8 row_newbcast:10 row_mask:0xf bank_mask:0xf
    v_and_b32_dpp v37, v22, v9 row_newbcast:10 row_mask:0xf bank_mask:0xf
    v_and_b32_dpp v38, v22, v10 row_newbcast:10 row_mask:0xf bank_mask:0xf
    v_and_b32_dpp v39, v22, v11 row_newbcast:10 row_mask:0xf bank_mask:0xf
    v_mfma_f32_16x16x32_bf16 v[40:43], v[172:175], v[32:35], v[40:43]
    s_waitcnt vmcnt(4)
    buffer_load_dwordx4 v[196:199], v1, s[48:51], s87 offen offset:2048 nt
    v_and_b32_dpp v32, v22, v8 row_newbcast:6 row_mask:0xf bank_mask:0xf
    v_and_b32_dpp v33, v22, v9 row_newbcast:6 row_mask:0xf bank_mask:0xf
    v_and_b32_dpp v34, v22, v10 row_newbcast:6 row_mask:0xf bank_mask:0xf
    v_and_b32_dpp v35, v22, v11 row_newbcast:6 row_mask:0xf bank_mask:0xf
    v_mfma_f32_16x16x32_bf16 v[40:43], v[176:179], v[36:39], v[40:43]
    s_waitcnt vmcnt(4)
    buffer_load_dwordx4 v[200:203], v1, s[48:51], s87 offen offset:3072 nt
    v_and_b32_dpp v36, v22, v8 row_newbcast:14 row_mask:0xf bank_mask:0xf
    v_and_b32_dpp v37, v22, v9 row_newbcast:14 row_mask:0xf bank_mask:0xf
    v_and_b32_dpp v38, v22, v10 row_newbcast:14 row_mask:0xf bank_mask:0xf
    v_and_b32_dpp v39, v22, v11 row_newbcast:14 row_mask:0xf bank_mask:0xf
    v_mfma_f32_16x16x32_bf16 v[40:43], v[180:183], v[32:35], v[40:43]
    s_waitcnt vmcnt(4)
    s_add_u32 s88, s6, 442368
    buffer_load_dwordx4 v[204:207], v1, s[48:51], s88 offen offset:0 nt
    v_and_b32_dpp v32, v22, v8 row_newbcast:1 row_mask:0xf bank_mask:0xf
    v_and_b32_dpp v33, v22, v9 row_newbcast:1 row_mask:0xf bank_mask:0xf
    v_and_b32_dpp v34, v22, v10 row_newbcast:1 row_mask:0xf bank_mask:0xf
    v_and_b32_dpp v35, v22, v11 row_newbcast:1 row_mask:0xf bank_mask:0xf
    v_mfma_f32_16x16x32_bf16 v[40:43], v[184:187], v[36:39], v[40:43]
    s_waitcnt vmcnt(4)
    buffer_load_dwordx4 v[208:211], v1, s[48:51], s88 offen offset:1024 nt
    v_and_b32_dpp v36, v22, v8 row_newbcast:9 row_mask:0xf bank_mask:0xf
    v_and_b32_dpp v37, v22, v9 row_newbcast:9 row_mask:0xf bank_mask:0xf
    v_and_b32_dpp v38, v22, v10 row_newbcast:9 row_mask:0xf bank_mask:0xf
    v_and_b32_dpp v39, v22, v11 row_newbcast:9 row_mask:0xf bank_mask:0xf
    v_mfma_f32_16x16x32_bf16 v[40:43], v[188:191], v[32:35], v[40:43]
    s_waitcnt vmcnt(4)
    buffer_load_dwordx4 v[212:215], v1, s[48:51], s88 offen offset:2048 nt
    v_and_b32_dpp v32, v22, v8 row_newbcast:5 row_mask:0xf bank_mask:0xf
    v_and_b32_dpp v33, v22, v9 row_newbcast:5 row_mask:0xf bank_mask:0xf
    v_and_b32_dpp v34, v22, v10 row_newbcast:5 row_mask:0xf bank_mask:0xf
    v_and_b32_dpp v35, v22, v11 row_newbcast:5 row_mask:0xf bank_mask:0xf
    v_mfma_f32_16x16x32_bf16 v[40:43], v[192:195], v[36:39], v[40:43]
    s_waitcnt vmcnt(4)
    buffer_load_dwordx4 v[216:219], v1, s[48:51], s88 offen offset:3072 nt
    v_and_b32_dpp v36, v22, v8 row_newbcast:13 row_mask:0xf bank_mask:0xf
    v_and_b32_dpp v37, v22, v9 row_newbcast:13 row_mask:0xf bank_mask:0xf
    v_and_b32_dpp v38, v22, v10 row_newbcast:13 row_mask:0xf bank_mask:0xf
    v_and_b32_dpp v39, v22, v11 row_newbcast:13 row_mask:0xf bank_mask:0xf
    v_mfma_f32_16x16x32_bf16 v[40:43], v[196:199], v[32:35], v[40:43]
    s_waitcnt vmcnt(4)
    s_add_u32 s89, s6, 458752
    buffer_load_dwordx4 v[220:223], v1, s[48:51], s89 offen offset:0 nt
    v_and_b32_dpp v32, v22, v8 row_newbcast:3 row_mask:0xf bank_mask:0xf
    v_and_b32_dpp v33, v22, v9 row_newbcast:3 row_mask:0xf bank_mask:0xf
    v_and_b32_dpp v34, v22, v10 row_newbcast:3 row_mask:0xf bank_mask:0xf
    v_and_b32_dpp v35, v22, v11 row_newbcast:3 row_mask:0xf bank_mask:0xf
    v_mfma_f32_16x16x32_bf16 v[40:43], v[200:203], v[36:39], v[40:43]
    s_waitcnt vmcnt(4)
    buffer_load_dwordx4 v[224:227], v1, s[48:51], s89 offen offset:1024 nt
    v_and_b32_dpp v36, v22, v8 row_newbcast:11 row_mask:0xf bank_mask:0xf
    v_and_b32_dpp v37, v22, v9 row_newbcast:11 row_mask:0xf bank_mask:0xf
    v_and_b32_dpp v38, v22, v10 row_newbcast:11 row_mask:0xf bank_mask:0xf
    v_and_b32_dpp v39, v22, v11 row_newbcast:11 row_mask:0xf bank_mask:0xf
    v_mfma_f32_16x16x32_bf16 v[40:43], v[204:207], v[32:35], v[40:43]
    s_waitcnt vmcnt(4)
    buffer_load_dwordx4 v[228:231], v1, s[48:51], s89 offen offset:2048 nt
    v_and_b32_dpp v32, v22, v8 row_newbcast:7 row_mask:0xf bank_mask:0xf
    v_and_b32_dpp v33, v22, v9 row_newbcast:7 row_mask:0xf bank_mask:0xf
    v_and_b32_dpp v34, v22, v10 row_newbcast:7 row_mask:0xf bank_mask:0xf
    v_and_b32_dpp v35, v22, v11 row_newbcast:7 row_mask:0xf bank_mask:0xf
    v_mfma_f32_16x16x32_bf16 v[40:43], v[208:211], v[36:39], v[40:43]
    s_waitcnt vmcnt(4)
    buffer_load_dwordx4 v[232:235], v1, s[48:51], s89 offen offset:3072 nt
    v_and_b32_dpp v36, v22, v8 row_newbcast:15 row_mask:0xf bank_mask:0xf
    v_and_b32_dpp v37, v22, v9 row_newbcast:15 row_mask:0xf bank_mask:0xf
    v_and_b32_dpp v38, v22, v10 row_newbcast:15 row_mask:0xf bank_mask:0xf
    v_and_b32_dpp v39, v22, v11 row_newbcast:15 row_mask:0xf bank_mask:0xf
    v_mfma_f32_16x16x32_bf16 v[40:43], v[212:215], v[32:35], v[40:43]
    s_waitcnt vmcnt(4)
    s_add_u32 s90, s6, 475136
    buffer_load_dwordx4 v[236:239], v1, s[48:51], s90 offen offset:0 nt
    v_and_b32_dpp v32, v23, v8 row_newbcast:0 row_mask:0xf bank_mask:0xf
    v_and_b32_dpp v33, v23, v9 row_newbcast:0 row_mask:0xf bank_mask:0xf
    v_and_b32_dpp v34, v23, v10 row_newbcast:0 row_mask:0xf bank_mask:0xf
    v_and_b32_dpp v35, v23, v11 row_newbcast:0 row_mask:0xf bank_mask:0xf
    v_mfma_f32_16x16x32_bf16 v[40:43], v[216:219], v[36:39], v[40:43]
    s_waitcnt vmcnt(4)
    buffer_load_dwordx4 v[240:243], v1, s[48:51], s90 offen offset:1024 nt
    v_and_b32_dpp v36, v23, v8 row_newbcast:8 row_mask:0xf bank_mask:0xf
    v_and_b32_dpp v37, v23, v9 row_newbcast:8 row_mask:0xf bank_mask:0xf
    v_and_b32_dpp v38, v23, v10 row_newbcast:8 row_mask:0xf bank_mask:0xf
    v_and_b32_dpp v39, v23, v11 row_newbcast:8 row_mask:0xf bank_mask:0xf
    v_mfma_f32_16x16x32_bf16 v[40:43], v[220:223], v[32:35], v[40:43]
    s_waitcnt vmcnt(4)
    buffer_load_dwordx4 v[244:247], v1, s[48:51], s90 offen offset:2048 nt
    v_and_b32_dpp v32, v23, v8 row_newbcast:4 row_mask:0xf bank_mask:0xf
    v_and_b32_dpp v33, v23, v9 row_newbcast:4 row_mask:0xf bank_mask:0xf
    v_and_b32_dpp v34, v23, v10 row_newbcast:4 row_mask:0xf bank_mask:0xf
    v_and_b32_dpp v35, v23, v11 row_newbcast:4 row_mask:0xf bank_mask:0xf
    v_mfma_f32_16x16x32_bf16 v[40:43], v[224:227], v[36:39], v[40:43]
    s_waitcnt vmcnt(4)
    buffer_load_dwordx4 v[248:251], v1, s[48:51], s90 offen offset:3072 nt
    v_and_b32_dpp v36, v23, v8 row_newbcast:12 row_mask:0xf bank_mask:0xf
    v_and_b32_dpp v37, v23, v9 row_newbcast:12 row_mask:0xf bank_mask:0xf
    v_and_b32_dpp v38, v23, v10 row_newbcast:12 row_mask:0xf bank_mask:0xf
    v_and_b32_dpp v39, v23, v11 row_newbcast:12 row_mask:0xf bank_mask:0xf
    v_mfma_f32_16x16x32_bf16 v[40:43], v[228:231], v[32:35], v[40:43]
    s_waitcnt vmcnt(4)
    s_add_u32 s91, s6, 491520
    buffer_load_dwordx4 v[64:67], v1, s[48:51], s91 offen offset:0 nt
    v_and_b32_dpp v32, v23, v8 row_newbcast:2 row_mask:0xf bank_mask:0xf
    v_and_b32_dpp v33, v23, v9 row_newbcast:2 row_mask:0xf bank_mask:0xf
    v_and_b32_dpp v34, v23, v10 row_newbcast:2 row_mask:0xf bank_mask:0xf
    v_and_b32_dpp v35, v23, v11 row_newbcast:2 row_mask:0xf bank_mask:0xf
    v_mfma_f32_16x16x32_bf16 v[40:43], v[232:235], v[36:39], v[40:43]
    s_waitcnt vmcnt(4)
    buffer_load_dwordx4 v[68:71], v1, s[48:51], s91 offen offset:1024 nt
    v_and_b32_dpp v36, v23, v8 row_newbcast:10 row_mask:0xf bank_mask:0xf
    v_and_b32_dpp v37, v23, v9 row_newbcast:10 row_mask:0xf bank_mask:0xf
    v_and_b32_dpp v38, v23, v10 row_newbcast:10 row_mask:0xf bank_mask:0xf
    v_and_b32_dpp v39, v23, v11 row_newbcast:10 row_mask:0xf bank_mask:0xf
    v_mfma_f32_16x16x32_bf16 v[40:43], v[236:239], v[32:35], v[40:43]
    s_waitcnt vmcnt(4)
    buffer_load_dwordx4 v[72:75], v1, s[48:51], s91 offen offset:2048 nt
    v_and_b32_dpp v32, v23, v8 row_newbcast:6 row_mask:0xf bank_mask:0xf
    v_and_b32_dpp v33, v23, v9 row_newbcast:6 row_mask:0xf bank_mask:0xf
    v_and_b32_dpp v34, v23, v10 row_newbcast:6 row_mask:0xf bank_mask:0xf
    v_and_b32_dpp v35, v23, v11 row_newbcast:6 row_mask:0xf bank_mask:0xf
    v_mfma_f32_16x16x32_bf16 v[40:43], v[240:243], v[36:39], v[40:43]
    s_waitcnt vmcnt(4)
    buffer_load_dwordx4 v[76:79], v1, s[48:51], s91 offen offset:3072 nt
    v_and_b32_dpp v36, v23, v8 row_newbcast:14 row_mask:0xf bank_mask:0xf
    v_and_b32_dpp v37, v23, v9 row_newbcast:14 row_mask:0xf bank_mask:0xf
    v_and_b32_dpp v38, v23, v10 row_newbcast:14 row_mask:0xf bank_mask:0xf
    v_and_b32_dpp v39, v23, v11 row_newbcast:14 row_mask:0xf bank_mask:0xf
    v_mfma_f32_16x16x32_bf16 v[40:43], v[244:247], v[32:35], v[40:43]
    s_waitcnt vmcnt(4)
    s_add_u32 s76, s6, 507904
    buffer_load_dwordx4 v[80:83], v1, s[48:51], s76 offen offset:0 nt
    v_and_b32_dpp v32, v23, v8 row_newbcast:1 row_mask:0xf bank_mask:0xf
    v_and_b32_dpp v33, v23, v9 row_newbcast:1 row_mask:0xf bank_mask:0xf
    v_and_b32_dpp v34, v23, v10 row_newbcast:1 row_mask:0xf bank_mask:0xf
    v_and_b32_dpp v35, v23, v11 row_newbcast:1 row_mask:0xf bank_mask:0xf
    v_mfma_f32_16x16x32_bf16 v[40:43], v[248:251], v[36:39], v[40:43]
    s_waitcnt vmcnt(4)
    buffer_load_dwordx4 v[84:87], v1, s[48:51], s76 offen offset:1024 nt
    v_and_b32_dpp v36, v23, v8 row_newbcast:9 row_mask:0xf bank_mask:0xf
    v_and_b32_dpp v37, v23, v9 row_newbcast:9 row_mask:0xf bank_mask:0xf
    v_and_b32_dpp v38, v23, v10 row_newbcast:9 row_mask:0xf bank_mask:0xf
    v_and_b32_dpp v39, v23, v11 row_newbcast:9 row_mask:0xf bank_mask:0xf
    v_mfma_f32_16x16x32_bf16 v[40:43], v[64:67], v[32:35], v[40:43]
    s_waitcnt vmcnt(4)
    buffer_load_dwordx4 v[88:91], v1, s[48:51], s76 offen offset:2048 nt
    v_and_b32_dpp v32, v23, v8 row_newbcast:5 row_mask:0xf bank_mask:0xf
    v_and_b32_dpp v33, v23, v9 row_newbcast:5 row_mask:0xf bank_mask:0xf
    v_and_b32_dpp v34, v23, v10 row_newbcast:5 row_mask:0xf bank_mask:0xf
    v_and_b32_dpp v35, v23, v11 row_newbcast:5 row_mask:0xf bank_mask:0xf
    v_mfma_f32_16x16x32_bf16 v[40:43], v[68:71], v[36:39], v[40:43]
    s_waitcnt vmcnt(4)
    buffer_load_dwordx4 v[92:95], v1, s[48:51], s76 offen offset:3072 nt
    v_and_b32_dpp v36, v23, v8 row_newbcast:13 row_mask:0xf bank_mask:0xf
    v_and_b32_dpp v37, v23, v9 row_newbcast:13 row_mask:0xf bank_mask:0xf
    v_and_b32_dpp v38, v23, v10 row_newbcast:13 row_mask:0xf bank_mask:0xf
    v_and_b32_dpp v39, v23, v11 row_newbcast:13 row_mask:0xf bank_mask:0xf
    v_mfma_f32_16x16x32_bf16 v[40:43], v[72:75], v[32:35], v[40:43]
    s_waitcnt vmcnt(4)
    s_add_u32 s77, s6, 524288
    buffer_load_dwordx4 v[96:99], v1, s[48:51], s77 offen offset:0 nt
    v_and_b32_dpp v32, v23, v8 row_newbcast:3 row_mask:0xf bank_mask:0xf
    v_and_b32_dpp v33, v23, v9 row_newbcast:3 row_mask:0xf bank_mask:0xf
    v_and_b32_dpp v34, v23, v10 row_newbcast:3 row_mask:0xf bank_mask:0xf
    v_and_b32_dpp v35, v23, v11 row_newbcast:3 row_mask:0xf bank_mask:0xf
    v_mfma_f32_16x16x32_bf16 v[40:43], v[76:79], v[36:39], v[40:43]
    s_waitcnt vmcnt(4)
    buffer_load_dwordx4 v[100:103], v1, s[48:51], s77 offen offset:1024 nt
    v_and_b32_dpp v36, v23, v8 row_newbcast:11 row_mask:0xf bank_mask:0xf
    v_and_b32_dpp v37, v23, v9 row_newbcast:11 row_mask:0xf bank_mask:0xf
    v_and_b32_dpp v38, v23, v10 row_newbcast:11 row_mask:0xf bank_mask:0xf
    v_and_b32_dpp v39, v23, v11 row_newbcast:11 row_mask:0xf bank_mask:0xf
    v_mfma_f32_16x16x32_bf16 v[40:43], v[80:83], v[32:35], v[40:43]
    s_waitcnt vmcnt(4)
    buffer_load_dwordx4 v[104:107], v1, s[48:51], s77 offen offset:2048 nt
    v_and_b32_dpp v32, v23, v8 row_newbcast:7 row_mask:0xf bank_mask:0xf
    v_and_b32_dpp v33, v23, v9 row_newbcast:7 row_mask:0xf bank_mask:0xf
    v_and_b32_dpp v34, v23, v10 row_newbcast:7 row_mask:0xf bank_mask:0xf
    v_and_b32_dpp v35, v23, v11 row_newbcast:7 row_mask:0xf bank_mask:0xf
    v_mfma_f32_16x16x32_bf16 v[40:43], v[84:87], v[36:39], v[40:43]
    s_waitcnt vmcnt(4)
    buffer_load_dwordx4 v[108:111], v1, s[48:51], s77 offen offset:3072 nt
    v_and_b32_dpp v36, v23, v8 row_newbcast:15 row_mask:0xf bank_mask:0xf
    v_and_b32_dpp v37, v23, v9 row_newbcast:15 row_mask:0xf bank_mask:0xf
    v_and_b32_dpp v38, v23, v10 row_newbcast:15 row_mask:0xf bank_mask:0xf
    v_and_b32_dpp v39, v23, v11 row_newbcast:15 row_mask:0xf bank_mask:0xf
    v_mfma_f32_16x16x32_bf16 v[40:43], v[88:91], v[32:35], v[40:43]
    s_waitcnt vmcnt(4)
    s_add_u32 s78, s6, 540672
    buffer_load_dwordx4 v[112:115], v1, s[48:51], s78 offen offset:0 nt
    v_and_b32_dpp v32, v24, v8 row_newbcast:0 row_mask:0xf bank_mask:0xf
    v_and_b32_dpp v33, v24, v9 row_newbcast:0 row_mask:0xf bank_mask:0xf
    v_and_b32_dpp v34, v24, v10 row_newbcast:0 row_mask:0xf bank_mask:0xf
    v_and_b32_dpp v35, v24, v11 row_newbcast:0 row_mask:0xf bank_mask:0xf
    v_mfma_f32_16x16x32_bf16 v[40:43], v[92:95], v[36:39], v[40:43]
    s_waitcnt vmcnt(4)
    buffer_load_dwordx4 v[116:119], v1, s[48:51], s78 offen offset:1024 nt
    v_and_b32_dpp v36, v24, v8 row_newbcast:8 row_mask:0xf bank_mask:0xf
    v_and_b32_dpp v37, v24, v9 row_newbcast:8 row_mask:0xf bank_mask:0xf
    v_and_b32_dpp v38, v24, v10 row_newbcast:8 row_mask:0xf bank_mask:0xf
    v_and_b32_dpp v39, v24, v11 row_newbcast:8 row_mask:0xf bank_mask:0xf
    v_mfma_f32_16x16x32_bf16 v[40:43], v[96:99], v[32:35], v[40:43]
    s_waitcnt vmcnt(4)
    buffer_load_dwordx4 v[120:123], v1, s[48:51], s78 offen offset:2048 nt
    v_and_b32_dpp v32, v24, v8 row_newbcast:4 row_mask:0xf bank_mask:0xf
    v_and_b32_dpp v33, v24, v9 row_newbcast:4 row_mask:0xf bank_mask:0xf
    v_and_b32_dpp v34, v24, v10 row_newbcast:4 row_mask:0xf bank_mask:0xf
    v_and_b32_dpp v35, v24, v11 row_newbcast:4 row_mask:0xf bank_mask:0xf
    v_mfma_f32_16x16x32_bf16 v[40:43], v[100:103], v[36:39], v[40:43]
    s_waitcnt vmcnt(4)
    buffer_load_dwordx4 v[124:127], v1, s[48:51], s78 offen offset:3072 nt
    v_and_b32_dpp v36, v24, v8 row_newbcast:12 row_mask:0xf bank_mask:0xf
    v_and_b32_dpp v37, v24, v9 row_newbcast:12 row_mask:0xf bank_mask:0xf
    v_and_b32_dpp v38, v24, v10 row_newbcast:12 row_mask:0xf bank_mask:0xf
    v_and_b32_dpp v39, v24, v11 row_newbcast:12 row_mask:0xf bank_mask:0xf
    v_mfma_f32_16x16x32_bf16 v[40:43], v[104:107], v[32:35], v[40:43]
    s_waitcnt vmcnt(4)
    s_add_u32 s79, s6, 557056
    buffer_load_dwordx4 v[128:131], v1, s[48:51], s79 offen offset:0 nt
    v_and_b32_dpp v32, v24, v8 row_newbcast:2 row_mask:0xf bank_mask:0xf
    v_and_b32_dpp v33, v24, v9 row_newbcast:2 row_mask:0xf bank_mask:0xf
    v_and_b32_dpp v34, v24, v10 row_newbcast:2 row_mask:0xf bank_mask:0xf
    v_and_b32_dpp v35, v24, v11 row_newbcast:2 row_mask:0xf bank_mask:0xf
    v_mfma_f32_16x16x32_bf16 v[40:43], v[108:111], v[36:39], v[40:43]
    s_waitcnt vmcnt(4)
    buffer_load_dwordx4 v[132:135], v1, s[48:51], s79 offen offset:1024 nt
    v_and_b32_dpp v36, v24, v8 row_newbcast:10 row_mask:0xf bank_mask:0xf
    v_and_b32_dpp v37, v24, v9 row_newbcast:10 row_mask:0xf bank_mask:0xf
    v_and_b32_dpp v38, v24, v10 row_newbcast:10 row_mask:0xf bank_mask:0xf
    v_and_b32_dpp v39, v24, v11 row_newbcast:10 row_mask:0xf bank_mask:0xf
    v_mfma_f32_16x16x32_bf16 v[40:43], v[112:115], v[32:35], v[40:43]
    s_waitcnt vmcnt(4)
    buffer_load_dwordx4 v[136:139], v1, s[48:51], s79 offen offset:2048 nt
    v_and_b32_dpp v32, v24, v8 row_newbcast:6 row_mask:0xf bank_mask:0xf
    v_and_b32_dpp v33, v24, v9 row_newbcast:6 row_mask:0xf bank_mask:0xf
    v_and_b32_dpp v34, v24, v10 row_newbcast:6 row_mask:0xf bank_mask:0xf
    v_and_b32_dpp v35, v24, v11 row_newbcast:6 row_mask:0xf bank_mask:0xf
    v_mfma_f32_16x16x32_bf16 v[40:43], v[116:119], v[36:39], v[40:43]
    s_waitcnt vmcnt(4)
    buffer_load_dwordx4 v[140:143], v1, s[48:51], s79 offen offset:3072 nt
    v_and_b32_dpp v36, v24, v8 row_newbcast:14 row_mask:0xf bank_mask:0xf
    v_and_b32_dpp v37, v24, v9 row_newbcast:14 row_mask:0xf bank_mask:0xf
    v_and_b32_dpp v38, v24, v10 row_newbcast:14 row_mask:0xf bank_mask:0xf
    v_and_b32_dpp v39, v24, v11 row_newbcast:14 row_mask:0xf bank_mask:0xf
    v_mfma_f32_16x16x32_bf16 v[40:43], v[120:123], v[32:35], v[40:43]
    s_waitcnt vmcnt(4)
    s_add_u32 s80, s6, 573440
    buffer_load_dwordx4 v[144:147], v1, s[48:51], s80 offen offset:0 nt
    v_and_b32_dpp v32, v24, v8 row_newbcast:1 row_mask:0xf bank_mask:0xf
    v_and_b32_dpp v33, v24, v9 row_newbcast:1 row_mask:0xf bank_mask:0xf
    v_and_b32_dpp v34, v24, v10 row_newbcast:1 row_mask:0xf bank_mask:0xf
    v_and_b32_dpp v35, v24, v11 row_newbcast:1 row_mask:0xf bank_mask:0xf
    v_mfma_f32_16x16x32_bf16 v[40:43], v[124:127], v[36:39], v[40:43]
    s_waitcnt vmcnt(4)
    buffer_load_dwordx4 v[148:151], v1, s[48:51], s80 offen offset:1024 nt
    v_and_b32_dpp v36, v24, v8 row_newbcast:9 row_mask:0xf bank_mask:0xf
    v_and_b32_dpp v37, v24, v9 row_newbcast:9 row_mask:0xf bank_mask:0xf
    v_and_b32_dpp v38, v24, v10 row_newbcast:9 row_mask:0xf bank_mask:0xf
    v_and_b32_dpp v39, v24, v11 row_newbcast:9 row_mask:0xf bank_mask:0xf
    v_mfma_f32_16x16x32_bf16 v[40:43], v[128:131], v[32:35], v[40:43]
    s_waitcnt vmcnt(4)
    buffer_load_dwordx4 v[152:155], v1, s[48:51], s80 offen offset:2048 nt
    v_and_b32_dpp v32, v24, v8 row_newbcast:5 row_mask:0xf bank_mask:0xf
    v_and_b32_dpp v33, v24, v9 row_newbcast:5 row_mask:0xf bank_mask:0xf
    v_and_b32_dpp v34, v24, v10 row_newbcast:5 row_mask:0xf bank_mask:0xf
    v_and_b32_dpp v35, v24, v11 row_newbcast:5 row_mask:0xf bank_mask:0xf
    v_mfma_f32_16x16x32_bf16 v[40:43], v[132:135], v[36:39], v[40:43]
    s_waitcnt vmcnt(4)
    buffer_load_dwordx4 v[156:159], v1, s[48:51], s80 offen offset:3072 nt
    v_and_b32_dpp v36, v24, v8 row_newbcast:13 row_mask:0xf bank_mask:0xf
    v_and_b32_dpp v37, v24, v9 row_newbcast:13 row_mask:0xf bank_mask:0xf
    v_and_b32_dpp v38, v24, v10 row_newbcast:13 row_mask:0xf bank_mask:0xf
    v_and_b32_dpp v39, v24, v11 row_newbcast:13 row_mask:0xf bank_mask:0xf
    v_mfma_f32_16x16x32_bf16 v[40:43], v[136:139], v[32:35], v[40:43]
    s_waitcnt vmcnt(4)
    s_add_u32 s81, s6, 589824
    buffer_load_dwordx4 v[160:163], v1, s[48:51], s81 offen offset:0 nt
    v_and_b32_dpp v32, v24, v8 row_newbcast:3 row_mask:0xf bank_mask:0xf
    v_and_b32_dpp v33, v24, v9 row_newbcast:3 row_mask:0xf bank_mask:0xf
    v_and_b32_dpp v34, v24, v10 row_newbcast:3 row_mask:0xf bank_mask:0xf
    v_and_b32_dpp v35, v24, v11 row_newbcast:3 row_mask:0xf bank_mask:0xf
    v_mfma_f32_16x16x32_bf16 v[40:43], v[140:143], v[36:39], v[40:43]
    s_waitcnt vmcnt(4)
    buffer_load_dwordx4 v[164:167], v1, s[48:51], s81 offen offset:1024 nt
    v_and_b32_dpp v36, v24, v8 row_newbcast:11 row_mask:0xf bank_mask:0xf
    v_and_b32_dpp v37, v24, v9 row_newbcast:11 row_mask:0xf bank_mask:0xf
    v_and_b32_dpp v38, v24, v10 row_newbcast:11 row_mask:0xf bank_mask:0xf
    v_and_b32_dpp v39, v24, v11 row_newbcast:11 row_mask:0xf bank_mask:0xf
    v_mfma_f32_16x16x32_bf16 v[40:43], v[144:147], v[32:35], v[40:43]
    s_waitcnt vmcnt(4)
    buffer_load_dwordx4 v[168:171], v1, s[48:51], s81 offen offset:2048 nt
    v_and_b32_dpp v32, v24, v8 row_newbcast:7 row_mask:0xf bank_mask:0xf
    v_and_b32_dpp v33, v24, v9 row_newbcast:7 row_mask:0xf bank_mask:0xf
    v_and_b32_dpp v34, v24, v10 row_newbcast:7 row_mask:0xf bank_mask:0xf
    v_and_b32_dpp v35, v24, v11 row_newbcast:7 row_mask:0xf bank_mask:0xf
    v_mfma_f32_16x16x32_bf16 v[40:43], v[148:151], v[36:39], v[40:43]
    s_waitcnt vmcnt(4)
    buffer_load_dwordx4 v[172:175], v1, s[48:51], s81 offen offset:3072 nt
    v_and_b32_dpp v36, v24, v8 row_newbcast:15 row_mask:0xf bank_mask:0xf
    v_and_b32_dpp v37, v24, v9 row_newbcast:15 row_mask:0xf bank_mask:0xf
    v_and_b32_dpp v38, v24, v10 row_newbcast:15 row_mask:0xf bank_mask:0xf
    v_and_b32_dpp v39, v24, v11 row_newbcast:15 row_mask:0xf bank_mask:0xf
    v_mfma_f32_16x16x32_bf16 v[40:43], v[152:155], v[32:35], v[40:43]
    s_waitcnt vmcnt(4)
    s_add_u32 s82, s6, 606208
    buffer_load_dwordx4 v[176:179], v1, s[48:51], s82 offen offset:0 nt
    v_and_b32_dpp v32, v25, v8 row_newbcast:0 row_mask:0xf bank_mask:0xf
    v_and_b32_dpp v33, v25, v9 row_newbcast:0 row_mask:0xf bank_mask:0xf
    v_and_b32_dpp v34, v25, v10 row_newbcast:0 row_mask:0xf bank_mask:0xf
    v_and_b32_dpp v35, v25, v11 row_newbcast:0 row_mask:0xf bank_mask:0xf
    v_mfma_f32_16x16x32_bf16 v[40:43], v[156:159], v[36:39], v[40:43]
    s_waitcnt vmcnt(4)
    buffer_load_dwordx4 v[180:183], v1, s[48:51], s82 offen offset:1024 nt
    v_and_b32_dpp v36, v25, v8 row_newbcast:8 row_mask:0xf bank_mask:0xf
    v_and_b32_dpp v37, v25, v9 row_newbcast:8 row_mask:0xf bank_mask:0xf
    v_and_b32_dpp v38, v25, v10 row_newbcast:8 row_mask:0xf bank_mask:0xf
    v_and_b32_dpp v39, v25, v11 row_newbcast:8 row_mask:0xf bank_mask:0xf
    v_mfma_f32_16x16x32_bf16 v[40:43], v[160:163], v[32:35], v[40:43]
    s_waitcnt vmcnt(4)
    buffer_load_dwordx4 v[184:187], v1, s[48:51], s82 offen offset:2048 nt
    v_and_b32_dpp v32, v25, v8 row_newbcast:4 row_mask:0xf bank_mask:0xf
    v_and_b32_dpp v33, v25, v9 row_newbcast:4 row_mask:0xf bank_mask:0xf
    v_and_b32_dpp v34, v25, v10 row_newbcast:4 row_mask:0xf bank_mask:0xf
    v_and_b32_dpp v35, v25, v11 row_newbcast:4 row_mask:0xf bank_mask:0xf
    v_mfma_f32_16x16x32_bf16 v[40:43], v[164:167], v[36:39], v[40:43]
    s_waitcnt vmcnt(4)
    buffer_load_dwordx4 v[188:191], v1, s[48:51], s82 offen offset:3072 nt
    v_and_b32_dpp v36, v25, v8 row_newbcast:12 row_mask:0xf bank_mask:0xf
    v_and_b32_dpp v37, v25, v9 row_newbcast:12 row_mask:0xf bank_mask:0xf
    v_and_b32_dpp v38, v25, v10 row_newbcast:12 row_mask:0xf bank_mask:0xf
    v_and_b32_dpp v39, v25, v11 row_newbcast:12 row_mask:0xf bank_mask:0xf
    v_mfma_f32_16x16x32_bf16 v[40:43], v[168:171], v[32:35], v[40:43]
    s_waitcnt vmcnt(4)
    s_add_u32 s83, s6, 622592
    buffer_load_dwordx4 v[192:195], v1, s[48:51], s83 offen offset:0 nt
    v_and_b32_dpp v32, v25, v8 row_newbcast:2 row_mask:0xf bank_mask:0xf
    v_and_b32_dpp v33, v25, v9 row_newbcast:2 row_mask:0xf bank_mask:0xf
    v_and_b32_dpp v34, v25, v10 row_newbcast:2 row_mask:0xf bank_mask:0xf
    v_and_b32_dpp v35, v25, v11 row_newbcast:2 row_mask:0xf bank_mask:0xf
    v_mfma_f32_16x16x32_bf16 v[40:43], v[172:175], v[36:39], v[40:43]
    s_waitcnt vmcnt(4)
    buffer_load_dwordx4 v[196:199], v1, s[48:51], s83 offen offset:1024 nt
    v_and_b32_dpp v36, v25, v8 row_newbcast:10 row_mask:0xf bank_mask:0xf
    v_and_b32_dpp v37, v25, v9 row_newbcast:10 row_mask:0xf bank_mask:0xf
    v_and_b32_dpp v38, v25, v10 row_newbcast:10 row_mask:0xf bank_mask:0xf
    v_and_b32_dpp v39, v25, v11 row_newbcast:10 row_mask:0xf bank_mask:0xf
    v_mfma_f32_16x16x32_bf16 v[40:43], v[176:179], v[32:35], v[40:43]
    s_waitcnt vmcnt(4)
    buffer_load_dwordx4 v[200:203], v1, s[48:51], s83 offen offset:2048 nt
    v_and_b32_dpp v32, v25, v8 row_newbcast:6 row_mask:0xf bank_mask:0xf
    v_and_b32_dpp v33, v25, v9 row_newbcast:6 row_mask:0xf bank_mask:0xf
    v_and_b32_dpp v34, v25, v10 row_newbcast:6 row_mask:0xf bank_mask:0xf
    v_and_b32_dpp v35, v25, v11 row_newbcast:6 row_mask:0xf bank_mask:0xf
    v_mfma_f32_16x16x32_bf16 v[40:43], v[180:183], v[36:39], v[40:43]
    s_waitcnt vmcnt(4)
    buffer_load_dwordx4 v[204:207], v1, s[48:51], s83 offen offset:3072 nt
    v_and_b32_dpp v36, v25, v8 row_newbcast:14 row_mask:0xf bank_mask:0xf
    v_and_b32_dpp v37, v25, v9 row_newbcast:14 row_mask:0xf bank_mask:0xf
    v_and_b32_dpp v38, v25, v10 row_newbcast:14 row_mask:0xf bank_mask:0xf
    v_and_b32_dpp v39, v25, v11 row_newbcast:14 row_mask:0xf bank_mask:0xf
    v_mfma_f32_16x16x32_bf16 v[40:43], v[184:187], v[32:35], v[40:43]
    s_waitcnt vmcnt(4)
    s_add_u32 s84, s6, 638976
    buffer_load_dwordx4 v[208:211], v1, s[48:51], s84 offen offset:0 nt
    v_and_b32_dpp v32, v25, v8 row_newbcast:1 row_mask:0xf bank_mask:0xf
    v_and_b32_dpp v33, v25, v9 row_newbcast:1 row_mask:0xf bank_mask:0xf
    v_and_b32_dpp v34, v25, v10 row_newbcast:1 row_mask:0xf bank_mask:0xf
    v_and_b32_dpp v35, v25, v11 row_newbcast:1 row_mask:0xf bank_mask:0xf
    v_mfma_f32_16x16x32_bf16 v[40:43], v[188:191], v[36:39], v[40:43]
    s_waitcnt vmcnt(4)
    buffer_load_dwordx4 v[212:215], v1, s[48:51], s84 offen offset:1024 nt
    v_and_b32_dpp v36, v25, v8 row_newbcast:9 row_mask:0xf bank_mask:0xf
    v_and_b32_dpp v37, v25, v9 row_newbcast:9 row_mask:0xf bank_mask:0xf
    v_and_b32_dpp v38, v25, v10 row_newbcast:9 row_mask:0xf bank_mask:0xf
    v_and_b32_dpp v39, v25, v11 row_newbcast:9 row_mask:0xf bank_mask:0xf
    v_mfma_f32_16x16x32_bf16 v[40:43], v[192:195], v[32:35], v[40:43]
    s_waitcnt vmcnt(4)
    buffer_load_dwordx4 v[216:219], v1, s[48:51], s84 offen offset:2048 nt
    v_and_b32_dpp v32, v25, v8 row_newbcast:5 row_mask:0xf bank_mask:0xf
    v_and_b32_dpp v33, v25, v9 row_newbcast:5 row_mask:0xf bank_mask:0xf
    v_and_b32_dpp v34, v25, v10 row_newbcast:5 row_mask:0xf bank_mask:0xf
    v_and_b32_dpp v35, v25, v11 row_newbcast:5 row_mask:0xf bank_mask:0xf
    v_mfma_f32_16x16x32_bf16 v[40:43], v[196:199], v[36:39], v[40:43]
    s_waitcnt vmcnt(4)
    buffer_load_dwordx4 v[220:223], v1, s[48:51], s84 offen offset:3072 nt
    v_and_b32_dpp v36, v25, v8 row_newbcast:13 row_mask:0xf bank_mask:0xf
    v_and_b32_dpp v37, v25, v9 row_newbcast:13 row_mask:0xf bank_mask:0xf
    v_and_b32_dpp v38, v25, v10 row_newbcast:13 row_mask:0xf bank_mask:0xf
    v_and_b32_dpp v39, v25, v11 row_newbcast:13 row_mask:0xf bank_mask:0xf
    v_mfma_f32_16x16x32_bf16 v[40:43], v[200:203], v[32:35], v[40:43]
    s_waitcnt vmcnt(4)
    s_add_u32 s85, s6, 655360
    buffer_load_dwordx4 v[224:227], v1, s[48:51], s85 offen offset:0 nt
    v_and_b32_dpp v32, v25, v8 row_newbcast:3 row_mask:0xf bank_mask:0xf
    v_and_b32_dpp v33, v25, v9 row_newbcast:3 row_mask:0xf bank_mask:0xf
    v_and_b32_dpp v34, v25, v10 row_newbcast:3 row_mask:0xf bank_mask:0xf
    v_and_b32_dpp v35, v25, v11 row_newbcast:3 row_mask:0xf bank_mask:0xf
    v_mfma_f32_16x16x32_bf16 v[40:43], v[204:207], v[36:39], v[40:43]
    s_waitcnt vmcnt(4)
    buffer_load_dwordx4 v[228:231], v1, s[48:51], s85 offen offset:1024 nt
    v_and_b32_dpp v36, v25, v8 row_newbcast:11 row_mask:0xf bank_mask:0xf
    v_and_b32_dpp v37, v25, v9 row_newbcast:11 row_mask:0xf bank_mask:0xf
    v_and_b32_dpp v38, v25, v10 row_newbcast:11 row_mask:0xf bank_mask:0xf
    v_and_b32_dpp v39, v25, v11 row_newbcast:11 row_mask:0xf bank_mask:0xf
    v_mfma_f32_16x16x32_bf16 v[40:43], v[208:211], v[32:35], v[40:43]
    s_waitcnt vmcnt(4)
    buffer_load_dwordx4 v[232:235], v1, s[48:51], s85 offen offset:2048 nt
    v_and_b32_dpp v32, v25, v8 row_newbcast:7 row_mask:0xf bank_mask:0xf
    v_and_b32_dpp v33, v25, v9 row_newbcast:7 row_mask:0xf bank_mask:0xf
    v_and_b32_dpp v34, v25, v10 row_newbcast:7 row_mask:0xf bank_mask:0xf
    v_and_b32_dpp v35, v25, v11 row_newbcast:7 row_mask:0xf bank_mask:0xf
    v_mfma_f32_16x16x32_bf16 v[40:43], v[212:215], v[36:39], v[40:43]
    s_waitcnt vmcnt(4)
    buffer_load_dwordx4 v[236:239], v1, s[48:51], s85 offen offset:3072 nt
    v_and_b32_dpp v36, v25, v8 row_newbcast:15 row_mask:0xf bank_mask:0xf
    v_and_b32_dpp v37, v25, v9 row_newbcast:15 row_mask:0xf bank_mask:0xf
    v_and_b32_dpp v38, v25, v10 row_newbcast:15 row_mask:0xf bank_mask:0xf
    v_and_b32_dpp v39, v25, v11 row_newbcast:15 row_mask:0xf bank_mask:0xf
    v_mfma_f32_16x16x32_bf16 v[40:43], v[216:219], v[32:35], v[40:43]
    s_waitcnt vmcnt(4)
    s_add_u32 s86, s6, 671744
    buffer_load_dwordx4 v[240:243], v1, s[48:51], s86 offen offset:0 nt
    v_and_b32_dpp v32, v26, v8 row_newbcast:0 row_mask:0xf bank_mask:0xf
    v_and_b32_dpp v33, v26, v9 row_newbcast:0 row_mask:0xf bank_mask:0xf
    v_and_b32_dpp v34, v26, v10 row_newbcast:0 row_mask:0xf bank_mask:0xf
    v_and_b32_dpp v35, v26, v11 row_newbcast:0 row_mask:0xf bank_mask:0xf
    v_mfma_f32_16x16x32_bf16 v[40:43], v[220:223], v[36:39], v[40:43]
    s_waitcnt vmcnt(4)
    buffer_load_dwordx4 v[244:247], v1, s[48:51], s86 offen offset:1024 nt
    v_and_b32_dpp v36, v26, v8 row_newbcast:8 row_mask:0xf bank_mask:0xf
    v_and_b32_dpp v37, v26, v9 row_newbcast:8 row_mask:0xf bank_mask:0xf
    v_and_b32_dpp v38, v26, v10 row_newbcast:8 row_mask:0xf bank_mask:0xf
    v_and_b32_dpp v39, v26, v11 row_newbcast:8 row_mask:0xf bank_mask:0xf
    v_mfma_f32_16x16x32_bf16 v[40:43], v[224:227], v[32:35], v[40:43]
    s_waitcnt vmcnt(4)
    buffer_load_dwordx4 v[248:251], v1, s[48:51], s86 offen offset:2048 nt
    v_and_b32_dpp v32, v26, v8 row_newbcast:4 row_mask:0xf bank_mask:0xf
    v_and_b32_dpp v33, v26, v9 row_newbcast:4 row_mask:0xf bank_mask:0xf
    v_and_b32_dpp v34, v26, v10 row_newbcast:4 row_mask:0xf bank_mask:0xf
    v_and_b32_dpp v35, v26, v11 row_newbcast:4 row_mask:0xf bank_mask:0xf
    v_mfma_f32_16x16x32_bf16 v[40:43], v[228:231], v[36:39], v[40:43]
    s_waitcnt vmcnt(4)
    buffer_load_dwordx4 v[64:67], v1, s[48:51], s86 offen offset:3072 nt
    v_and_b32_dpp v36, v26, v8 row_newbcast:12 row_mask:0xf bank_mask:0xf
    v_and_b32_dpp v37, v26, v9 row_newbcast:12 row_mask:0xf bank_mask:0xf
    v_and_b32_dpp v38, v26, v10 row_newbcast:12 row_mask:0xf bank_mask:0xf
    v_and_b32_dpp v39, v26, v11 row_newbcast:12 row_mask:0xf bank_mask:0xf
    v_mfma_f32_16x16x32_bf16 v[40:43], v[232:235], v[32:35], v[40:43]
    s_waitcnt vmcnt(4)
    s_add_u32 s87, s6, 688128
    buffer_load_dwordx4 v[68:71], v1, s[48:51], s87 offen offset:0 nt
    v_and_b32_dpp v32, v26, v8 row_newbcast:2 row_mask:0xf bank_mask:0xf
    v_and_b32_dpp v33, v26, v9 row_newbcast:2 row_mask:0xf bank_mask:0xf
    v_and_b32_dpp v34, v26, v10 row_newbcast:2 row_mask:0xf bank_mask:0xf
    v_and_b32_dpp v35, v26, v11 row_newbcast:2 row_mask:0xf bank_mask:0xf
    v_mfma_f32_16x16x32_bf16 v[40:43], v[236:239], v[36:39], v[40:43]
    s_waitcnt vmcnt(4)
    buffer_load_dwordx4 v[72:75], v1, s[48:51], s87 offen offset:1024 nt
    v_and_b32_dpp v36, v26, v8 row_newbcast:10 row_mask:0xf bank_mask:0xf
    v_and_b32_dpp v37, v26, v9 row_newbcast:10 row_mask:0xf bank_mask:0xf
    v_and_b32_dpp v38, v26, v10 row_newbcast:10 row_mask:0xf bank_mask:0xf
    v_and_b32_dpp v39, v26, v11 row_newbcast:10 row_mask:0xf bank_mask:0xf
    v_mfma_f32_16x16x32_bf16 v[40:43], v[240:243], v[32:35], v[40:43]
    s_waitcnt vmcnt(4)
    buffer_load_dwordx4 v[76:79], v1, s[48:51], s87 offen offset:2048 nt
    v_and_b32_dpp v32, v26, v8 row_newbcast:6 row_mask:0xf bank_mask:0xf
    v_and_b32_dpp v33, v26, v9 row_newbcast:6 row_mask:0xf bank_mask:0xf
    v_and_b32_dpp v34, v26, v10 row_newbcast:6 row_mask:0xf bank_mask:0xf
    v_and_b32_dpp v35, v26, v11 row_newbcast:6 row_mask:0xf bank_mask:0xf
    v_mfma_f32_16x16x32_bf16 v[40:43], v[244:247], v[36:39], v[40:43]
    s_waitcnt vmcnt(4)
    buffer_load_dwordx4 v[80:83], v1, s[48:51], s87 offen offset:3072 nt
    v_and_b32_dpp v36, v26, v8 row_newbcast:14 row_mask:0xf bank_mask:0xf
    v_and_b32_dpp v37, v26, v9 row_newbcast:14 row_mask:0xf bank_mask:0xf
    v_and_b32_dpp v38, v26, v10 row_newbcast:14 row_mask:0xf bank_mask:0xf
    v_and_b32_dpp v39, v26, v11 row_newbcast:14 row_mask:0xf bank_mask:0xf
    v_mfma_f32_16x16x32_bf16 v[40:43], v[248:251], v[32:35], v[40:43]
    s_waitcnt vmcnt(4)
    s_add_u32 s88, s6, 704512
    buffer_load_dwordx4 v[84:87], v1, s[48:51], s88 offen offset:0 nt
    v_and_b32_dpp v32, v26, v8 row_newbcast:1 row_mask:0xf bank_mask:0xf
    v_and_b32_dpp v33, v26, v9 row_newbcast:1 row_mask:0xf bank_mask:0xf
    v_and_b32_dpp v34, v26, v10 row_newbcast:1 row_mask:0xf bank_mask:0xf
    v_and_b32_dpp v35, v26, v11 row_newbcast:1 row_mask:0xf bank_mask:0xf
    v_mfma_f32_16x16x32_bf16 v[40:43], v[64:67], v[36:39], v[40:43]
    s_waitcnt vmcnt(4)
    buffer_load_dwordx4 v[88:91], v1, s[48:51], s88 offen offset:1024 nt
    v_and_b32_dpp v36, v26, v8 row_newbcast:9 row_mask:0xf bank_mask:0xf
    v_and_b32_dpp v37, v26, v9 row_newbcast:9 row_mask:0xf bank_mask:0xf
    v_and_b32_dpp v38, v26, v10 row_newbcast:9 row_mask:0xf bank_mask:0xf
    v_and_b32_dpp v39, v26, v11 row_newbcast:9 row_mask:0xf bank_mask:0xf
    v_mfma_f32_16x16x32_bf16 v[40:43], v[68:71], v[32:35], v[40:43]
    s_waitcnt vmcnt(4)
    buffer_load_dwordx4 v[92:95], v1, s[48:51], s88 offen offset:2048 nt
    v_and_b32_dpp v32, v26, v8 row_newbcast:5 row_mask:0xf bank_mask:0xf
    v_and_b32_dpp v33, v26, v9 row_newbcast:5 row_mask:0xf bank_mask:0xf
    v_and_b32_dpp v34, v26, v10 row_newbcast:5 row_mask:0xf bank_mask:0xf
    v_and_b32_dpp v35, v26, v11 row_newbcast:5 row_mask:0xf bank_mask:0xf
    v_mfma_f32_16x16x32_bf16 v[40:43], v[72:75], v[36:39], v[40:43]
    s_waitcnt vmcnt(4)
    buffer_load_dwordx4 v[96:99], v1, s[48:51], s88 offen offset:3072 nt
    v_and_b32_dpp v36, v26, v8 row_newbcast:13 row_mask:0xf bank_mask:0xf
    v_and_b32_dpp v37, v26, v9 row_newbcast:13 row_mask:0xf bank_mask:0xf
    v_and_b32_dpp v38, v26, v10 row_newbcast:13 row_mask:0xf bank_mask:0xf
    v_and_b32_dpp v39, v26, v11 row_newbcast:13 row_mask:0xf bank_mask:0xf
    v_mfma_f32_16x16x32_bf16 v[40:43], v[76:79], v[32:35], v[40:43]
    s_waitcnt vmcnt(4)
    s_add_u32 s89, s6, 720896
    buffer_load_dwordx4 v[100:103], v1, s[48:51], s89 offen offset:0 nt
    v_and_b32_dpp v32, v26, v8 row_newbcast:3 row_mask:0xf bank_mask:0xf
    v_and_b32_dpp v33, v26, v9 row_newbcast:3 row_mask:0xf bank_mask:0xf
    v_and_b32_dpp v34, v26, v10 row_newbcast:3 row_mask:0xf bank_mask:0xf
    v_and_b32_dpp v35, v26, v11 row_newbcast:3 row_mask:0xf bank_mask:0xf
    v_mfma_f32_16x16x32_bf16 v[40:43], v[80:83], v[36:39], v[40:43]
    s_waitcnt vmcnt(4)
    buffer_load_dwordx4 v[104:107], v1, s[48:51], s89 offen offset:1024 nt
    v_and_b32_dpp v36, v26, v8 row_newbcast:11 row_mask:0xf bank_mask:0xf
    v_and_b32_dpp v37, v26, v9 row_newbcast:11 row_mask:0xf bank_mask:0xf
    v_and_b32_dpp v38, v26, v10 row_newbcast:11 row_mask:0xf bank_mask:0xf
    v_and_b32_dpp v39, v26, v11 row_newbcast:11 row_mask:0xf bank_mask:0xf
    v_mfma_f32_16x16x32_bf16 v[40:43], v[84:87], v[32:35], v[40:43]
    s_waitcnt vmcnt(4)
    buffer_load_dwordx4 v[108:111], v1, s[48:51], s89 offen offset:2048 nt
    v_and_b32_dpp v32, v26, v8 row_newbcast:7 row_mask:0xf bank_mask:0xf
    v_and_b32_dpp v33, v26, v9 row_newbcast:7 row_mask:0xf bank_mask:0xf
    v_and_b32_dpp v34, v26, v10 row_newbcast:7 row_mask:0xf bank_mask:0xf
    v_and_b32_dpp v35, v26, v11 row_newbcast:7 row_mask:0xf bank_mask:0xf
    v_mfma_f32_16x16x32_bf16 v[40:43], v[88:91], v[36:39], v[40:43]
    s_waitcnt vmcnt(4)
    buffer_load_dwordx4 v[112:115], v1, s[48:51], s89 offen offset:3072 nt
    v_and_b32_dpp v36, v26, v8 row_newbcast:15 row_mask:0xf bank_mask:0xf
    v_and_b32_dpp v37, v26, v9 row_newbcast:15 row_mask:0xf bank_mask:0xf
    v_and_b32_dpp v38, v26, v10 row_newbcast:15 row_mask:0xf bank_mask:0xf
    v_and_b32_dpp v39, v26, v11 row_newbcast:15 row_mask:0xf bank_mask:0xf
    v_mfma_f32_16x16x32_bf16 v[40:43], v[92:95], v[32:35], v[40:43]
    s_waitcnt vmcnt(4)
    s_add_u32 s90, s6, 737280
    buffer_load_dwordx4 v[116:119], v1, s[48:51], s90 offen offset:0 nt
    v_and_b32_dpp v32, v27, v8 row_newbcast:0 row_mask:0xf bank_mask:0xf
    v_and_b32_dpp v33, v27, v9 row_newbcast:0 row_mask:0xf bank_mask:0xf
    v_and_b32_dpp v34, v27, v10 row_newbcast:0 row_mask:0xf bank_mask:0xf
    v_and_b32_dpp v35, v27, v11 row_newbcast:0 row_mask:0xf bank_mask:0xf
    v_mfma_f32_16x16x32_bf16 v[40:43], v[96:99], v[36:39], v[40:43]
    s_waitcnt vmcnt(4)
    buffer_load_dwordx4 v[120:123], v1, s[48:51], s90 offen offset:1024 nt
    v_and_b32_dpp v36, v27, v8 row_newbcast:8 row_mask:0xf bank_mask:0xf
    v_and_b32_dpp v37, v27, v9 row_newbcast:8 row_mask:0xf bank_mask:0xf
    v_and_b32_dpp v38, v27, v10 row_newbcast:8 row_mask:0xf bank_mask:0xf
    v_and_b32_dpp v39, v27, v11 row_newbcast:8 row_mask:0xf bank_mask:0xf
    v_mfma_f32_16x16x32_bf16 v[40:43], v[100:103], v[32:35], v[40:43]
    s_waitcnt vmcnt(4)
    buffer_load_dwordx4 v[124:127], v1, s[48:51], s90 offen offset:2048 nt
    v_and_b32_dpp v32, v27, v8 row_newbcast:4 row_mask:0xf bank_mask:0xf
    v_and_b32_dpp v33, v27, v9 row_newbcast:4 row_mask:0xf bank_mask:0xf
    v_and_b32_dpp v34, v27, v10 row_newbcast:4 row_mask:0xf bank_mask:0xf
    v_and_b32_dpp v35, v27, v11 row_newbcast:4 row_mask:0xf bank_mask:0xf
    v_mfma_f32_16x16x32_bf16 v[40:43], v[104:107], v[36:39], v[40:43]
    s_waitcnt vmcnt(4)
    buffer_load_dwordx4 v[128:131], v1, s[48:51], s90 offen offset:3072 nt
    v_and_b32_dpp v36, v27, v8 row_newbcast:12 row_mask:0xf bank_mask:0xf
    v_and_b32_dpp v37, v27, v9 row_newbcast:12 row_mask:0xf bank_mask:0xf
    v_and_b32_dpp v38, v27, v10 row_newbcast:12 row_mask:0xf bank_mask:0xf
    v_and_b32_dpp v39, v27, v11 row_newbcast:12 row_mask:0xf bank_mask:0xf
    v_mfma_f32_16x16x32_bf16 v[40:43], v[108:111], v[32:35], v[40:43]
    s_waitcnt vmcnt(4)
    s_add_u32 s91, s6, 753664
    buffer_load_dwordx4 v[132:135], v1, s[48:51], s91 offen offset:0 nt
    v_and_b32_dpp v32, v27, v8 row_newbcast:2 row_mask:0xf bank_mask:0xf
    v_and_b32_dpp v33, v27, v9 row_newbcast:2 row_mask:0xf bank_mask:0xf
    v_and_b32_dpp v34, v27, v10 row_newbcast:2 row_mask:0xf bank_mask:0xf
    v_and_b32_dpp v35, v27, v11 row_newbcast:2 row_mask:0xf bank_mask:0xf
    v_mfma_f32_16x16x32_bf16 v[40:43], v[112:115], v[36:39], v[40:43]
    s_waitcnt vmcnt(4)
    buffer_load_dwordx4 v[136:139], v1, s[48:51], s91 offen offset:1024 nt
    v_and_b32_dpp v36, v27, v8 row_newbcast:10 row_mask:0xf bank_mask:0xf
    v_and_b32_dpp v37, v27, v9 row_newbcast:10 row_mask:0xf bank_mask:0xf
    v_and_b32_dpp v38, v27, v10 row_newbcast:10 row_mask:0xf bank_mask:0xf
    v_and_b32_dpp v39, v27, v11 row_newbcast:10 row_mask:0xf bank_mask:0xf
    v_mfma_f32_16x16x32_bf16 v[40:43], v[116:119], v[32:35], v[40:43]
    s_waitcnt vmcnt(4)
    buffer_load_dwordx4 v[140:143], v1, s[48:51], s91 offen offset:2048 nt
    v_and_b32_dpp v32, v27, v8 row_newbcast:6 row_mask:0xf bank_mask:0xf
    v_and_b32_dpp v33, v27, v9 row_newbcast:6 row_mask:0xf bank_mask:0xf
    v_and_b32_dpp v34, v27, v10 row_newbcast:6 row_mask:0xf bank_mask:0xf
    v_and_b32_dpp v35, v27, v11 row_newbcast:6 row_mask:0xf bank_mask:0xf
    v_mfma_f32_16x16x32_bf16 v[40:43], v[120:123], v[36:39], v[40:43]
    s_waitcnt vmcnt(4)
    buffer_load_dwordx4 v[144:147], v1, s[48:51], s91 offen offset:3072 nt
    v_and_b32_dpp v36, v27, v8 row_newbcast:14 row_mask:0xf bank_mask:0xf
    v_and_b32_dpp v37, v27, v9 row_newbcast:14 row_mask:0xf bank_mask:0xf
    v_and_b32_dpp v38, v27, v10 row_newbcast:14 row_mask:0xf bank_mask:0xf
    v_and_b32_dpp v39, v27, v11 row_newbcast:14 row_mask:0xf bank_mask:0xf
    v_mfma_f32_16x16x32_bf16 v[40:43], v[124:127], v[32:35], v[40:43]
    s_waitcnt vmcnt(4)
    s_add_u32 s76, s6, 770048
    buffer_load_dwordx4 v[148:151], v1, s[48:51], s76 offen offset:0 nt
    v_and_b32_dpp v32, v27, v8 row_newbcast:1 row_mask:0xf bank_mask:0xf
    v_and_b32_dpp v33, v27, v9 row_newbcast:1 row_mask:0xf bank_mask:0xf
    v_and_b32_dpp v34, v27, v10 row_newbcast:1 row_mask:0xf bank_mask:0xf
    v_and_b32_dpp v35, v27, v11 row_newbcast:1 row_mask:0xf bank_mask:0xf
    v_mfma_f32_16x16x32_bf16 v[40:43], v[128:131], v[36:39], v[40:43]
    s_waitcnt vmcnt(4)
    buffer_load_dwordx4 v[152:155], v1, s[48:51], s76 offen offset:1024 nt
    v_and_b32_dpp v36, v27, v8 row_newbcast:9 row_mask:0xf bank_mask:0xf
    v_and_b32_dpp v37, v27, v9 row_newbcast:9 row_mask:0xf bank_mask:0xf
    v_and_b32_dpp v38, v27, v10 row_newbcast:9 row_mask:0xf bank_mask:0xf
    v_and_b32_dpp v39, v27, v11 row_newbcast:9 row_mask:0xf bank_mask:0xf
    v_mfma_f32_16x16x32_bf16 v[40:43], v[132:135], v[32:35], v[40:43]
    s_waitcnt vmcnt(4)
    buffer_load_dwordx4 v[156:159], v1, s[48:51], s76 offen offset:2048 nt
    v_and_b32_dpp v32, v27, v8 row_newbcast:5 row_mask:0xf bank_mask:0xf
    v_and_b32_dpp v33, v27, v9 row_newbcast:5 row_mask:0xf bank_mask:0xf
    v_and_b32_dpp v34, v27, v10 row_newbcast:5 row_mask:0xf bank_mask:0xf
    v_and_b32_dpp v35, v27, v11 row_newbcast:5 row_mask:0xf bank_mask:0xf
    v_mfma_f32_16x16x32_bf16 v[40:43], v[136:139], v[36:39], v[40:43]
    s_waitcnt vmcnt(4)
    buffer_load_dwordx4 v[160:163], v1, s[48:51], s76 offen offset:3072 nt
    v_and_b32_dpp v36, v27, v8 row_newbcast:13 row_mask:0xf bank_mask:0xf
    v_and_b32_dpp v37, v27, v9 row_newbcast:13 row_mask:0xf bank_mask:0xf
    v_and_b32_dpp v38, v27, v10 row_newbcast:13 row_mask:0xf bank_mask:0xf
    v_and_b32_dpp v39, v27, v11 row_newbcast:13 row_mask:0xf bank_mask:0xf
    v_mfma_f32_16x16x32_bf16 v[40:43], v[140:143], v[32:35], v[40:43]
    s_waitcnt vmcnt(4)
    s_add_u32 s77, s6, 786432
    buffer_load_dwordx4 v[164:167], v1, s[48:51], s77 offen offset:0 nt
    v_and_b32_dpp v32, v27, v8 row_newbcast:3 row_mask:0xf bank_mask:0xf
    v_and_b32_dpp v33, v27, v9 row_newbcast:3 row_mask:0xf bank_mask:0xf
    v_and_b32_dpp v34, v27, v10 row_newbcast:3 row_mask:0xf bank_mask:0xf
    v_and_b32_dpp v35, v27, v11 row_newbcast:3 row_mask:0xf bank_mask:0xf
    v_mfma_f32_16x16x32_bf16 v[40:43], v[144:147], v[36:39], v[40:43]
    s_waitcnt vmcnt(4)
    buffer_load_dwordx4 v[168:171], v1, s[48:51], s77 offen offset:1024 nt
    v_and_b32_dpp v36, v27, v8 row_newbcast:11 row_mask:0xf bank_mask:0xf
    v_and_b32_dpp v37, v27, v9 row_newbcast:11 row_mask:0xf bank_mask:0xf
    v_and_b32_dpp v38, v27, v10 row_newbcast:11 row_mask:0xf bank_mask:0xf
    v_and_b32_dpp v39, v27, v11 row_newbcast:11 row_mask:0xf bank_mask:0xf
    v_mfma_f32_16x16x32_bf16 v[40:43], v[148:151], v[32:35], v[40:43]
    s_waitcnt vmcnt(4)
    buffer_load_dwordx4 v[172:175], v1, s[48:51], s77 offen offset:2048 nt
    v_and_b32_dpp v32, v27, v8 row_newbcast:7 row_mask:0xf bank_mask:0xf
    v_and_b32_dpp v33, v27, v9 row_newbcast:7 row_mask:0xf bank_mask:0xf
    v_and_b32_dpp v34, v27, v10 row_newbcast:7 row_mask:0xf bank_mask:0xf
    v_and_b32_dpp v35, v27, v11 row_newbcast:7 row_mask:0xf bank_mask:0xf
    v_mfma_f32_16x16x32_bf16 v[40:43], v[152:155], v[36:39], v[40:43]
    s_waitcnt vmcnt(4)
    buffer_load_dwordx4 v[176:179], v1, s[48:51], s77 offen offset:3072 nt
    v_and_b32_dpp v36, v27, v8 row_newbcast:15 row_mask:0xf bank_mask:0xf
    v_and_b32_dpp v37, v27, v9 row_newbcast:15 row_mask:0xf bank_mask:0xf
    v_and_b32_dpp v38, v27, v10 row_newbcast:15 row_mask:0xf bank_mask:0xf
    v_and_b32_dpp v39, v27, v11 row_newbcast:15 row_mask:0xf bank_mask:0xf
    v_mfma_f32_16x16x32_bf16 v[40:43], v[156:159], v[32:35], v[40:43]
    s_waitcnt vmcnt(4)
    s_add_u32 s78, s6, 802816
    buffer_load_dwordx4 v[180:183], v1, s[48:51], s78 offen offset:0 nt
    v_and_b32_dpp v32, v28, v8 row_newbcast:0 row_mask:0xf bank_mask:0xf
    v_and_b32_dpp v33, v28, v9 row_newbcast:0 row_mask:0xf bank_mask:0xf
    v_and_b32_dpp v34, v28, v10 row_newbcast:0 row_mask:0xf bank_mask:0xf
    v_and_b32_dpp v35, v28, v11 row_newbcast:0 row_mask:0xf bank_mask:0xf
    v_mfma_f32_16x16x32_bf16 v[40:43], v[160:163], v[36:39], v[40:43]
    s_waitcnt vmcnt(4)
    buffer_load_dwordx4 v[184:187], v1, s[48:51], s78 offen offset:1024 nt
    v_and_b32_dpp v36, v28, v8 row_newbcast:8 row_mask:0xf bank_mask:0xf
    v_and_b32_dpp v37, v28, v9 row_newbcast:8 row_mask:0xf bank_mask:0xf
    v_and_b32_dpp v38, v28, v10 row_newbcast:8 row_mask:0xf bank_mask:0xf
    v_and_b32_dpp v39, v28, v11 row_newbcast:8 row_mask:0xf bank_mask:0xf
    v_mfma_f32_16x16x32_bf16 v[40:43], v[164:167], v[32:35], v[40:43]
    s_waitcnt vmcnt(4)
    buffer_load_dwordx4 v[188:191], v1, s[48:51], s78 offen offset:2048 nt
    v_and_b32_dpp v32, v28, v8 row_newbcast:4 row_mask:0xf bank_mask:0xf
    v_and_b32_dpp v33, v28, v9 row_newbcast:4 row_mask:0xf bank_mask:0xf
    v_and_b32_dpp v34, v28, v10 row_newbcast:4 row_mask:0xf bank_mask:0xf
    v_and_b32_dpp v35, v28, v11 row_newbcast:4 row_mask:0xf bank_mask:0xf
    v_mfma_f32_16x16x32_bf16 v[40:43], v[168:171], v[36:39], v[40:43]
    s_waitcnt vmcnt(4)
    buffer_load_dwordx4 v[192:195], v1, s[48:51], s78 offen offset:3072 nt
    v_and_b32_dpp v36, v28, v8 row_newbcast:12 row_mask:0xf bank_mask:0xf
    v_and_b32_dpp v37, v28, v9 row_newbcast:12 row_mask:0xf bank_mask:0xf
    v_and_b32_dpp v38, v28, v10 row_newbcast:12 row_mask:0xf bank_mask:0xf
    v_and_b32_dpp v39, v28, v11 row_newbcast:12 row_mask:0xf bank_mask:0xf
    v_mfma_f32_16x16x32_bf16 v[40:43], v[172:175], v[32:35], v[40:43]
    s_waitcnt vmcnt(4)
    s_add_u32 s79, s6, 819200
    buffer_load_dwordx4 v[196:199], v1, s[48:51], s79 offen offset:0 nt
    v_and_b32_dpp v32, v28, v8 row_newbcast:2 row_mask:0xf bank_mask:0xf
    v_and_b32_dpp v33, v28, v9 row_newbcast:2 row_mask:0xf bank_mask:0xf
    v_and_b32_dpp v34, v28, v10 row_newbcast:2 row_mask:0xf bank_mask:0xf
    v_and_b32_dpp v35, v28, v11 row_newbcast:2 row_mask:0xf bank_mask:0xf
    v_mfma_f32_16x16x32_bf16 v[40:43], v[176:179], v[36:39], v[40:43]
    s_waitcnt vmcnt(4)
    buffer_load_dwordx4 v[200:203], v1, s[48:51], s79 offen offset:1024 nt
    v_and_b32_dpp v36, v28, v8 row_newbcast:10 row_mask:0xf bank_mask:0xf
    v_and_b32_dpp v37, v28, v9 row_newbcast:10 row_mask:0xf bank_mask:0xf
    v_and_b32_dpp v38, v28, v10 row_newbcast:10 row_mask:0xf bank_mask:0xf
    v_and_b32_dpp v39, v28, v11 row_newbcast:10 row_mask:0xf bank_mask:0xf
    v_mfma_f32_16x16x32_bf16 v[40:43], v[180:183], v[32:35], v[40:43]
    s_waitcnt vmcnt(4)
    buffer_load_dwordx4 v[204:207], v1, s[48:51], s79 offen offset:2048 nt
    v_and_b32_dpp v32, v28, v8 row_newbcast:6 row_mask:0xf bank_mask:0xf
    v_and_b32_dpp v33, v28, v9 row_newbcast:6 row_mask:0xf bank_mask:0xf
    v_and_b32_dpp v34, v28, v10 row_newbcast:6 row_mask:0xf bank_mask:0xf
    v_and_b32_dpp v35, v28, v11 row_newbcast:6 row_mask:0xf bank_mask:0xf
    v_mfma_f32_16x16x32_bf16 v[40:43], v[184:187], v[36:39], v[40:43]
    s_waitcnt vmcnt(4)
    buffer_load_dwordx4 v[208:211], v1, s[48:51], s79 offen offset:3072 nt
    v_and_b32_dpp v36, v28, v8 row_newbcast:14 row_mask:0xf bank_mask:0xf
    v_and_b32_dpp v37, v28, v9 row_newbcast:14 row_mask:0xf bank_mask:0xf
    v_and_b32_dpp v38, v28, v10 row_newbcast:14 row_mask:0xf bank_mask:0xf
    v_and_b32_dpp v39, v28, v11 row_newbcast:14 row_mask:0xf bank_mask:0xf
    v_mfma_f32_16x16x32_bf16 v[40:43], v[188:191], v[32:35], v[40:43]
    s_waitcnt vmcnt(4)
    s_add_u32 s80, s6, 835584
    buffer_load_dwordx4 v[212:215], v1, s[48:51], s80 offen offset:0 nt
    v_and_b32_dpp v32, v28, v8 row_newbcast:1 row_mask:0xf bank_mask:0xf
    v_and_b32_dpp v33, v28, v9 row_newbcast:1 row_mask:0xf bank_mask:0xf
    v_and_b32_dpp v34, v28, v10 row_newbcast:1 row_mask:0xf bank_mask:0xf
    v_and_b32_dpp v35, v28, v11 row_newbcast:1 row_mask:0xf bank_mask:0xf
    v_mfma_f32_16x16x32_bf16 v[40:43], v[192:195], v[36:39], v[40:43]
    s_waitcnt vmcnt(4)
    buffer_load_dwordx4 v[216:219], v1, s[48:51], s80 offen offset:1024 nt
    v_and_b32_dpp v36, v28, v8 row_newbcast:9 row_mask:0xf bank_mask:0xf
    v_and_b32_dpp v37, v28, v9 row_newbcast:9 row_mask:0xf bank_mask:0xf
    v_and_b32_dpp v38, v28, v10 row_newbcast:9 row_mask:0xf bank_mask:0xf
    v_and_b32_dpp v39, v28, v11 row_newbcast:9 row_mask:0xf bank_mask:0xf
    v_mfma_f32_16x16x32_bf16 v[40:43], v[196:199], v[32:35], v[40:43]
    s_waitcnt vmcnt(4)
    buffer_load_dwordx4 v[220:223], v1, s[48:51], s80 offen offset:2048 nt
    v_and_b32_dpp v32, v28, v8 row_newbcast:5 row_mask:0xf bank_mask:0xf
    v_and_b32_dpp v33, v28, v9 row_newbcast:5 row_mask:0xf bank_mask:0xf
    v_and_b32_dpp v34, v28, v10 row_newbcast:5 row_mask:0xf bank_mask:0xf
    v_and_b32_dpp v35, v28, v11 row_newbcast:5 row_mask:0xf bank_mask:0xf
    v_mfma_f32_16x16x32_bf16 v[40:43], v[200:203], v[36:39], v[40:43]
    s_waitcnt vmcnt(4)
    buffer_load_dwordx4 v[224:227], v1, s[48:51], s80 offen offset:3072 nt
    v_and_b32_dpp v36, v28, v8 row_newbcast:13 row_mask:0xf bank_mask:0xf
    v_and_b32_dpp v37, v28, v9 row_newbcast:13 row_mask:0xf bank_mask:0xf
    v_and_b32_dpp v38, v28, v10 row_newbcast:13 row_mask:0xf bank_mask:0xf
    v_and_b32_dpp v39, v28, v11 row_newbcast:13 row_mask:0xf bank_mask:0xf
    v_mfma_f32_16x16x32_bf16 v[40:43], v[204:207], v[32:35], v[40:43]
    s_waitcnt vmcnt(4)
    s_add_u32 s81, s6, 851968
    buffer_load_dwordx4 v[228:231], v1, s[48:51], s81 offen offset:0 nt
    v_and_b32_dpp v32, v28, v8 row_newbcast:3 row_mask:0xf bank_mask:0xf
    v_and_b32_dpp v33, v28, v9 row_newbcast:3 row_mask:0xf bank_mask:0xf
    v_and_b32_dpp v34, v28, v10 row_newbcast:3 row_mask:0xf bank_mask:0xf
    v_and_b32_dpp v35, v28, v11 row_newbcast:3 row_mask:0xf bank_mask:0xf
    v_mfma_f32_16x16x32_bf16 v[40:43], v[208:211], v[36:39], v[40:43]
    s_waitcnt vmcnt(4)
    buffer_load_dwordx4 v[232:235], v1, s[48:51], s81 offen offset:1024 nt
    v_and_b32_dpp v36, v28, v8 row_newbcast:11 row_mask:0xf bank_mask:0xf
    v_and_b32_dpp v37, v28, v9 row_newbcast:11 row_mask:0xf bank_mask:0xf
    v_and_b32_dpp v38, v28, v10 row_newbcast:11 row_mask:0xf bank_mask:0xf
    v_and_b32_dpp v39, v28, v11 row_newbcast:11 row_mask:0xf bank_mask:0xf
    v_mfma_f32_16x16x32_bf16 v[40:43], v[212:215], v[32:35], v[40:43]
    s_waitcnt vmcnt(4)
    buffer_load_dwordx4 v[236:239], v1, s[48:51], s81 offen offset:2048 nt
    v_and_b32_dpp v32, v28, v8 row_newbcast:7 row_mask:0xf bank_mask:0xf
    v_and_b32_dpp v33, v28, v9 row_newbcast:7 row_mask:0xf bank_mask:0xf
    v_and_b32_dpp v34, v28, v10 row_newbcast:7 row_mask:0xf bank_mask:0xf
    v_and_b32_dpp v35, v28, v11 row_newbcast:7 row_mask:0xf bank_mask:0xf
    v_mfma_f32_16x16x32_bf16 v[40:43], v[216:219], v[36:39], v[40:43]
    s_waitcnt vmcnt(4)
    buffer_load_dwordx4 v[240:243], v1, s[48:51], s81 offen offset:3072 nt
    v_and_b32_dpp v36, v28, v8 row_newbcast:15 row_mask:0xf bank_mask:0xf
    v_and_b32_dpp v37, v28, v9 row_newbcast:15 row_mask:0xf bank_mask:0xf
    v_and_b32_dpp v38, v28, v10 row_newbcast:15 row_mask:0xf bank_mask:0xf
    v_and_b32_dpp v39, v28, v11 row_newbcast:15 row_mask:0xf bank_mask:0xf
    v_mfma_f32_16x16x32_bf16 v[40:43], v[220:223], v[32:35], v[40:43]
    s_waitcnt vmcnt(4)
    s_add_u32 s82, s6, 868352
    buffer_load_dwordx4 v[244:247], v1, s[48:51], s82 offen offset:0 nt
    v_and_b32_dpp v32, v29, v8 row_newbcast:0 row_mask:0xf bank_mask:0xf
    v_and_b32_dpp v33, v29, v9 row_newbcast:0 row_mask:0xf bank_mask:0xf
    v_and_b32_dpp v34, v29, v10 row_newbcast:0 row_mask:0xf bank_mask:0xf
    v_and_b32_dpp v35, v29, v11 row_newbcast:0 row_mask:0xf bank_mask:0xf
    v_mfma_f32_16x16x32_bf16 v[40:43], v[224:227], v[36:39], v[40:43]
    s_waitcnt vmcnt(4)
    buffer_load_dwordx4 v[248:251], v1, s[48:51], s82 offen offset:1024 nt
    v_and_b32_dpp v36, v29, v8 row_newbcast:8 row_mask:0xf bank_mask:0xf
    v_and_b32_dpp v37, v29, v9 row_newbcast:8 row_mask:0xf bank_mask:0xf
    v_and_b32_dpp v38, v29, v10 row_newbcast:8 row_mask:0xf bank_mask:0xf
    v_and_b32_dpp v39, v29, v11 row_newbcast:8 row_mask:0xf bank_mask:0xf
    v_mfma_f32_16x16x32_bf16 v[40:43], v[228:231], v[32:35], v[40:43]
    s_waitcnt vmcnt(4)
    buffer_load_dwordx4 v[64:67], v1, s[48:51], s82 offen offset:2048 nt
    v_and_b32_dpp v32, v29, v8 row_newbcast:4 row_mask:0xf bank_mask:0xf
    v_and_b32_dpp v33, v29, v9 row_newbcast:4 row_mask:0xf bank_mask:0xf
    v_and_b32_dpp v34, v29, v10 row_newbcast:4 row_mask:0xf bank_mask:0xf
    v_and_b32_dpp v35, v29, v11 row_newbcast:4 row_mask:0xf bank_mask:0xf
    v_mfma_f32_16x16x32_bf16 v[40:43], v[232:235], v[36:39], v[40:43]
    s_waitcnt vmcnt(4)
    buffer_load_dwordx4 v[68:71], v1, s[48:51], s82 offen offset:3072 nt
    v_and_b32_dpp v36, v29, v8 row_newbcast:12 row_mask:0xf bank_mask:0xf
    v_and_b32_dpp v37, v29, v9 row_newbcast:12 row_mask:0xf bank_mask:0xf
    v_and_b32_dpp v38, v29, v10 row_newbcast:12 row_mask:0xf bank_mask:0xf
    v_and_b32_dpp v39, v29, v11 row_newbcast:12 row_mask:0xf bank_mask:0xf
    v_mfma_f32_16x16x32_bf16 v[40:43], v[236:239], v[32:35], v[40:43]
    s_waitcnt vmcnt(4)
    s_add_u32 s83, s6, 884736
    buffer_load_dwordx4 v[72:75], v1, s[48:51], s83 offen offset:0 nt
    v_and_b32_dpp v32, v29, v8 row_newbcast:2 row_mask:0xf bank_mask:0xf
    v_and_b32_dpp v33, v29, v9 row_newbcast:2 row_mask:0xf bank_mask:0xf
    v_and_b32_dpp v34, v29, v10 row_newbcast:2 row_mask:0xf bank_mask:0xf
    v_and_b32_dpp v35, v29, v11 row_newbcast:2 row_mask:0xf bank_mask:0xf
    v_mfma_f32_16x16x32_bf16 v[40:43], v[240:243], v[36:39], v[40:43]
    s_waitcnt vmcnt(4)
    buffer_load_dwordx4 v[76:79], v1, s[48:51], s83 offen offset:1024 nt
    v_and_b32_dpp v36, v29, v8 row_newbcast:10 row_mask:0xf bank_mask:0xf
    v_and_b32_dpp v37, v29, v9 row_newbcast:10 row_mask:0xf bank_mask:0xf
    v_and_b32_dpp v38, v29, v10 row_newbcast:10 row_mask:0xf bank_mask:0xf
    v_and_b32_dpp v39, v29, v11 row_newbcast:10 row_mask:0xf bank_mask:0xf
    v_mfma_f32_16x16x32_bf16 v[40:43], v[244:247], v[32:35], v[40:43]
    s_waitcnt vmcnt(4)
    buffer_load_dwordx4 v[80:83], v1, s[48:51], s83 offen offset:2048 nt
    buffer_load_dwordx4 v[84:87], v1, s[48:51], s83 offen offset:3072 nt
    s_add_u32 s84, s6, 901120
    buffer_load_dwordx4 v[88:91], v1, s[48:51], s84 offen offset:0 nt
    buffer_load_dwordx4 v[92:95], v1, s[48:51], s84 offen offset:1024 nt
    buffer_load_dwordx4 v[96:99], v1, s[48:51], s84 offen offset:2048 nt
    buffer_load_dwordx4 v[100:103], v1, s[48:51], s84 offen offset:3072 nt
    v_and_b32_dpp v32, v29, v8 row_newbcast:6 row_mask:0xf bank_mask:0xf
    v_and_b32_dpp v33, v29, v9 row_newbcast:6 row_mask:0xf bank_mask:0xf
    v_and_b32_dpp v34, v29, v10 row_newbcast:6 row_mask:0xf bank_mask:0xf
    v_and_b32_dpp v35, v29, v11 row_newbcast:6 row_mask:0xf bank_mask:0xf
    v_mfma_f32_16x16x32_bf16 v[40:43], v[248:251], v[36:39], v[40:43]
    s_waitcnt vmcnt(9)
    s_add_u32 s85, s6, 917504
    buffer_load_dwordx4 v[104:107], v1, s[48:51], s85 offen offset:0 nt
    v_and_b32_dpp v36, v29, v8 row_newbcast:14 row_mask:0xf bank_mask:0xf
    v_and_b32_dpp v37, v29, v9 row_newbcast:14 row_mask:0xf bank_mask:0xf
    v_and_b32_dpp v38, v29, v10 row_newbcast:14 row_mask:0xf bank_mask:0xf
    v_and_b32_dpp v39, v29, v11 row_newbcast:14 row_mask:0xf bank_mask:0xf
    v_mfma_f32_16x16x32_bf16 v[40:43], v[64:67], v[32:35], v[40:43]
    s_waitcnt vmcnt(9)
    buffer_load_dwordx4 v[108:111], v1, s[48:51], s85 offen offset:1024 nt
    v_and_b32_dpp v32, v29, v8 row_newbcast:1 row_mask:0xf bank_mask:0xf
    v_and_b32_dpp v33, v29, v9 row_newbcast:1 row_mask:0xf bank_mask:0xf
    v_and_b32_dpp v34, v29, v10 row_newbcast:1 row_mask:0xf bank_mask:0xf
    v_and_b32_dpp v35, v29, v11 row_newbcast:1 row_mask:0xf bank_mask:0xf
    v_mfma_f32_16x16x32_bf16 v[40:43], v[68:71], v[36:39], v[40:43]
    s_waitcnt vmcnt(9)
    buffer_load_dwordx4 v[112:115], v1, s[48:51], s85 offen offset:2048 nt
    v_and_b32_dpp v36, v29, v8 row_newbcast:9 row_mask:0xf bank_mask:0xf
    v_and_b32_dpp v37, v29, v9 row_newbcast:9 row_mask:0xf bank_mask:0xf
    v_and_b32_dpp v38, v29, v10 row_newbcast:9 row_mask:0xf bank_mask:0xf
    v_and_b32_dpp v39, v29, v11 row_newbcast:9 row_mask:0xf bank_mask:0xf
    v_mfma_f32_16x16x32_bf16 v[40:43], v[72:75], v[32:35], v[40:43]
    s_waitcnt vmcnt(9)
    buffer_load_dwordx4 v[116:119], v1, s[48:51], s85 offen offset:3072 nt
    v_and_b32_dpp v32, v29, v8 row_newbcast:5 row_mask:0xf bank_mask:0xf
    v_and_b32_dpp v33, v29, v9 row_newbcast:5 row_mask:0xf bank_mask:0xf
    v_and_b32_dpp v34, v29, v10 row_newbcast:5 row_mask:0xf bank_mask:0xf
    v_and_b32_dpp v35, v29, v11 row_newbcast:5 row_mask:0xf bank_mask:0xf
    v_mfma_f32_16x16x32_bf16 v[40:43], v[76:79], v[36:39], v[40:43]
    s_waitcnt vmcnt(9)
    s_add_u32 s86, s6, 933888
    buffer_load_dwordx4 v[120:123], v1, s[48:51], s86 offen offset:0 nt
    v_and_b32_dpp v36, v29, v8 row_newbcast:13 row_mask:0xf bank_mask:0xf
    v_and_b32_dpp v37, v29, v9 row_newbcast:13 row_mask:0xf bank_mask:0xf
    v_and_b32_dpp v38, v29, v10 row_newbcast:13 row_mask:0xf bank_mask:0xf
    v_and_b32_dpp v39, v29, v11 row_newbcast:13 row_mask:0xf bank_mask:0xf
    v_mfma_f32_16x16x32_bf16 v[40:43], v[80:83], v[32:35], v[40:43]
    s_waitcnt vmcnt(9)
    buffer_load_dwordx4 v[124:127], v1, s[48:51], s86 offen offset:1024 nt
    v_and_b32_dpp v32, v29, v8 row_newbcast:3 row_mask:0xf bank_mask:0xf
    v_and_b32_dpp v33, v29, v9 row_newbcast:3 row_mask:0xf bank_mask:0xf
    v_and_b32_dpp v34, v29, v10 row_newbcast:3 row_mask:0xf bank_mask:0xf
    v_and_b32_dpp v35, v29, v11 row_newbcast:3 row_mask:0xf bank_mask:0xf
    v_mfma_f32_16x16x32_bf16 v[40:43], v[84:87], v[36:39], v[40:43]
    s_waitcnt vmcnt(9)
    buffer_load_dwordx4 v[128:131], v1, s[48:51], s86 offen offset:2048 nt
    v_and_b32_dpp v36, v29, v8 row_newbcast:11 row_mask:0xf bank_mask:0xf
    v_and_b32_dpp v37, v29, v9 row_newbcast:11 row_mask:0xf bank_mask:0xf
    v_and_b32_dpp v38, v29, v10 row_newbcast:11 row_mask:0xf bank_mask:0xf
    v_and_b32_dpp v39, v29, v11 row_newbcast:11 row_mask:0xf bank_mask:0xf
    v_mfma_f32_16x16x32_bf16 v[40:43], v[88:91], v[32:35], v[40:43]
    s_waitcnt vmcnt(9)
    buffer_load_dwordx4 v[132:135], v1, s[48:51], s86 offen offset:3072 nt
    v_and_b32_dpp v32, v29, v8 row_newbcast:7 row_mask:0xf bank_mask:0xf
    v_and_b32_dpp v33, v29, v9 row_newbcast:7 row_mask:0xf bank_mask:0xf
    v_and_b32_dpp v34, v29, v10 row_newbcast:7 row_mask:0xf bank_mask:0xf
    v_and_b32_dpp v35, v29, v11 row_newbcast:7 row_mask:0xf bank_mask:0xf
    v_mfma_f32_16x16x32_bf16 v[40:43], v[92:95], v[36:39], v[40:43]
    s_waitcnt vmcnt(9)
    s_add_u32 s87, s6, 950272
    buffer_load_dwordx4 v[136:139], v1, s[48:51], s87 offen offset:0 nt
    v_and_b32_dpp v36, v29, v8 row_newbcast:15 row_mask:0xf bank_mask:0xf
    v_and_b32_dpp v37, v29, v9 row_newbcast:15 row_mask:0xf bank_mask:0xf
    v_and_b32_dpp v38, v29, v10 row_newbcast:15 row_mask:0xf bank_mask:0xf
    v_and_b32_dpp v39, v29, v11 row_newbcast:15 row_mask:0xf bank_mask:0xf
    v_mfma_f32_16x16x32_bf16 v[40:43], v[96:99], v[32:35], v[40:43]
    s_waitcnt vmcnt(9)
    buffer_load_dwordx4 v[140:143], v1, s[48:51], s87 offen offset:1024 nt
    v_and_b32_dpp v32, v30, v8 row_newbcast:0 row_mask:0xf bank_mask:0xf
    v_and_b32_dpp v33, v30, v9 row_newbcast:0 row_mask:0xf bank_mask:0xf
    v_and_b32_dpp v34, v30, v10 row_newbcast:0 row_mask:0xf bank_mask:0xf
    v_and_b32_dpp v35, v30, v11 row_newbcast:0 row_mask:0xf bank_mask:0xf
    v_mfma_f32_16x16x32_bf16 v[40:43], v[100:103], v[36:39], v[40:43]
    s_waitcnt vmcnt(9)
    buffer_load_dwordx4 v[144:147], v1, s[48:51], s87 offen offset:2048 nt
    v_and_b32_dpp v36, v30, v8 row_newbcast:8 row_mask:0xf bank_mask:0xf
    v_and_b32_dpp v37, v30, v9 row_newbcast:8 row_mask:0xf bank_mask:0xf
    v_and_b32_dpp v38, v30, v10 row_newbcast:8 row_mask:0xf bank_mask:0xf
    v_and_b32_dpp v39, v30, v11 row_newbcast:8 row_mask:0xf bank_mask:0xf
    v_mfma_f32_16x16x32_bf16 v[40:43], v[104:107], v[32:35], v[40:43]
    s_waitcnt vmcnt(9)
    buffer_load_dwordx4 v[148:151], v1, s[48:51], s87 offen offset:3072 nt
    v_and_b32_dpp v32, v30, v8 row_newbcast:4 row_mask:0xf bank_mask:0xf
    v_and_b32_dpp v33, v30, v9 row_newbcast:4 row_mask:0xf bank_mask:0xf
    v_and_b32_dpp v34, v30, v10 row_newbcast:4 row_mask:0xf bank_mask:0xf
    v_and_b32_dpp v35, v30, v11 row_newbcast:4 row_mask:0xf bank_mask:0xf
    v_mfma_f32_16x16x32_bf16 v[40:43], v[108:111], v[36:39], v[40:43]
    s_waitcnt vmcnt(9)
    s_add_u32 s88, s6, 966656
    buffer_load_dwordx4 v[152:155], v1, s[48:51], s88 offen offset:0 nt
    v_and_b32_dpp v36, v30, v8 row_newbcast:12 row_mask:0xf bank_mask:0xf
    v_and_b32_dpp v37, v30, v9 row_newbcast:12 row_mask:0xf bank_mask:0xf
    v_and_b32_dpp v38, v30, v10 row_newbcast:12 row_mask:0xf bank_mask:0xf
    v_and_b32_dpp v39, v30, v11 row_newbcast:12 row_mask:0xf bank_mask:0xf
    v_mfma_f32_16x16x32_bf16 v[40:43], v[112:115], v[32:35], v[40:43]
    s_waitcnt vmcnt(9)
    buffer_load_dwordx4 v[156:159], v1, s[48:51], s88 offen offset:1024 nt
    v_and_b32_dpp v32, v30, v8 row_newbcast:2 row_mask:0xf bank_mask:0xf
    v_and_b32_dpp v33, v30, v9 row_newbcast:2 row_mask:0xf bank_mask:0xf
    v_and_b32_dpp v34, v30, v10 row_newbcast:2 row_mask:0xf bank_mask:0xf
    v_and_b32_dpp v35, v30, v11 row_newbcast:2 row_mask:0xf bank_mask:0xf
    v_mfma_f32_16x16x32_bf16 v[40:43], v[116:119], v[36:39], v[40:43]
    s_waitcnt vmcnt(9)
    buffer_load_dwordx4 v[160:163], v1, s[48:51], s88 offen offset:2048 nt
    v_and_b32_dpp v36, v30, v8 row_newbcast:10 row_mask:0xf bank_mask:0xf
    v_and_b32_dpp v37, v30, v9 row_newbcast:10 row_mask:0xf bank_mask:0xf
    v_and_b32_dpp v38, v30, v10 row_newbcast:10 row_mask:0xf bank_mask:0xf
    v_and_b32_dpp v39, v30, v11 row_newbcast:10 row_mask:0xf bank_mask:0xf
    v_mfma_f32_16x16x32_bf16 v[40:43], v[120:123], v[32:35], v[40:43]
    s_waitcnt vmcnt(9)
    buffer_load_dwordx4 v[164:167], v1, s[48:51], s88 offen offset:3072 nt
    v_and_b32_dpp v32, v30, v8 row_newbcast:6 row_mask:0xf bank_mask:0xf
    v_and_b32_dpp v33, v30, v9 row_newbcast:6 row_mask:0xf bank_mask:0xf
    v_and_b32_dpp v34, v30, v10 row_newbcast:6 row_mask:0xf bank_mask:0xf
    v_and_b32_dpp v35, v30, v11 row_newbcast:6 row_mask:0xf bank_mask:0xf
    v_mfma_f32_16x16x32_bf16 v[40:43], v[124:127], v[36:39], v[40:43]
    s_waitcnt vmcnt(9)
    s_add_u32 s89, s6, 983040
    buffer_load_dwordx4 v[168:171], v1, s[48:51], s89 offen offset:0 nt
    v_and_b32_dpp v36, v30, v8 row_newbcast:14 row_mask:0xf bank_mask:0xf
    v_and_b32_dpp v37, v30, v9 row_newbcast:14 row_mask:0xf bank_mask:0xf
    v_and_b32_dpp v38, v30, v10 row_newbcast:14 row_mask:0xf bank_mask:0xf
    v_and_b32_dpp v39, v30, v11 row_newbcast:14 row_mask:0xf bank_mask:0xf
    v_mfma_f32_16x16x32_bf16 v[40:43], v[128:131], v[32:35], v[40:43]
    s_waitcnt vmcnt(9)
    buffer_load_dwordx4 v[172:175], v1, s[48:51], s89 offen offset:1024 nt
    v_and_b32_dpp v32, v30, v8 row_newbcast:1 row_mask:0xf bank_mask:0xf
    v_and_b32_dpp v33, v30, v9 row_newbcast:1 row_mask:0xf bank_mask:0xf
    v_and_b32_dpp v34, v30, v10 row_newbcast:1 row_mask:0xf bank_mask:0xf
    v_and_b32_dpp v35, v30, v11 row_newbcast:1 row_mask:0xf bank_mask:0xf
    v_mfma_f32_16x16x32_bf16 v[40:43], v[132:135], v[36:39], v[40:43]
    s_waitcnt vmcnt(9)
    buffer_load_dwordx4 v[176:179], v1, s[48:51], s89 offen offset:2048 nt
    v_and_b32_dpp v36, v30, v8 row_newbcast:9 row_mask:0xf bank_mask:0xf
    v_and_b32_dpp v37, v30, v9 row_newbcast:9 row_mask:0xf bank_mask:0xf
    v_and_b32_dpp v38, v30, v10 row_newbcast:9 row_mask:0xf bank_mask:0xf
    v_and_b32_dpp v39, v30, v11 row_newbcast:9 row_mask:0xf bank_mask:0xf
    v_mfma_f32_16x16x32_bf16 v[40:43], v[136:139], v[32:35], v[40:43]
    s_waitcnt vmcnt(9)
    buffer_load_dwordx4 v[180:183], v1, s[48:51], s89 offen offset:3072 nt
    v_and_b32_dpp v32, v30, v8 row_newbcast:5 row_mask:0xf bank_mask:0xf
    v_and_b32_dpp v33, v30, v9 row_newbcast:5 row_mask:0xf bank_mask:0xf
    v_and_b32_dpp v34, v30, v10 row_newbcast:5 row_mask:0xf bank_mask:0xf
    v_and_b32_dpp v35, v30, v11 row_newbcast:5 row_mask:0xf bank_mask:0xf
    v_mfma_f32_16x16x32_bf16 v[40:43], v[140:143], v[36:39], v[40:43]
    s_waitcnt vmcnt(9)
    s_add_u32 s90, s6, 999424
    buffer_load_dwordx4 v[184:187], v1, s[48:51], s90 offen offset:0 nt
    v_and_b32_dpp v36, v30, v8 row_newbcast:13 row_mask:0xf bank_mask:0xf
    v_and_b32_dpp v37, v30, v9 row_newbcast:13 row_mask:0xf bank_mask:0xf
    v_and_b32_dpp v38, v30, v10 row_newbcast:13 row_mask:0xf bank_mask:0xf
    v_and_b32_dpp v39, v30, v11 row_newbcast:13 row_mask:0xf bank_mask:0xf
    v_mfma_f32_16x16x32_bf16 v[40:43], v[144:147], v[32:35], v[40:43]
    s_waitcnt vmcnt(9)
    buffer_load_dwordx4 v[188:191], v1, s[48:51], s90 offen offset:1024 nt
    v_and_b32_dpp v32, v30, v8 row_newbcast:3 row_mask:0xf bank_mask:0xf
    v_and_b32_dpp v33, v30, v9 row_newbcast:3 row_mask:0xf bank_mask:0xf
    v_and_b32_dpp v34, v30, v10 row_newbcast:3 row_mask:0xf bank_mask:0xf
    v_and_b32_dpp v35, v30, v11 row_newbcast:3 row_mask:0xf bank_mask:0xf
    v_mfma_f32_16x16x32_bf16 v[40:43], v[148:151], v[36:39], v[40:43]
    s_waitcnt vmcnt(9)
    buffer_load_dwordx4 v[192:195], v1, s[48:51], s90 offen offset:2048 nt
    v_and_b32_dpp v36, v30, v8 row_newbcast:11 row_mask:0xf bank_mask:0xf
    v_and_b32_dpp v37, v30, v9 row_newbcast:11 row_mask:0xf bank_mask:0xf
    v_and_b32_dpp v38, v30, v10 row_newbcast:11 row_mask:0xf bank_mask:0xf
    v_and_b32_dpp v39, v30, v11 row_newbcast:11 row_mask:0xf bank_mask:0xf
    v_mfma_f32_16x16x32_bf16 v[40:43], v[152:155], v[32:35], v[40:43]
    s_waitcnt vmcnt(9)
    buffer_load_dwordx4 v[196:199], v1, s[48:51], s90 offen offset:3072 nt
    v_and_b32_dpp v32, v30, v8 row_newbcast:7 row_mask:0xf bank_mask:0xf
    v_and_b32_dpp v33, v30, v9 row_newbcast:7 row_mask:0xf bank_mask:0xf
    v_and_b32_dpp v34, v30, v10 row_newbcast:7 row_mask:0xf bank_mask:0xf
    v_and_b32_dpp v35, v30, v11 row_newbcast:7 row_mask:0xf bank_mask:0xf
    v_mfma_f32_16x16x32_bf16 v[40:43], v[156:159], v[36:39], v[40:43]
    s_waitcnt vmcnt(9)
    s_add_u32 s91, s6, 1015808
    buffer_load_dwordx4 v[200:203], v1, s[48:51], s91 offen offset:0 nt
    v_and_b32_dpp v36, v30, v8 row_newbcast:15 row_mask:0xf bank_mask:0xf
    v_and_b32_dpp v37, v30, v9 row_newbcast:15 row_mask:0xf bank_mask:0xf
    v_and_b32_dpp v38, v30, v10 row_newbcast:15 row_mask:0xf bank_mask:0xf
    v_and_b32_dpp v39, v30, v11 row_newbcast:15 row_mask:0xf bank_mask:0xf
    v_mfma_f32_16x16x32_bf16 v[40:43], v[160:163], v[32:35], v[40:43]
    s_waitcnt vmcnt(9)
    buffer_load_dwordx4 v[204:207], v1, s[48:51], s91 offen offset:1024 nt
    v_and_b32_dpp v32, v31, v8 row_newbcast:0 row_mask:0xf bank_mask:0xf
    v_and_b32_dpp v33, v31, v9 row_newbcast:0 row_mask:0xf bank_mask:0xf
    v_and_b32_dpp v34, v31, v10 row_newbcast:0 row_mask:0xf bank_mask:0xf
    v_and_b32_dpp v35, v31, v11 row_newbcast:0 row_mask:0xf bank_mask:0xf
    v_mfma_f32_16x16x32_bf16 v[40:43], v[164:167], v[36:39], v[40:43]
    s_waitcnt vmcnt(9)
    buffer_load_dwordx4 v[208:211], v1, s[48:51], s91 offen offset:2048 nt
    v_and_b32_dpp v36, v31, v8 row_newbcast:8 row_mask:0xf bank_mask:0xf
    v_and_b32_dpp v37, v31, v9 row_newbcast:8 row_mask:0xf bank_mask:0xf
    v_and_b32_dpp v38, v31, v10 row_newbcast:8 row_mask:0xf bank_mask:0xf
    v_and_b32_dpp v39, v31, v11 row_newbcast:8 row_mask:0xf bank_mask:0xf
    v_mfma_f32_16x16x32_bf16 v[40:43], v[168:171], v[32:35], v[40:43]
    s_waitcnt vmcnt(9)
    buffer_load_dwordx4 v[212:215], v1, s[48:51], s91 offen offset:3072 nt
    v_and_b32_dpp v32, v31, v8 row_newbcast:4 row_mask:0xf bank_mask:0xf
    v_and_b32_dpp v33, v31, v9 row_newbcast:4 row_mask:0xf bank_mask:0xf
    v_and_b32_dpp v34, v31, v10 row_newbcast:4 row_mask:0xf bank_mask:0xf
    v_and_b32_dpp v35, v31, v11 row_newbcast:4 row_mask:0xf bank_mask:0xf
    v_mfma_f32_16x16x32_bf16 v[40:43], v[172:175], v[36:39], v[40:43]
    s_waitcnt vmcnt(9)
    s_add_u32 s76, s6, 1032192
    buffer_load_dwordx4 v[216:219], v1, s[48:51], s76 offen offset:0 nt
    v_and_b32_dpp v36, v31, v8 row_newbcast:12 row_mask:0xf bank_mask:0xf
    v_and_b32_dpp v37, v31, v9 row_newbcast:12 row_mask:0xf bank_mask:0xf
    v_and_b32_dpp v38, v31, v10 row_newbcast:12 row_mask:0xf bank_mask:0xf
    v_and_b32_dpp v39, v31, v11 row_newbcast:12 row_mask:0xf bank_mask:0xf
    v_mfma_f32_16x16x32_bf16 v[40:43], v[176:179], v[32:35], v[40:43]
    s_waitcnt vmcnt(9)
    buffer_load_dwordx4 v[220:223], v1, s[48:51], s76 offen offset:1024 nt
    v_and_b32_dpp v32, v31, v8 row_newbcast:2 row_mask:0xf bank_mask:0xf
    v_and_b32_dpp v33, v31, v9 row_newbcast:2 row_mask:0xf bank_mask:0xf
    v_and_b32_dpp v34, v31, v10 row_newbcast:2 row_mask:0xf bank_mask:0xf
    v_and_b32_dpp v35, v31, v11 row_newbcast:2 row_mask:0xf bank_mask:0xf
    v_mfma_f32_16x16x32_bf16 v[40:43], v[180:183], v[36:39], v[40:43]
    s_waitcnt vmcnt(9)
    buffer_load_dwordx4 v[224:227], v1, s[48:51], s76 offen offset:2048 nt
    v_and_b32_dpp v36, v31, v8 row_newbcast:10 row_mask:0xf bank_mask:0xf
    v_and_b32_dpp v37, v31, v9 row_newbcast:10 row_mask:0xf bank_mask:0xf
    v_and_b32_dpp v38, v31, v10 row_newbcast:10 row_mask:0xf bank_mask:0xf
    v_and_b32_dpp v39, v31, v11 row_newbcast:10 row_mask:0xf bank_mask:0xf
    v_mfma_f32_16x16x32_bf16 v[40:43], v[184:187], v[32:35], v[40:43]
    s_waitcnt vmcnt(9)
    buffer_load_dwordx4 v[228:231], v1, s[48:51], s76 offen offset:3072 nt
    v_and_b32_dpp v32, v31, v8 row_newbcast:6 row_mask:0xf bank_mask:0xf
    v_and_b32_dpp v33, v31, v9 row_newbcast:6 row_mask:0xf bank_mask:0xf
    v_and_b32_dpp v34, v31, v10 row_newbcast:6 row_mask:0xf bank_mask:0xf
    v_and_b32_dpp v35, v31, v11 row_newbcast:6 row_mask:0xf bank_mask:0xf
    v_mfma_f32_16x16x32_bf16 v[40:43], v[188:191], v[36:39], v[40:43]
    v_and_b32_dpp v36, v31, v8 row_newbcast:14 row_mask:0xf bank_mask:0xf
    v_and_b32_dpp v37, v31, v9 row_newbcast:14 row_mask:0xf bank_mask:0xf
    v_and_b32_dpp v38, v31, v10 row_newbcast:14 row_mask:0xf bank_mask:0xf
    v_and_b32_dpp v39, v31, v11 row_newbcast:14 row_mask:0xf bank_mask:0xf
    s_waitcnt vmcnt(9)
    v_mfma_f32_16x16x32_bf16 v[40:43], v[192:195], v[32:35], v[40:43]
    v_and_b32_dpp v32, v31, v8 row_newbcast:1 row_mask:0xf bank_mask:0xf
    v_and_b32_dpp v33, v31, v9 row_newbcast:1 row_mask:0xf bank_mask:0xf
    v_and_b32_dpp v34, v31, v10 row_newbcast:1 row_mask:0xf bank_mask:0xf
    v_and_b32_dpp v35, v31, v11 row_newbcast:1 row_mask:0xf bank_mask:0xf
    s_waitcnt vmcnt(8)
    v_mfma_f32_16x16x32_bf16 v[40:43], v[196:199], v[36:39], v[40:43]
    v_and_b32_dpp v36, v31, v8 row_newbcast:9 row_mask:0xf bank_mask:0xf
    v_and_b32_dpp v37, v31, v9 row_newbcast:9 row_mask:0xf bank_mask:0xf
    v_and_b32_dpp v38, v31, v10 row_newbcast:9 row_mask:0xf bank_mask:0xf
    v_and_b32_dpp v39, v31, v11 row_newbcast:9 row_mask:0xf bank_mask:0xf
    s_waitcnt vmcnt(7)
    v_mfma_f32_16x16x32_bf16 v[40:43], v[200:203], v[32:35], v[40:43]
    v_and_b32_dpp v32, v31, v8 row_newbcast:5 row_mask:0xf bank_mask:0xf
    v_and_b32_dpp v33, v31, v9 row_newbcast:5 row_mask:0xf bank_mask:0xf
    v_and_b32_dpp v34, v31, v10 row_newbcast:5 row_mask:0xf bank_mask:0xf
    v_and_b32_dpp v35, v31, v11 row_newbcast:5 row_mask:0xf bank_mask:0xf
    s_waitcnt vmcnt(6)
    v_mfma_f32_16x16x32_bf16 v[40:43], v[204:207], v[36:39], v[40:43]
    v_and_b32_dpp v36, v31, v8 row_newbcast:13 row_mask:0xf bank_mask:0xf
    v_and_b32_dpp v37, v31, v9 row_newbcast:13 row_mask:0xf bank_mask:0xf
    v_and_b32_dpp v38, v31, v10 row_newbcast:13 row_mask:0xf bank_mask:0xf
    v_and_b32_dpp v39, v31, v11 row_newbcast:13 row_mask:0xf bank_mask:0xf
    s_waitcnt vmcnt(5)
    v_mfma_f32_16x16x32_bf16 v[40:43], v[208:211], v[32:35], v[40:43]
    v_and_b32_dpp v32, v31, v8 row_newbcast:3 row_mask:0xf bank_mask:0xf
    v_and_b32_dpp v33, v31, v9 row_newbcast:3 row_mask:0xf bank_mask:0xf
    v_and_b32_dpp v34, v31, v10 row_newbcast:3 row_mask:0xf bank_mask:0xf
    v_and_b32_dpp v35, v31, v11 row_newbcast:3 row_mask:0xf bank_mask:0xf
    s_waitcnt vmcnt(4)
    v_mfma_f32_16x16x32_bf16 v[40:43], v[212:215], v[36:39], v[40:43]
    v_and_b32_dpp v36, v31, v8 row_newbcast:11 row_mask:0xf bank_mask:0xf
    v_and_b32_dpp v37, v31, v9 row_newbcast:11 row_mask:0xf bank_mask:0xf
    v_and_b32_dpp v38, v31, v10 row_newbcast:11 row_mask:0xf bank_mask:0xf
    v_and_b32_dpp v39, v31, v11 row_newbcast:11 row_mask:0xf bank_mask:0xf
    s_waitcnt vmcnt(3)
    v_mfma_f32_16x16x32_bf16 v[40:43], v[216:219], v[32:35], v[40:43]
    v_and_b32_dpp v32, v31, v8 row_newbcast:7 row_mask:0xf bank_mask:0xf
    v_and_b32_dpp v33, v31, v9 row_newbcast:7 row_mask:0xf bank_mask:0xf
    v_and_b32_dpp v34, v31, v10 row_newbcast:7 row_mask:0xf bank_mask:0xf
    v_and_b32_dpp v35, v31, v11 row_newbcast:7 row_mask:0xf bank_mask:0xf
    s_waitcnt vmcnt(2)
    v_mfma_f32_16x16x32_bf16 v[40:43], v[220:223], v[36:39], v[40:43]
    v_and_b32_dpp v36, v31, v8 row_newbcast:15 row_mask:0xf bank_mask:0xf
    v_and_b32_dpp v37, v31, v9 row_newbcast:15 row_mask:0xf bank_mask:0xf
    v_and_b32_dpp v38, v31, v10 row_newbcast:15 row_mask:0xf bank_mask:0xf
    v_and_b32_dpp v39, v31, v11 row_newbcast:15 row_mask:0xf bank_mask:0xf
    s_waitcnt vmcnt(1)
    v_mfma_f32_16x16x32_bf16 v[40:43], v[224:227], v[32:35], v[40:43]
    s_waitcnt vmcnt(0)
    v_mfma_f32_16x16x32_bf16 v[40:43], v[228:231], v[36:39], v[40:43]
    s_mov_b64 exec, s[96:97]
    s_nop 6
    ds_write_b32 v7, v40 offset:4096
    ds_write_b32 v7, v41 offset:4128
    ds_write_b32 v7, v42 offset:4160
    ds_write_b32 v7, v43 offset:4192
    s_mov_b64 exec, -1
    s_waitcnt lgkmcnt(0)
    s_barrier
    s_endpgm
L_helper:
    v_lshlrev_b32 v60, 4, v2
    v_lshl_add_u32 v4, v3, 13, v60
    v_lshl_add_u32 v6, v3, 10, v60
    v_min_u32 v61, 6, v2
    v_lshlrev_b32 v61, 4, v61
    s_movk_i32 s7, 3584
    v_mad_u32_u24 v5, v3, s7, v61
    v_lshl_add_u32 v14, v2, 2, v3
    s_mul_i32 s42, s4, 0
    v_add_u32 v20, s42, v2
    v_add_u32 v21, 16, v20
    v_and_b32 v20, 31, v20
    v_and_b32 v21, 31, v21
    v_lshl_add_u32 v56, v20, 2, v3
    v_lshl_add_u32 v57, v21, 2, v3
    s_lshl_b32 s7, s8, 7
    v_add_u32 v61, s7, v56
    v_lshlrev_b32 v61, 1, v61
    v_add_u32 v62, s7, v57
    v_lshlrev_b32 v62, 1, v62
    s_lshl_b32 s10, s8, 20
    s_lshl_b32 s7, s5, 8
    s_add_u32 s10, s10, s7
    s_lshl_b32 s7, s4, 10
    s_waitcnt lgkmcnt(0)
    s_add_u32 s16, s16, s7
    s_addc_u32 s17, s17, 0
    global_load_dwordx4 v[48:51], v1, s[16:17] nt
    global_load_ushort v12, v61, s[16:17] nt
    global_load_ushort v13, v62, s[16:17] nt
    s_mov_b32 s52, s22
    s_mov_b32 s53, s23
    s_mov_b32 s54, 4194304
    s_mov_b32 s55, 0x20000
    s_add_u32 s77, s42, 0
    s_and_b32 s77, s77, 31
    s_mul_i32 s77, s77, 32768
    s_add_u32 s77, s77, s10
    buffer_load_dwordx4 v[64:67], v4, s[52:55], s77 offen
    s_add_u32 s78, s42, 1
    s_and_b32 s78, s78, 31
    s_mul_i32 s78, s78, 32768
    s_add_u32 s78, s78, s10
    buffer_load_dwordx4 v[68:71], v4, s[52:55], s78 offen
    s_add_u32 s79, s42, 2
    s_and_b32 s79, s79, 31
    s_mul_i32 s79, s79, 32768
    s_add_u32 s79, s79, s10
    buffer_load_dwordx4 v[72:75], v4, s[52:55], s79 offen
    s_add_u32 s80, s42, 3
    s_and_b32 s80, s80, 31
    s_mul_i32 s80, s80, 32768
    s_add_u32 s80, s80, s10
    buffer_load_dwordx4 v[76:79], v4, s[52:55], s80 offen
    s_add_u32 s81, s42, 4
    s_and_b32 s81, s81, 31
    s_mul_i32 s81, s81, 32768
    s_add_u32 s81, s81, s10
    buffer_load_dwordx4 v[80:83], v4, s[52:55], s81 offen
    s_add_u32 s82, s42, 5
    s_and_b32 s82, s82, 31
    s_mul_i32 s82, s82, 32768
    s_add_u32 s82, s82, s10
    buffer_load_dwordx4 v[84:87], v4, s[52:55], s82 offen
    s_add_u32 s83, s42, 6
    s_and_b32 s83, s83, 31
    s_mul_i32 s83, s83, 32768
    s_add_u32 s83, s83, s10
    buffer_load_dwordx4 v[88:91], v4, s[52:55], s83 offen
    s_add_u32 s84, s42, 7
    s_and_b32 s84, s84, 31
    s_mul_i32 s84, s84, 32768
    s_add_u32 s84, s84, s10
    buffer_load_dwordx4 v[92:95], v4, s[52:55], s84 offen
    s_add_u32 s85, s42, 8
    s_and_b32 s85, s85, 31
    s_mul_i32 s85, s85, 32768
    s_add_u32 s85, s85, s10
    buffer_load_dwordx4 v[96:99], v4, s[52:55], s85 offen
    s_add_u32 s86, s42, 9
    s_and_b32 s86, s86, 31
    s_mul_i32 s86, s86, 32768
    s_add_u32 s86, s86, s10
    buffer_load_dwordx4 v[100:103], v4, s[52:55], s86 offen
    s_add_u32 s87, s42, 10
    s_and_b32 s87, s87, 31
    s_mul_i32 s87, s87, 32768
    s_add_u32 s87, s87, s10
    buffer_load_dwordx4 v[104:107], v4, s[52:55], s87 offen
    s_add_u32 s88, s42, 11
    s_and_b32 s88, s88, 31
    s_mul_i32 s88, s88, 32768
    s_add_u32 s88, s88, s10
    buffer_load_dwordx4 v[108:111], v4, s[52:55], s88 offen
    s_add_u32 s89, s42, 12
    s_and_b32 s89, s89, 31
    s_mul_i32 s89, s89, 32768
    s_add_u32 s89, s89, s10
    buffer_load_dwordx4 v[112:115], v4, s[52:55], s89 offen
    s_add_u32 s90, s42, 13
    s_and_b32 s90, s90, 31
    s_mul_i32 s90, s90, 32768
    s_add_u32 s90, s90, s10
    buffer_load_dwordx4 v[116:119], v4, s[52:55], s90 offen
    s_add_u32 s91, s42, 14
    s_and_b32 s91, s91, 31
    s_mul_i32 s91, s91, 32768
    s_add_u32 s91, s91, s10
    buffer_load_dwordx4 v[120:123], v4, s[52:55], s91 offen
    s_add_u32 s76, s42, 15
    s_and_b32 s76, s76, 31
    s_mul_i32 s76, s76, 32768
    s_add_u32 s76, s76, s10
    buffer_load_dwordx4 v[124:127], v4, s[52:55], s76 offen
    s_add_u32 s77, s42, 16
    s_and_b32 s77, s77, 31
    s_mul_i32 s77, s77, 32768
    s_add_u32 s77, s77, s10
    buffer_load_dwordx4 v[128:131], v4, s[52:55], s77 offen
    s_add_u32 s78, s42, 17
    s_and_b32 s78, s78, 31
    s_mul_i32 s78, s78, 32768
    s_add_u32 s78, s78, s10
    buffer_load_dwordx4 v[132:135], v4, s[52:55], s78 offen
    s_add_u32 s79, s42, 18
    s_and_b32 s79, s79, 31
    s_mul_i32 s79, s79, 32768
    s_add_u32 s79, s79, s10
    buffer_load_dwordx4 v[136:139], v4, s[52:55], s79 offen
    s_add_u32 s80, s42, 19
    s_and_b32 s80, s80, 31
    s_mul_i32 s80, s80, 32768
    s_add_u32 s80, s80, s10
    buffer_load_dwordx4 v[140:143], v4, s[52:55], s80 offen
    s_add_u32 s81, s42, 20
    s_and_b32 s81, s81, 31
    s_mul_i32 s81, s81, 32768
    s_add_u32 s81, s81, s10
    buffer_load_dwordx4 v[144:147], v4, s[52:55], s81 offen
    s_add_u32 s82, s42, 21
    s_and_b32 s82, s82, 31
    s_mul_i32 s82, s82, 32768
    s_add_u32 s82, s82, s10
    buffer_load_dwordx4 v[148:151], v4, s[52:55], s82 offen
    s_add_u32 s83, s42, 22
    s_and_b32 s83, s83, 31
    s_mul_i32 s83, s83, 32768
    s_add_u32 s83, s83, s10
    buffer_load_dwordx4 v[152:155], v4, s[52:55], s83 offen
    s_add_u32 s84, s42, 23
    s_and_b32 s84, s84, 31
    s_mul_i32 s84, s84, 32768
    s_add_u32 s84, s84, s10
    buffer_load_dwordx4 v[156:159], v4, s[52:55], s84 offen
    s_add_u32 s85, s42, 24
    s_and_b32 s85, s85, 31
    s_mul_i32 s85, s85, 32768
    s_add_u32 s85, s85, s10
    buffer_load_dwordx4 v[160:163], v4, s[52:55], s85 offen
    s_add_u32 s86, s42, 25
    s_and_b32 s86, s86, 31
    s_mul_i32 s86, s86, 32768
    s_add_u32 s86, s86, s10
    buffer_load_dwordx4 v[164:167], v4, s[52:55], s86 offen
    s_add_u32 s87, s42, 26
    s_and_b32 s87, s87, 31
    s_mul_i32 s87, s87, 32768
    s_add_u32 s87, s87, s10
    buffer_load_dwordx4 v[168:171], v4, s[52:55], s87 offen
    s_add_u32 s88, s42, 27
    s_and_b32 s88, s88, 31
    s_mul_i32 s88, s88, 32768
    s_add_u32 s88, s88, s10
    buffer_load_dwordx4 v[172:175], v4, s[52:55], s88 offen
    s_add_u32 s89, s42, 28
    s_and_b32 s89, s89, 31
    s_mul_i32 s89, s89, 32768
    s_add_u32 s89, s89, s10
    buffer_load_dwordx4 v[176:179], v4, s[52:55], s89 offen
    s_add_u32 s90, s42, 29
    s_and_b32 s90, s90, 31
    s_mul_i32 s90, s90, 32768
    s_add_u32 s90, s90, s10
    buffer_load_dwordx4 v[180:183], v4, s[52:55], s90 offen
    s_add_u32 s91, s42, 30
    s_and_b32 s91, s91, 31
    s_mul_i32 s91, s91, 32768
    s_add_u32 s91, s91, s10
    buffer_load_dwordx4 v[184:187], v4, s[52:55], s91 offen
    s_add_u32 s76, s42, 31
    s_and_b32 s76, s76, 31
    s_mul_i32 s76, s76, 32768
    s_add_u32 s76, s76, s10
    buffer_load_dwordx4 v[188:191], v4, s[52:55], s76 offen
    s_mov_b32 s56, s24
    s_mov_b32 s57, s25
    s_mov_b32 s58, 4194304
    s_mov_b32 s59, 0x20000
    s_mov_b32 s60, s28
    s_mov_b32 s61, s29
    s_mov_b32 s62, 1835008
    s_mov_b32 s63, 0x20000
    s_mov_b32 s64, s32
    s_mov_b32 s65, s33
    s_mov_b32 s66, 1835008
    s_mov_b32 s67, 0x20000
    s_mov_b32 s68, s40
    s_mov_b32 s69, s41
    s_mov_b32 s70, 16777216
    s_mov_b32 s71, 0x20000
    s_mov_b32 s72, s36
    s_mov_b32 s73, s37
    s_mov_b32 s74, 8192
    s_mov_b32 s75, 0x20000
    v_lshl_add_u32 v7, v3, 5, v2
    v_lshlrev_b32 v7, 2, v7
    s_lshl_b32 s7, s8, 9
    v_add_u32 v7, s7, v7
    v_mov_b32 v60, 0xffff
    v_mov_b32 v61, 0xffff0000
    v_cmp_eq_u32 vcc, 0, v2
    s_nop 1
    v_cndmask_b32 v8, 0, v60, vcc
    v_cmp_eq_u32 vcc, 1, v2
    s_nop 1
    v_cndmask_b32 v8, v8, v61, vcc
    v_cmp_eq_u32 vcc, 2, v2
    s_nop 1
    v_cndmask_b32 v9, 0, v60, vcc
    v_cmp_eq_u32 vcc, 3, v2
    s_nop 1
    v_cndmask_b32 v9, v9, v61, vcc
    v_cmp_eq_u32 vcc, 4, v2
    s_nop 1
    v_cndmask_b32 v10, 0, v60, vcc
    v_cmp_eq_u32 vcc, 5, v2
    s_nop 1
    v_cndmask_b32 v10, v10, v61, vcc
    v_cmp_eq_u32 vcc, 6, v2
    s_nop 1
    v_cndmask_b32 v11, 0, v60, vcc
    v_cmp_eq_u32 vcc, 7, v2
    s_nop 1
    v_cndmask_b32 v11, v11, v61, vcc
    s_mov_b32 s96, 0x00ff00ff
    s_mov_b32 s97, 0x00ff00ff
    s_mul_i32 s11, s8, 458752
    s_mul_i32 s7, s5, 112
    s_add_u32 s11, s11, s7
    s_lshl_b32 s7, s8, 8
    s_mul_i32 s12, s5, 57344
    s_add_u32 s12, s12, s7
    s_lshl_b32 s13, s5, 17
    s_add_u32 s13, s13, s7
    v_mov_b32 v60, 0
    ds_write_b32 v60, v60 offset:6212
    s_waitcnt vmcnt(34)
    v_lshlrev_b32 v16, 16, v48
    v_and_b32 v17, 0xffff0000, v48
    v_lshlrev_b32 v18, 16, v49
    v_and_b32 v19, 0xffff0000, v49
    v_lshlrev_b32 v20, 16, v50
    v_and_b32 v21, 0xffff0000, v50
    v_lshlrev_b32 v22, 16, v51
    v_and_b32 v23, 0xffff0000, v51
    v_add_f32 v24, v16, v17
    v_add_f32 v25, v18, v19
    v_add_f32 v26, v20, v21
    v_add_f32 v27, v22, v23
    v_add_f32 v24, v24, v25
    v_add_f32 v26, v26, v27
    v_add_f32 v24, v24, v26
    s_nop 1
    v_add_f32_dpp v24, v24, v24 quad_perm:[1,0,3,2] row_mask:0xf bank_mask:0xf
    s_nop 1
    v_add_f32_dpp v24, v24, v24 quad_perm:[2,3,0,1] row_mask:0xf bank_mask:0xf
    s_nop 1
    v_add_f32_dpp v24, v24, v24 row_half_mirror row_mask:0xf bank_mask:0xf
    s_nop 1
    v_add_f32_dpp v24, v24, v24 row_mirror row_mask:0xf bank_mask:0xf
    v_mov_b32 v25, v24
    s_nop 1
    v_permlane16_swap_b32 v24, v25
    v_add_f32 v24, v24, v25
    v_mov_b32 v25, v24
    s_nop 1
    v_permlane32_swap_b32 v24, v25
    v_add_f32 v24, v24, v25
    v_mul_f32 v24, 0x3b000000, v24
    v_sub_f32 v16, v16, v24
    v_sub_f32 v17, v17, v24
    v_sub_f32 v18, v18, v24
    v_sub_f32 v19, v19, v24
    v_sub_f32 v20, v20, v24
    v_sub_f32 v21, v21, v24
    v_sub_f32 v22, v22, v24
    v_sub_f32 v23, v23, v24
    v_mul_f32 v26, v16, v16
    v_mul_f32 v27, v17, v17
    v_fmac_f32 v26, v18, v18
    v_fmac_f32 v27, v19, v19
    v_fmac_f32 v26, v20, v20
    v_fmac_f32 v27, v21, v21
    v_fmac_f32 v26, v22, v22
    v_fmac_f32 v27, v23, v23
    v_add_f32 v26, v26, v27
    s_nop 1
    v_add_f32_dpp v26, v26, v26 quad_perm:[1,0,3,2] row_mask:0xf bank_mask:0xf
    s_nop 1
    v_add_f32_dpp v26, v26, v26 quad_perm:[2,3,0,1] row_mask:0xf bank_mask:0xf
    s_nop 1
    v_add_f32_dpp v26, v26, v26 row_half_mirror row_mask:0xf bank_mask:0xf
    s_nop 1
    v_add_f32_dpp v26, v26, v26 row_mirror row_mask:0xf bank_mask:0xf
    v_mov_b32 v25, v26
    s_nop 1
    v_permlane16_swap_b32 v26, v25
    v_add_f32 v26, v26, v25
    v_mov_b32 v25, v26
    s_nop 1
    v_permlane32_swap_b32 v26, v25
    v_add_f32 v26, v26, v25
    v_mul_f32 v26, 0x3b000000, v26
    v_cvt_pk_bf16_f32 v26, v26, v26
    v_and_b32 v26, 0xffff0000, v26
    v_add_f32 v26, 0x3727c5ac, v26
    v_cvt_pk_bf16_f32 v26, v26, v26
    v_and_b32 v26, 0xffff0000, v26
    v_sqrt_f32 v26, v26
    s_nop 0
    v_cvt_pk_bf16_f32 v26, v26, v26
    v_and_b32 v26, 0xffff0000, v26
    v_rcp_f32 v26, v26
    v_cvt_pk_bf16_f32 v24, v24, v24
    v_and_b32 v24, 0xffff0000, v24
    s_waitcnt vmcnt(32)
    v_lshlrev_b32 v12, 16, v12
    v_sub_f32 v12, v12, v24
    v_cvt_pk_bf16_f32 v12, v12, v12
    v_and_b32 v12, 0xffff0000, v12
    v_mul_f32 v12, v12, v26
    v_cvt_pk_bf16_f32 v12, v12, v12
    v_lshlrev_b32 v13, 16, v13
    v_sub_f32 v13, v13, v24
    v_cvt_pk_bf16_f32 v13, v13, v13
    v_and_b32 v13, 0xffff0000, v13
    v_mul_f32 v13, v13, v26
    v_cvt_pk_bf16_f32 v13, v13, v13
    v_and_b32_dpp v32, v12, v8 row_newbcast:0 row_mask:0xf bank_mask:0xf
    v_and_b32_dpp v33, v12, v9 row_newbcast:0 row_mask:0xf bank_mask:0xf
    v_and_b32_dpp v34, v12, v10 row_newbcast:0 row_mask:0xf bank_mask:0xf
    v_and_b32_dpp v35, v12, v11 row_newbcast:0 row_mask:0xf bank_mask:0xf
    v_and_b32_dpp v36, v12, v8 row_newbcast:1 row_mask:0xf bank_mask:0xf
    v_and_b32_dpp v37, v12, v9 row_newbcast:1 row_mask:0xf bank_mask:0xf
    v_and_b32_dpp v38, v12, v10 row_newbcast:1 row_mask:0xf bank_mask:0xf
    v_and_b32_dpp v39, v12, v11 row_newbcast:1 row_mask:0xf bank_mask:0xf
    s_waitcnt vmcnt(31)
    v_mfma_f32_16x16x32_bf16 v[40:43], v[64:67], v[32:35], 0
    v_and_b32_dpp v32, v12, v8 row_newbcast:2 row_mask:0xf bank_mask:0xf
    v_and_b32_dpp v33, v12, v9 row_newbcast:2 row_mask:0xf bank_mask:0xf
    v_and_b32_dpp v34, v12, v10 row_newbcast:2 row_mask:0xf bank_mask:0xf
    v_and_b32_dpp v35, v12, v11 row_newbcast:2 row_mask:0xf bank_mask:0xf
    s_waitcnt vmcnt(30)
    v_mfma_f32_16x16x32_bf16 v[40:43], v[68:71], v[36:39], v[40:43]
    v_and_b32_dpp v36, v12, v8 row_newbcast:3 row_mask:0xf bank_mask:0xf
    v_and_b32_dpp v37, v12, v9 row_newbcast:3 row_mask:0xf bank_mask:0xf
    v_and_b32_dpp v38, v12, v10 row_newbcast:3 row_mask:0xf bank_mask:0xf
    v_and_b32_dpp v39, v12, v11 row_newbcast:3 row_mask:0xf bank_mask:0xf
    s_waitcnt vmcnt(29)
    v_mfma_f32_16x16x32_bf16 v[40:43], v[72:75], v[32:35], v[40:43]
    v_and_b32_dpp v32, v12, v8 row_newbcast:4 row_mask:0xf bank_mask:0xf
    v_and_b32_dpp v33, v12, v9 row_newbcast:4 row_mask:0xf bank_mask:0xf
    v_and_b32_dpp v34, v12, v10 row_newbcast:4 row_mask:0xf bank_mask:0xf
    v_and_b32_dpp v35, v12, v11 row_newbcast:4 row_mask:0xf bank_mask:0xf
    s_waitcnt vmcnt(28)
    v_mfma_f32_16x16x32_bf16 v[40:43], v[76:79], v[36:39], v[40:43]
    v_and_b32_dpp v36, v12, v8 row_newbcast:5 row_mask:0xf bank_mask:0xf
    v_and_b32_dpp v37, v12, v9 row_newbcast:5 row_mask:0xf bank_mask:0xf
    v_and_b32_dpp v38, v12, v10 row_newbcast:5 row_mask:0xf bank_mask:0xf
    v_and_b32_dpp v39, v12, v11 row_newbcast:5 row_mask:0xf bank_mask:0xf
    s_waitcnt vmcnt(27)
    v_mfma_f32_16x16x32_bf16 v[40:43], v[80:83], v[32:35], v[40:43]
    v_and_b32_dpp v32, v12, v8 row_newbcast:6 row_mask:0xf bank_mask:0xf
    v_and_b32_dpp v33, v12, v9 row_newbcast:6 row_mask:0xf bank_mask:0xf
    v_and_b32_dpp v34, v12, v10 row_newbcast:6 row_mask:0xf bank_mask:0xf
    v_and_b32_dpp v35, v12, v11 row_newbcast:6 row_mask:0xf bank_mask:0xf
    s_waitcnt vmcnt(26)
    v_mfma_f32_16x16x32_bf16 v[40:43], v[84:87], v[36:39], v[40:43]
    v_and_b32_dpp v36, v12, v8 row_newbcast:7 row_mask:0xf bank_mask:0xf
    v_and_b32_dpp v37, v12, v9 row_newbcast:7 row_mask:0xf bank_mask:0xf
    v_and_b32_dpp v38, v12, v10 row_newbcast:7 row_mask:0xf bank_mask:0xf
    v_and_b32_dpp v39, v12, v11 row_newbcast:7 row_mask:0xf bank_mask:0xf
    s_waitcnt vmcnt(25)
    v_mfma_f32_16x16x32_bf16 v[40:43], v[88:91], v[32:35], v[40:43]
    v_and_b32_dpp v32, v12, v8 row_newbcast:8 row_mask:0xf bank_mask:0xf
    v_and_b32_dpp v33, v12, v9 row_newbcast:8 row_mask:0xf bank_mask:0xf
    v_and_b32_dpp v34, v12, v10 row_newbcast:8 row_mask:0xf bank_mask:0xf
    v_and_b32_dpp v35, v12, v11 row_newbcast:8 row_mask:0xf bank_mask:0xf
    s_waitcnt vmcnt(24)
    v_mfma_f32_16x16x32_bf16 v[40:43], v[92:95], v[36:39], v[40:43]
    v_and_b32_dpp v36, v12, v8 row_newbcast:9 row_mask:0xf bank_mask:0xf
    v_and_b32_dpp v37, v12, v9 row_newbcast:9 row_mask:0xf bank_mask:0xf
    v_and_b32_dpp v38, v12, v10 row_newbcast:9 row_mask:0xf bank_mask:0xf
    v_and_b32_dpp v39, v12, v11 row_newbcast:9 row_mask:0xf bank_mask:0xf
    s_waitcnt vmcnt(23)
    v_mfma_f32_16x16x32_bf16 v[40:43], v[96:99], v[32:35], v[40:43]
    v_and_b32_dpp v32, v12, v8 row_newbcast:10 row_mask:0xf bank_mask:0xf
    v_and_b32_dpp v33, v12, v9 row_newbcast:10 row_mask:0xf bank_mask:0xf
    v_and_b32_dpp v34, v12, v10 row_newbcast:10 row_mask:0xf bank_mask:0xf
    v_and_b32_dpp v35, v12, v11 row_newbcast:10 row_mask:0xf bank_mask:0xf
    s_waitcnt vmcnt(22)
    v_mfma_f32_16x16x32_bf16 v[40:43], v[100:103], v[36:39], v[40:43]
    v_and_b32_dpp v36, v12, v8 row_newbcast:11 row_mask:0xf bank_mask:0xf
    v_and_b32_dpp v37, v12, v9 row_newbcast:11 row_mask:0xf bank_mask:0xf
    v_and_b32_dpp v38, v12, v10 row_newbcast:11 row_mask:0xf bank_mask:0xf
    v_and_b32_dpp v39, v12, v11 row_newbcast:11 row_mask:0xf bank_mask:0xf
    s_waitcnt vmcnt(21)
    v_mfma_f32_16x16x32_bf16 v[40:43], v[104:107], v[32:35], v[40:43]
    v_and_b32_dpp v32, v12, v8 row_newbcast:12 row_mask:0xf bank_mask:0xf
    v_and_b32_dpp v33, v12, v9 row_newbcast:12 row_mask:0xf bank_mask:0xf
    v_and_b32_dpp v34, v12, v10 row_newbcast:12 row_mask:0xf bank_mask:0xf
    v_and_b32_dpp v35, v12, v11 row_newbcast:12 row_mask:0xf bank_mask:0xf
    s_waitcnt vmcnt(20)
    v_mfma_f32_16x16x32_bf16 v[40:43], v[108:111], v[36:39], v[40:43]
    v_and_b32_dpp v36, v12, v8 row_newbcast:13 row_mask:0xf bank_mask:0xf
    v_and_b32_dpp v37, v12, v9 row_newbcast:13 row_mask:0xf bank_mask:0xf
    v_and_b32_dpp v38, v12, v10 row_newbcast:13 row_mask:0xf bank_mask:0xf
    v_and_b32_dpp v39, v12, v11 row_newbcast:13 row_mask:0xf bank_mask:0xf
    s_waitcnt vmcnt(19)
    v_mfma_f32_16x16x32_bf16 v[40:43], v[112:115], v[32:35], v[40:43]
    v_and_b32_dpp v32, v12, v8 row_newbcast:14 row_mask:0xf bank_mask:0xf
    v_and_b32_dpp v33, v12, v9 row_newbcast:14 row_mask:0xf bank_mask:0xf
    v_and_b32_dpp v34, v12, v10 row_newbcast:14 row_mask:0xf bank_mask:0xf
    v_and_b32_dpp v35, v12, v11 row_newbcast:14 row_mask:0xf bank_mask:0xf
    s_waitcnt vmcnt(18)
    v_mfma_f32_16x16x32_bf16 v[40:43], v[116:119], v[36:39], v[40:43]
    v_and_b32_dpp v36, v12, v8 row_newbcast:15 row_mask:0xf bank_mask:0xf
    v_and_b32_dpp v37, v12, v9 row_newbcast:15 row_mask:0xf bank_mask:0xf
    v_and_b32_dpp v38, v12, v10 row_newbcast:15 row_mask:0xf bank_mask:0xf
    v_and_b32_dpp v39, v12, v11 row_newbcast:15 row_mask:0xf bank_mask:0xf
    s_waitcnt vmcnt(17)
    v_mfma_f32_16x16x32_bf16 v[40:43], v[120:123], v[32:35], v[40:43]
    v_and_b32_dpp v32, v13, v8 row_newbcast:0 row_mask:0xf bank_mask:0xf
    v_and_b32_dpp v33, v13, v9 row_newbcast:0 row_mask:0xf bank_mask:0xf
    v_and_b32_dpp v34, v13, v10 row_newbcast:0 row_mask:0xf bank_mask:0xf
    v_and_b32_dpp v35, v13, v11 row_newbcast:0 row_mask:0xf bank_mask:0xf
    s_waitcnt vmcnt(16)
    v_mfma_f32_16x16x32_bf16 v[40:43], v[124:127], v[36:39], v[40:43]
    v_and_b32_dpp v36, v13, v8 row_newbcast:1 row_mask:0xf bank_mask:0xf
    v_and_b32_dpp v37, v13, v9 row_newbcast:1 row_mask:0xf bank_mask:0xf
    v_and_b32_dpp v38, v13, v10 row_newbcast:1 row_mask:0xf bank_mask:0xf
    v_and_b32_dpp v39, v13, v11 row_newbcast:1 row_mask:0xf bank_mask:0xf
    s_waitcnt vmcnt(15)
    v_mfma_f32_16x16x32_bf16 v[40:43], v[128:131], v[32:35], v[40:43]
    v_and_b32_dpp v32, v13, v8 row_newbcast:2 row_mask:0xf bank_mask:0xf
    v_and_b32_dpp v33, v13, v9 row_newbcast:2 row_mask:0xf bank_mask:0xf
    v_and_b32_dpp v34, v13, v10 row_newbcast:2 row_mask:0xf bank_mask:0xf
    v_and_b32_dpp v35, v13, v11 row_newbcast:2 row_mask:0xf bank_mask:0xf
    s_waitcnt vmcnt(14)
    v_mfma_f32_16x16x32_bf16 v[40:43], v[132:135], v[36:39], v[40:43]
    v_and_b32_dpp v36, v13, v8 row_newbcast:3 row_mask:0xf bank_mask:0xf
    v_and_b32_dpp v37, v13, v9 row_newbcast:3 row_mask:0xf bank_mask:0xf
    v_and_b32_dpp v38, v13, v10 row_newbcast:3 row_mask:0xf bank_mask:0xf
    v_and_b32_dpp v39, v13, v11 row_newbcast:3 row_mask:0xf bank_mask:0xf
    s_waitcnt vmcnt(13)
    v_mfma_f32_16x16x32_bf16 v[40:43], v[136:139], v[32:35], v[40:43]
    v_and_b32_dpp v32, v13, v8 row_newbcast:4 row_mask:0xf bank_mask:0xf
    v_and_b32_dpp v33, v13, v9 row_newbcast:4 row_mask:0xf bank_mask:0xf
    v_and_b32_dpp v34, v13, v10 row_newbcast:4 row_mask:0xf bank_mask:0xf
    v_and_b32_dpp v35, v13, v11 row_newbcast:4 row_mask:0xf bank_mask:0xf
    s_waitcnt vmcnt(12)
    v_mfma_f32_16x16x32_bf16 v[40:43], v[140:143], v[36:39], v[40:43]
    v_and_b32_dpp v36, v13, v8 row_newbcast:5 row_mask:0xf bank_mask:0xf
    v_and_b32_dpp v37, v13, v9 row_newbcast:5 row_mask:0xf bank_mask:0xf
    v_and_b32_dpp v38, v13, v10 row_newbcast:5 row_mask:0xf bank_mask:0xf
    v_and_b32_dpp v39, v13, v11 row_newbcast:5 row_mask:0xf bank_mask:0xf
    s_waitcnt vmcnt(11)
    v_mfma_f32_16x16x32_bf16 v[40:43], v[144:147], v[32:35], v[40:43]
    v_and_b32_dpp v32, v13, v8 row_newbcast:6 row_mask:0xf bank_mask:0xf
    v_and_b32_dpp v33, v13, v9 row_newbcast:6 row_mask:0xf bank_mask:0xf
    v_and_b32_dpp v34, v13, v10 row_newbcast:6 row_mask:0xf bank_mask:0xf
    v_and_b32_dpp v35, v13, v11 row_newbcast:6 row_mask:0xf bank_mask:0xf
    s_waitcnt vmcnt(10)
    v_mfma_f32_16x16x32_bf16 v[40:43], v[148:151], v[36:39], v[40:43]
    v_and_b32_dpp v36, v13, v8 row_newbcast:7 row_mask:0xf bank_mask:0xf
    v_and_b32_dpp v37, v13, v9 row_newbcast:7 row_mask:0xf bank_mask:0xf
    v_and_b32_dpp v38, v13, v10 row_newbcast:7 row_mask:0xf bank_mask:0xf
    v_and_b32_dpp v39, v13, v11 row_newbcast:7 row_mask:0xf bank_mask:0xf
    s_waitcnt vmcnt(9)
    v_mfma_f32_16x16x32_bf16 v[40:43], v[152:155], v[32:35], v[40:43]
    v_and_b32_dpp v32, v13, v8 row_newbcast:8 row_mask:0xf bank_mask:0xf
    v_and_b32_dpp v33, v13, v9 row_newbcast:8 row_mask:0xf bank_mask:0xf
    v_and_b32_dpp v34, v13, v10 row_newbcast:8 row_mask:0xf bank_mask:0xf
    v_and_b32_dpp v35, v13, v11 row_newbcast:8 row_mask:0xf bank_mask:0xf
    s_waitcnt vmcnt(8)
    v_mfma_f32_16x16x32_bf16 v[40:43], v[156:159], v[36:39], v[40:43]
    v_and_b32_dpp v36, v13, v8 row_newbcast:9 row_mask:0xf bank_mask:0xf
    v_and_b32_dpp v37, v13, v9 row_newbcast:9 row_mask:0xf bank_mask:0xf
    v_and_b32_dpp v38, v13, v10 row_newbcast:9 row_mask:0xf bank_mask:0xf
    v_and_b32_dpp v39, v13, v11 row_newbcast:9 row_mask:0xf bank_mask:0xf
    s_waitcnt vmcnt(7)
    v_mfma_f32_16x16x32_bf16 v[40:43], v[160:163], v[32:35], v[40:43]
    v_and_b32_dpp v32, v13, v8 row_newbcast:10 row_mask:0xf bank_mask:0xf
    v_and_b32_dpp v33, v13, v9 row_newbcast:10 row_mask:0xf bank_mask:0xf
    v_and_b32_dpp v34, v13, v10 row_newbcast:10 row_mask:0xf bank_mask:0xf
    v_and_b32_dpp v35, v13, v11 row_newbcast:10 row_mask:0xf bank_mask:0xf
    s_waitcnt vmcnt(6)
    v_mfma_f32_16x16x32_bf16 v[40:43], v[164:167], v[36:39], v[40:43]
    v_and_b32_dpp v36, v13, v8 row_newbcast:11 row_mask:0xf bank_mask:0xf
    v_and_b32_dpp v37, v13, v9 row_newbcast:11 row_mask:0xf bank_mask:0xf
    v_and_b32_dpp v38, v13, v10 row_newbcast:11 row_mask:0xf bank_mask:0xf
    v_and_b32_dpp v39, v13, v11 row_newbcast:11 row_mask:0xf bank_mask:0xf
    s_waitcnt vmcnt(5)
    v_mfma_f32_16x16x32_bf16 v[40:43], v[168:171], v[32:35], v[40:43]
    v_and_b32_dpp v32, v13, v8 row_newbcast:12 row_mask:0xf bank_mask:0xf
    v_and_b32_dpp v33, v13, v9 row_newbcast:12 row_mask:0xf bank_mask:0xf
    v_and_b32_dpp v34, v13, v10 row_newbcast:12 row_mask:0xf bank_mask:0xf
    v_and_b32_dpp v35, v13, v11 row_newbcast:12 row_mask:0xf bank_mask:0xf
    s_waitcnt vmcnt(4)
    v_mfma_f32_16x16x32_bf16 v[40:43], v[172:175], v[36:39], v[40:43]
    v_and_b32_dpp v36, v13, v8 row_newbcast:13 row_mask:0xf bank_mask:0xf
    v_and_b32_dpp v37, v13, v9 row_newbcast:13 row_mask:0xf bank_mask:0xf
    v_and_b32_dpp v38, v13, v10 row_newbcast:13 row_mask:0xf bank_mask:0xf
    v_and_b32_dpp v39, v13, v11 row_newbcast:13 row_mask:0xf bank_mask:0xf
    s_waitcnt vmcnt(3)
    v_mfma_f32_16x16x32_bf16 v[40:43], v[176:179], v[32:35], v[40:43]
    v_and_b32_dpp v32, v13, v8 row_newbcast:14 row_mask:0xf bank_mask:0xf
    v_and_b32_dpp v33, v13, v9 row_newbcast:14 row_mask:0xf bank_mask:0xf
    v_and_b32_dpp v34, v13, v10 row_newbcast:14 row_mask:0xf bank_mask:0xf
    v_and_b32_dpp v35, v13, v11 row_newbcast:14 row_mask:0xf bank_mask:0xf
    s_waitcnt vmcnt(2)
    v_mfma_f32_16x16x32_bf16 v[40:43], v[180:183], v[36:39], v[40:43]
    v_and_b32_dpp v36, v13, v8 row_newbcast:15 row_mask:0xf bank_mask:0xf
    v_and_b32_dpp v37, v13, v9 row_newbcast:15 row_mask:0xf bank_mask:0xf
    v_and_b32_dpp v38, v13, v10 row_newbcast:15 row_mask:0xf bank_mask:0xf
    v_and_b32_dpp v39, v13, v11 row_newbcast:15 row_mask:0xf bank_mask:0xf
    s_waitcnt vmcnt(1)
    v_mfma_f32_16x16x32_bf16 v[40:43], v[184:187], v[32:35], v[40:43]
    s_waitcnt vmcnt(0)
    v_mfma_f32_16x16x32_bf16 v[40:43], v[188:191], v[36:39], v[40:43]
    s_mov_b64 exec, s[96:97]
    s_nop 6
    ds_write_b32 v7, v40 offset:0
    ds_write_b32 v7, v41 offset:32
    ds_write_b32 v7, v42 offset:64
    ds_write_b32 v7, v43 offset:96
    s_mov_b64 exec, -1
    s_waitcnt lgkmcnt(0)
    s_barrier
    s_or_b32 s7, s5, s8
    s_cmp_lg_u32 s7, 0
    s_cbranch_scc1 L_nozero
    s_lshl_b32 s7, s4, 5
    v_mov_b32 v58, s7
L_sbtry0:
    v_mov_b32 v60, 1
    v_mov_b32 v61, 0
    s_mov_b64 exec, 1
    global_atomic_cmpswap v59, v58, v[60:61], s[38:39] sc0
    s_waitcnt vmcnt(0)
    v_readfirstlane_b32 s7, v59
    s_mov_b64 exec, -1
    s_cmp_eq_u32 s7, 2
    s_cbranch_scc1 L_sbdone0
    s_cmp_eq_u32 s7, 0
    s_cbranch_scc1 L_sbzero0
    s_sleep 8
    s_branch L_sbtry0
L_sbzero0:
    s_lshl_b32 s7, s4, 11
    s_add_u32 s7, s7, 1310720
    v_lshlrev_b32 v60, 8, v0
    s_mov_b64 exec, 0xff
    buffer_store_dword v61, v60, s[68:71], s7 offen sc1
    s_waitcnt vmcnt(0)
    v_mov_b32 v60, 2
    s_mov_b64 exec, 1
    global_store_dword v58, v60, s[38:39] sc1
    s_mov_b64 exec, -1
    s_waitcnt vmcnt(0)
    s_nop 0
L_sbdone0:
L_nozero:
    v_min_u32 v60, 55, v14
    s_mul_i32 s7, s5, 56
    v_add_u32 v60, s7, v60
    v_lshlrev_b32 v60, 1, v60
    global_load_ushort v15, v60, s[30:31] nt
    v_and_b32 v60, 7, v0
    v_bfe_u32 v61, v0, 3, 2
    v_lshl_add_u32 v60, v61, 5, v60
    v_lshlrev_b32 v28, 1, v60
    s_lshl_b32 s7, s8, 8
    v_add_u32 v29, s7, v28
    global_load_ushort v16, v29, s[16:17] offset:0 nt
    global_load_ushort v17, v29, s[16:17] offset:16 nt
    global_load_ushort v18, v29, s[16:17] offset:32 nt
    global_load_ushort v19, v29, s[16:17] offset:48 nt
    s_add_u32 s77, s42, 0
    s_and_b32 s77, s77, 31
    s_mul_i32 s77, s77, 14336
    s_add_u32 s77, s77, s11
    buffer_load_dwordx4 v[64:67], v5, s[60:63], s77 offen
    s_add_u32 s78, s42, 1
    s_and_b32 s78, s78, 31
    s_mul_i32 s78, s78, 14336
    s_add_u32 s78, s78, s11
    buffer_load_dwordx4 v[68:71], v5, s[60:63], s78 offen
    v_and_b32_dpp v32, v12, v8 row_newbcast:0 row_mask:0xf bank_mask:0xf
    v_and_b32_dpp v33, v12, v9 row_newbcast:0 row_mask:0xf bank_mask:0xf
    v_and_b32_dpp v34, v12, v10 row_newbcast:0 row_mask:0xf bank_mask:0xf
    v_and_b32_dpp v35, v12, v11 row_newbcast:0 row_mask:0xf bank_mask:0xf
    s_waitcnt vmcnt(1)
    s_nop 0
    v_mfma_f32_16x16x32_bf16 v[40:43], v[64:67], v[32:35], 0
    s_add_u32 s79, s42, 2
    s_and_b32 s79, s79, 31
    s_mul_i32 s79, s79, 14336
    s_add_u32 s79, s79, s11
    buffer_load_dwordx4 v[72:75], v5, s[60:63], s79 offen
    v_and_b32_dpp v36, v12, v8 row_newbcast:1 row_mask:0xf bank_mask:0xf
    v_and_b32_dpp v37, v12, v9 row_newbcast:1 row_mask:0xf bank_mask:0xf
    v_and_b32_dpp v38, v12, v10 row_newbcast:1 row_mask:0xf bank_mask:0xf
    v_and_b32_dpp v39, v12, v11 row_newbcast:1 row_mask:0xf bank_mask:0xf
    s_waitcnt vmcnt(1)
    s_nop 0
    v_mfma_f32_16x16x32_bf16 v[40:43], v[68:71], v[36:39], v[40:43]
    s_add_u32 s80, s42, 3
    s_and_b32 s80, s80, 31
    s_mul_i32 s80, s80, 14336
    s_add_u32 s80, s80, s11
    buffer_load_dwordx4 v[76:79], v5, s[60:63], s80 offen
    v_and_b32_dpp v32, v12, v8 row_newbcast:2 row_mask:0xf bank_mask:0xf
    v_and_b32_dpp v33, v12, v9 row_newbcast:2 row_mask:0xf bank_mask:0xf
    v_and_b32_dpp v34, v12, v10 row_newbcast:2 row_mask:0xf bank_mask:0xf
    v_and_b32_dpp v35, v12, v11 row_newbcast:2 row_mask:0xf bank_mask:0xf
    s_waitcnt vmcnt(1)
    s_nop 0
    v_mfma_f32_16x16x32_bf16 v[40:43], v[72:75], v[32:35], v[40:43]
    s_add_u32 s81, s42, 4
    s_and_b32 s81, s81, 31
    s_mul_i32 s81, s81, 14336
    s_add_u32 s81, s81, s11
    buffer_load_dwordx4 v[80:83], v5, s[60:63], s81 offen
    v_and_b32_dpp v36, v12, v8 row_newbcast:3 row_mask:0xf bank_mask:0xf
    v_and_b32_dpp v37, v12, v9 row_newbcast:3 row_mask:0xf bank_mask:0xf
    v_and_b32_dpp v38, v12, v10 row_newbcast:3 row_mask:0xf bank_mask:0xf
    v_and_b32_dpp v39, v12, v11 row_newbcast:3 row_mask:0xf bank_mask:0xf
    s_waitcnt vmcnt(1)
    s_nop 0
    v_mfma_f32_16x16x32_bf16 v[40:43], v[76:79], v[36:39], v[40:43]
    s_add_u32 s82, s42, 5
    s_and_b32 s82, s82, 31
    s_mul_i32 s82, s82, 14336
    s_add_u32 s82, s82, s11
    buffer_load_dwordx4 v[84:87], v5, s[60:63], s82 offen
    v_and_b32_dpp v32, v12, v8 row_newbcast:4 row_mask:0xf bank_mask:0xf
    v_and_b32_dpp v33, v12, v9 row_newbcast:4 row_mask:0xf bank_mask:0xf
    v_and_b32_dpp v34, v12, v10 row_newbcast:4 row_mask:0xf bank_mask:0xf
    v_and_b32_dpp v35, v12, v11 row_newbcast:4 row_mask:0xf bank_mask:0xf
    s_waitcnt vmcnt(1)
    s_nop 0
    v_mfma_f32_16x16x32_bf16 v[40:43], v[80:83], v[32:35], v[40:43]
    s_add_u32 s83, s42, 6
    s_and_b32 s83, s83, 31
    s_mul_i32 s83, s83, 14336
    s_add_u32 s83, s83, s11
    buffer_load_dwordx4 v[88:91], v5, s[60:63], s83 offen
    v_and_b32_dpp v36, v12, v8 row_newbcast:5 row_mask:0xf bank_mask:0xf
    v_and_b32_dpp v37, v12, v9 row_newbcast:5 row_mask:0xf bank_mask:0xf
    v_and_b32_dpp v38, v12, v10 row_newbcast:5 row_mask:0xf bank_mask:0xf
    v_and_b32_dpp v39, v12, v11 row_newbcast:5 row_mask:0xf bank_mask:0xf
    s_waitcnt vmcnt(1)
    s_nop 0
    v_mfma_f32_16x16x32_bf16 v[40:43], v[84:87], v[36:39], v[40:43]
    s_add_u32 s84, s42, 7
    s_and_b32 s84, s84, 31
    s_mul_i32 s84, s84, 14336
    s_add_u32 s84, s84, s11
    buffer_load_dwordx4 v[92:95], v5, s[60:63], s84 offen
    v_and_b32_dpp v32, v12, v8 row_newbcast:6 row_mask:0xf bank_mask:0xf
    v_and_b32_dpp v33, v12, v9 row_newbcast:6 row_mask:0xf bank_mask:0xf
    v_and_b32_dpp v34, v12, v10 row_newbcast:6 row_mask:0xf bank_mask:0xf
    v_and_b32_dpp v35, v12, v11 row_newbcast:6 row_mask:0xf bank_mask:0xf
    s_waitcnt vmcnt(1)
    s_nop 0
    v_mfma_f32_16x16x32_bf16 v[40:43], v[88:91], v[32:35], v[40:43]
    s_add_u32 s85, s42, 8
    s_and_b32 s85, s85, 31
    s_mul_i32 s85, s85, 14336
    s_add_u32 s85, s85, s11
    buffer_load_dwordx4 v[96:99], v5, s[60:63], s85 offen
    v_and_b32_dpp v36, v12, v8 row_newbcast:7 row_mask:0xf bank_mask:0xf
    v_and_b32_dpp v37, v12, v9 row_newbcast:7 row_mask:0xf bank_mask:0xf
    v_and_b32_dpp v38, v12, v10 row_newbcast:7 row_mask:0xf bank_mask:0xf
    v_and_b32_dpp v39, v12, v11 row_newbcast:7 row_mask:0xf bank_mask:0xf
    s_waitcnt vmcnt(1)
    s_nop 0
    v_mfma_f32_16x16x32_bf16 v[40:43], v[92:95], v[36:39], v[40:43]
    s_add_u32 s86, s42, 9
    s_and_b32 s86, s86, 31
    s_mul_i32 s86, s86, 14336
    s_add_u32 s86, s86, s11
    buffer_load_dwordx4 v[100:103], v5, s[60:63], s86 offen
    v_and_b32_dpp v32, v12, v8 row_newbcast:8 row_mask:0xf bank_mask:0xf
    v_and_b32_dpp v33, v12, v9 row_newbcast:8 row_mask:0xf bank_mask:0xf
    v_and_b32_dpp v34, v12, v10 row_newbcast:8 row_mask:0xf bank_mask:0xf
    v_and_b32_dpp v35, v12, v11 row_newbcast:8 row_mask:0xf bank_mask:0xf
    s_waitcnt vmcnt(1)
    s_nop 0
    v_mfma_f32_16x16x32_bf16 v[40:43], v[96:99], v[32:35], v[40:43]
    s_add_u32 s87, s42, 10
    s_and_b32 s87, s87, 31
    s_mul_i32 s87, s87, 14336
    s_add_u32 s87, s87, s11
    buffer_load_dwordx4 v[104:107], v5, s[60:63], s87 offen
    v_and_b32_dpp v36, v12, v8 row_newbcast:9 row_mask:0xf bank_mask:0xf
    v_and_b32_dpp v37, v12, v9 row_newbcast:9 row_mask:0xf bank_mask:0xf
    v_and_b32_dpp v38, v12, v10 row_newbcast:9 row_mask:0xf bank_mask:0xf
    v_and_b32_dpp v39, v12, v11 row_newbcast:9 row_mask:0xf bank_mask:0xf
    s_waitcnt vmcnt(1)
    s_nop 0
    v_mfma_f32_16x16x32_bf16 v[40:43], v[100:103], v[36:39], v[40:43]
    s_add_u32 s88, s42, 11
    s_and_b32 s88, s88, 31
    s_mul_i32 s88, s88, 14336
    s_add_u32 s88, s88, s11
    buffer_load_dwordx4 v[108:111], v5, s[60:63], s88 offen
    v_and_b32_dpp v32, v12, v8 row_newbcast:10 row_mask:0xf bank_mask:0xf
    v_and_b32_dpp v33, v12, v9 row_newbcast:10 row_mask:0xf bank_mask:0xf
    v_and_b32_dpp v34, v12, v10 row_newbcast:10 row_mask:0xf bank_mask:0xf
    v_and_b32_dpp v35, v12, v11 row_newbcast:10 row_mask:0xf bank_mask:0xf
    s_waitcnt vmcnt(1)
    s_nop 0
    v_mfma_f32_16x16x32_bf16 v[40:43], v[104:107], v[32:35], v[40:43]
    s_add_u32 s89, s42, 12
    s_and_b32 s89, s89, 31
    s_mul_i32 s89, s89, 14336
    s_add_u32 s89, s89, s11
    buffer_load_dwordx4 v[112:115], v5, s[60:63], s89 offen
    v_and_b32_dpp v36, v12, v8 row_newbcast:11 row_mask:0xf bank_mask:0xf
    v_and_b32_dpp v37, v12, v9 row_newbcast:11 row_mask:0xf bank_mask:0xf
    v_and_b32_dpp v38, v12, v10 row_newbcast:11 row_mask:0xf bank_mask:0xf
    v_and_b32_dpp v39, v12, v11 row_newbcast:11 row_mask:0xf bank_mask:0xf
    s_waitcnt vmcnt(1)
    s_nop 0
    v_mfma_f32_16x16x32_bf16 v[40:43], v[108:111], v[36:39], v[40:43]
    s_add_u32 s90, s42, 13
    s_and_b32 s90, s90, 31
    s_mul_i32 s90, s90, 14336
    s_add_u32 s90, s90, s11
    buffer_load_dwordx4 v[116:119], v5, s[60:63], s90 offen
    v_and_b32_dpp v32, v12, v8 row_newbcast:12 row_mask:0xf bank_mask:0xf
    v_and_b32_dpp v33, v12, v9 row_newbcast:12 row_mask:0xf bank_mask:0xf
    v_and_b32_dpp v34, v12, v10 row_newbcast:12 row_mask:0xf bank_mask:0xf
    v_and_b32_dpp v35, v12, v11 row_newbcast:12 row_mask:0xf bank_mask:0xf
    s_waitcnt vmcnt(1)
    s_nop 0
    v_mfma_f32_16x16x32_bf16 v[40:43], v[112:115], v[32:35], v[40:43]
    s_add_u32 s91, s42, 14
    s_and_b32 s91, s91, 31
    s_mul_i32 s91, s91, 14336
    s_add_u32 s91, s91, s11
    buffer_load_dwordx4 v[120:123], v5, s[60:63], s91 offen
    v_and_b32_dpp v36, v12, v8 row_newbcast:13 row_mask:0xf bank_mask:0xf
    v_and_b32_dpp v37, v12, v9 row_newbcast:13 row_mask:0xf bank_mask:0xf
    v_and_b32_dpp v38, v12, v10 row_newbcast:13 row_mask:0xf bank_mask:0xf
    v_and_b32_dpp v39, v12, v11 row_newbcast:13 row_mask:0xf bank_mask:0xf
    s_waitcnt vmcnt(1)
    s_nop 0
    v_mfma_f32_16x16x32_bf16 v[40:43], v[116:119], v[36:39], v[40:43]
    s_add_u32 s76, s42, 15
    s_and_b32 s76, s76, 31
    s_mul_i32 s76, s76, 14336
    s_add_u32 s76, s76, s11
    buffer_load_dwordx4 v[124:127], v5, s[60:63], s76 offen
    v_and_b32_dpp v32, v12, v8 row_newbcast:14 row_mask:0xf bank_mask:0xf
    v_and_b32_dpp v33, v12, v9 row_newbcast:14 row_mask:0xf bank_mask:0xf
    v_and_b32_dpp v34, v12, v10 row_newbcast:14 row_mask:0xf bank_mask:0xf
    v_and_b32_dpp v35, v12, v11 row_newbcast:14 row_mask:0xf bank_mask:0xf
    s_waitcnt vmcnt(1)
    s_nop 0
    v_mfma_f32_16x16x32_bf16 v[40:43], v[120:123], v[32:35], v[40:43]
    s_add_u32 s77, s42, 16
    s_and_b32 s77, s77, 31
    s_mul_i32 s77, s77, 14336
    s_add_u32 s77, s77, s11
    buffer_load_dwordx4 v[128:131], v5, s[60:63], s77 offen
    v_and_b32_dpp v36, v12, v8 row_newbcast:15 row_mask:0xf bank_mask:0xf
    v_and_b32_dpp v37, v12, v9 row_newbcast:15 row_mask:0xf bank_mask:0xf
    v_and_b32_dpp v38, v12, v10 row_newbcast:15 row_mask:0xf bank_mask:0xf
    v_and_b32_dpp v39, v12, v11 row_newbcast:15 row_mask:0xf bank_mask:0xf
    s_waitcnt vmcnt(1)
    s_nop 0
    v_mfma_f32_16x16x32_bf16 v[40:43], v[124:127], v[36:39], v[40:43]
    s_add_u32 s78, s42, 17
    s_and_b32 s78, s78, 31
    s_mul_i32 s78, s78, 14336
    s_add_u32 s78, s78, s11
    buffer_load_dwordx4 v[132:135], v5, s[60:63], s78 offen
    v_and_b32_dpp v32, v13, v8 row_newbcast:0 row_mask:0xf bank_mask:0xf
    v_and_b32_dpp v33, v13, v9 row_newbcast:0 row_mask:0xf bank_mask:0xf
    v_and_b32_dpp v34, v13, v10 row_newbcast:0 row_mask:0xf bank_mask:0xf
    v_and_b32_dpp v35, v13, v11 row_newbcast:0 row_mask:0xf bank_mask:0xf
    s_waitcnt vmcnt(1)
    s_nop 0
    v_mfma_f32_16x16x32_bf16 v[40:43], v[128:131], v[32:35], v[40:43]
    s_add_u32 s79, s42, 18
    s_and_b32 s79, s79, 31
    s_mul_i32 s79, s79, 14336
    s_add_u32 s79, s79, s11
    buffer_load_dwordx4 v[136:139], v5, s[60:63], s79 offen
    v_and_b32_dpp v36, v13, v8 row_newbcast:1 row_mask:0xf bank_mask:0xf
    v_and_b32_dpp v37, v13, v9 row_newbcast:1 row_mask:0xf bank_mask:0xf
    v_and_b32_dpp v38, v13, v10 row_newbcast:1 row_mask:0xf bank_mask:0xf
    v_and_b32_dpp v39, v13, v11 row_newbcast:1 row_mask:0xf bank_mask:0xf
    s_waitcnt vmcnt(1)
    s_nop 0
    v_mfma_f32_16x16x32_bf16 v[40:43], v[132:135], v[36:39], v[40:43]
    s_add_u32 s80, s42, 19
    s_and_b32 s80, s80, 31
    s_mul_i32 s80, s80, 14336
    s_add_u32 s80, s80, s11
    buffer_load_dwordx4 v[140:143], v5, s[60:63], s80 offen
    v_and_b32_dpp v32, v13, v8 row_newbcast:2 row_mask:0xf bank_mask:0xf
    v_and_b32_dpp v33, v13, v9 row_newbcast:2 row_mask:0xf bank_mask:0xf
    v_and_b32_dpp v34, v13, v10 row_newbcast:2 row_mask:0xf bank_mask:0xf
    v_and_b32_dpp v35, v13, v11 row_newbcast:2 row_mask:0xf bank_mask:0xf
    s_waitcnt vmcnt(1)
    s_nop 0
    v_mfma_f32_16x16x32_bf16 v[40:43], v[136:139], v[32:35], v[40:43]
    s_add_u32 s81, s42, 20
    s_and_b32 s81, s81, 31
    s_mul_i32 s81, s81, 14336
    s_add_u32 s81, s81, s11
    buffer_load_dwordx4 v[144:147], v5, s[60:63], s81 offen
    v_and_b32_dpp v36, v13, v8 row_newbcast:3 row_mask:0xf bank_mask:0xf
    v_and_b32_dpp v37, v13, v9 row_newbcast:3 row_mask:0xf bank_mask:0xf
    v_and_b32_dpp v38, v13, v10 row_newbcast:3 row_mask:0xf bank_mask:0xf
    v_and_b32_dpp v39, v13, v11 row_newbcast:3 row_mask:0xf bank_mask:0xf
    s_waitcnt vmcnt(1)
    s_nop 0
    v_mfma_f32_16x16x32_bf16 v[40:43], v[140:143], v[36:39], v[40:43]
    s_add_u32 s82, s42, 21
    s_and_b32 s82, s82, 31
    s_mul_i32 s82, s82, 14336
    s_add_u32 s82, s82, s11
    buffer_load_dwordx4 v[148:151], v5, s[60:63], s82 offen
    v_and_b32_dpp v32, v13, v8 row_newbcast:4 row_mask:0xf bank_mask:0xf
    v_and_b32_dpp v33, v13, v9 row_newbcast:4 row_mask:0xf bank_mask:0xf
    v_and_b32_dpp v34, v13, v10 row_newbcast:4 row_mask:0xf bank_mask:0xf
    v_and_b32_dpp v35, v13, v11 row_newbcast:4 row_mask:0xf bank_mask:0xf
    s_waitcnt vmcnt(1)
    s_nop 0
    v_mfma_f32_16x16x32_bf16 v[40:43], v[144:147], v[32:35], v[40:43]
    s_add_u32 s83, s42, 22
    s_and_b32 s83, s83, 31
    s_mul_i32 s83, s83, 14336
    s_add_u32 s83, s83, s11
    buffer_load_dwordx4 v[152:155], v5, s[60:63], s83 offen
    v_and_b32_dpp v36, v13, v8 row_newbcast:5 row_mask:0xf bank_mask:0xf
    v_and_b32_dpp v37, v13, v9 row_newbcast:5 row_mask:0xf bank_mask:0xf
    v_and_b32_dpp v38, v13, v10 row_newbcast:5 row_mask:0xf bank_mask:0xf
    v_and_b32_dpp v39, v13, v11 row_newbcast:5 row_mask:0xf bank_mask:0xf
    s_waitcnt vmcnt(1)
    s_nop 0
    v_mfma_f32_16x16x32_bf16 v[40:43], v[148:151], v[36:39], v[40:43]
    s_add_u32 s84, s42, 23
    s_and_b32 s84, s84, 31
    s_mul_i32 s84, s84, 14336
    s_add_u32 s84, s84, s11
    buffer_load_dwordx4 v[156:159], v5, s[60:63], s84 offen
    v_and_b32_dpp v32, v13, v8 row_newbcast:6 row_mask:0xf bank_mask:0xf
    v_and_b32_dpp v33, v13, v9 row_newbcast:6 row_mask:0xf bank_mask:0xf
    v_and_b32_dpp v34, v13, v10 row_newbcast:6 row_mask:0xf bank_mask:0xf
    v_and_b32_dpp v35, v13, v11 row_newbcast:6 row_mask:0xf bank_mask:0xf
    s_waitcnt vmcnt(1)
    s_nop 0
    v_mfma_f32_16x16x32_bf16 v[40:43], v[152:155], v[32:35], v[40:43]
    s_add_u32 s85, s42, 24
    s_and_b32 s85, s85, 31
    s_mul_i32 s85, s85, 14336
    s_add_u32 s85, s85, s11
    buffer_load_dwordx4 v[160:163], v5, s[60:63], s85 offen
    v_and_b32_dpp v36, v13, v8 row_newbcast:7 row_mask:0xf bank_mask:0xf
    v_and_b32_dpp v37, v13, v9 row_newbcast:7 row_mask:0xf bank_mask:0xf
    v_and_b32_dpp v38, v13, v10 row_newbcast:7 row_mask:0xf bank_mask:0xf
    v_and_b32_dpp v39, v13, v11 row_newbcast:7 row_mask:0xf bank_mask:0xf
    s_waitcnt vmcnt(1)
    s_nop 0
    v_mfma_f32_16x16x32_bf16 v[40:43], v[156:159], v[36:39], v[40:43]
    s_add_u32 s86, s42, 25
    s_and_b32 s86, s86, 31
    s_mul_i32 s86, s86, 14336
    s_add_u32 s86, s86, s11
    buffer_load_dwordx4 v[164:167], v5, s[60:63], s86 offen
    v_and_b32_dpp v32, v13, v8 row_newbcast:8 row_mask:0xf bank_mask:0xf
    v_and_b32_dpp v33, v13, v9 row_newbcast:8 row_mask:0xf bank_mask:0xf
    v_and_b32_dpp v34, v13, v10 row_newbcast:8 row_mask:0xf bank_mask:0xf
    v_and_b32_dpp v35, v13, v11 row_newbcast:8 row_mask:0xf bank_mask:0xf
    s_waitcnt vmcnt(1)
    s_nop 0
    v_mfma_f32_16x16x32_bf16 v[40:43], v[160:163], v[32:35], v[40:43]
    s_add_u32 s87, s42, 26
    s_and_b32 s87, s87, 31
    s_mul_i32 s87, s87, 14336
    s_add_u32 s87, s87, s11
    buffer_load_dwordx4 v[168:171], v5, s[60:63], s87 offen
    v_and_b32_dpp v36, v13, v8 row_newbcast:9 row_mask:0xf bank_mask:0xf
    v_and_b32_dpp v37, v13, v9 row_newbcast:9 row_mask:0xf bank_mask:0xf
    v_and_b32_dpp v38, v13, v10 row_newbcast:9 row_mask:0xf bank_mask:0xf
    v_and_b32_dpp v39, v13, v11 row_newbcast:9 row_mask:0xf bank_mask:0xf
    s_waitcnt vmcnt(1)
    s_nop 0
    v_mfma_f32_16x16x32_bf16 v[40:43], v[164:167], v[36:39], v[40:43]
    s_add_u32 s88, s42, 27
    s_and_b32 s88, s88, 31
    s_mul_i32 s88, s88, 14336
    s_add_u32 s88, s88, s11
    buffer_load_dwordx4 v[172:175], v5, s[60:63], s88 offen
    v_and_b32_dpp v32, v13, v8 row_newbcast:10 row_mask:0xf bank_mask:0xf
    v_and_b32_dpp v33, v13, v9 row_newbcast:10 row_mask:0xf bank_mask:0xf
    v_and_b32_dpp v34, v13, v10 row_newbcast:10 row_mask:0xf bank_mask:0xf
    v_and_b32_dpp v35, v13, v11 row_newbcast:10 row_mask:0xf bank_mask:0xf
    s_waitcnt vmcnt(1)
    s_nop 0
    v_mfma_f32_16x16x32_bf16 v[40:43], v[168:171], v[32:35], v[40:43]
    s_add_u32 s89, s42, 28
    s_and_b32 s89, s89, 31
    s_mul_i32 s89, s89, 14336
    s_add_u32 s89, s89, s11
    buffer_load_dwordx4 v[176:179], v5, s[60:63], s89 offen
    v_and_b32_dpp v36, v13, v8 row_newbcast:11 row_mask:0xf bank_mask:0xf
    v_and_b32_dpp v37, v13, v9 row_newbcast:11 row_mask:0xf bank_mask:0xf
    v_and_b32_dpp v38, v13, v10 row_newbcast:11 row_mask:0xf bank_mask:0xf
    v_and_b32_dpp v39, v13, v11 row_newbcast:11 row_mask:0xf bank_mask:0xf
    s_waitcnt vmcnt(1)
    s_nop 0
    v_mfma_f32_16x16x32_bf16 v[40:43], v[172:175], v[36:39], v[40:43]
    s_add_u32 s90, s42, 29
    s_and_b32 s90, s90, 31
    s_mul_i32 s90, s90, 14336
    s_add_u32 s90, s90, s11
    buffer_load_dwordx4 v[180:183], v5, s[60:63], s90 offen
    v_and_b32_dpp v32, v13, v8 row_newbcast:12 row_mask:0xf bank_mask:0xf
    v_and_b32_dpp v33, v13, v9 row_newbcast:12 row_mask:0xf bank_mask:0xf
    v_and_b32_dpp v34, v13, v10 row_newbcast:12 row_mask:0xf bank_mask:0xf
    v_and_b32_dpp v35, v13, v11 row_newbcast:12 row_mask:0xf bank_mask:0xf
    s_waitcnt vmcnt(1)
    s_nop 0
    v_mfma_f32_16x16x32_bf16 v[40:43], v[176:179], v[32:35], v[40:43]
    s_add_u32 s91, s42, 30
    s_and_b32 s91, s91, 31
    s_mul_i32 s91, s91, 14336
    s_add_u32 s91, s91, s11
    buffer_load_dwordx4 v[184:187], v5, s[60:63], s91 offen
    v_and_b32_dpp v36, v13, v8 row_newbcast:13 row_mask:0xf bank_mask:0xf
    v_and_b32_dpp v37, v13, v9 row_newbcast:13 row_mask:0xf bank_mask:0xf
    v_and_b32_dpp v38, v13, v10 row_newbcast:13 row_mask:0xf bank_mask:0xf
    v_and_b32_dpp v39, v13, v11 row_newbcast:13 row_mask:0xf bank_mask:0xf
    s_waitcnt vmcnt(1)
    s_nop 0
    v_mfma_f32_16x16x32_bf16 v[40:43], v[180:183], v[36:39], v[40:43]
    s_add_u32 s76, s42, 31
    s_and_b32 s76, s76, 31
    s_mul_i32 s76, s76, 14336
    s_add_u32 s76, s76, s11
    buffer_load_dwordx4 v[188:191], v5, s[60:63], s76 offen
    v_and_b32_dpp v32, v13, v8 row_newbcast:14 row_mask:0xf bank_mask:0xf
    v_and_b32_dpp v33, v13, v9 row_newbcast:14 row_mask:0xf bank_mask:0xf
    v_and_b32_dpp v34, v13, v10 row_newbcast:14 row_mask:0xf bank_mask:0xf
    v_and_b32_dpp v35, v13, v11 row_newbcast:14 row_mask:0xf bank_mask:0xf
    s_waitcnt vmcnt(1)
    s_nop 0
    v_mfma_f32_16x16x32_bf16 v[40:43], v[184:187], v[32:35], v[40:43]
    v_and_b32_dpp v36, v13, v8 row_newbcast:15 row_mask:0xf bank_mask:0xf
    v_and_b32_dpp v37, v13, v9 row_newbcast:15 row_mask:0xf bank_mask:0xf
    v_and_b32_dpp v38, v13, v10 row_newbcast:15 row_mask:0xf bank_mask:0xf
    v_and_b32_dpp v39, v13, v11 row_newbcast:15 row_mask:0xf bank_mask:0xf
    s_waitcnt vmcnt(0)
    s_nop 0
    v_mfma_f32_16x16x32_bf16 v[40:43], v[188:191], v[36:39], v[40:43]
    s_mov_b64 exec, s[96:97]
    s_nop 6
    ds_write_b32 v7, v40 offset:2048
    ds_write_b32 v7, v41 offset:2080
    ds_write_b32 v7, v42 offset:2112
    ds_write_b32 v7, v43 offset:2144
    s_mov_b64 exec, -1
    s_add_u32 s77, s12, 0
    buffer_load_dwordx4 v[192:195], v6, s[64:67], s77 offen
    s_add_u32 s78, s12, 4096
    buffer_load_dwordx4 v[196:199], v6, s[64:67], s78 offen
    s_waitcnt vmcnt(1)
    s_add_u32 s79, s12, 8192
    buffer_load_dwordx4 v[200:203], v6, s[64:67], s79 offen
    s_waitcnt vmcnt(1)
    s_add_u32 s80, s12, 12288
    buffer_load_dwordx4 v[204:207], v6, s[64:67], s80 offen
    s_waitcnt vmcnt(1)
    s_add_u32 s81, s12, 16384
    buffer_load_dwordx4 v[208:211], v6, s[64:67], s81 offen
    s_waitcnt vmcnt(1)
    s_add_u32 s82, s12, 20480
    buffer_load_dwordx4 v[212:215], v6, s[64:67], s82 offen
    s_waitcnt vmcnt(1)
    s_add_u32 s83, s12, 24576
    buffer_load_dwordx4 v[216:219], v6, s[64:67], s83 offen
    s_waitcnt vmcnt(1)
    s_add_u32 s84, s12, 28672
    buffer_load_dwordx4 v[220:223], v6, s[64:67], s84 offen
    s_waitcnt vmcnt(1)
    s_add_u32 s85, s12, 32768
    buffer_load_dwordx4 v[224:227], v6, s[64:67], s85 offen
    s_waitcnt vmcnt(1)
    s_add_u32 s86, s12, 36864
    buffer_load_dwordx4 v[228:231], v6, s[64:67], s86 offen
    s_waitcnt vmcnt(1)
    s_add_u32 s87, s12, 40960
    buffer_load_dwordx4 v[232:235], v6, s[64:67], s87 offen
    s_waitcnt vmcnt(1)
    s_add_u32 s88, s12, 45056
    buffer_load_dwordx4 v[236:239], v6, s[64:67], s88 offen
    s_waitcnt vmcnt(1)
    s_add_u32 s89, s12, 49152
    buffer_load_dwordx4 v[240:243], v6, s[64:67], s89 offen
    s_waitcnt vmcnt(1)
    s_add_u32 s90, s12, 53248
    buffer_load_dwordx4 v[244:247], v6, s[64:67], s90 offen
    s_waitcnt vmcnt(1)
    s_add_u32 s91, s42, 0
    s_and_b32 s91, s91, 31
    s_mul_i32 s91, s91, 4096
    s_add_u32 s91, s91, s13
    buffer_load_dwordx4 v[64:67], v6, s[56:59], s91 offen
    s_waitcnt vmcnt(1)
    s_add_u32 s76, s42, 1
    s_and_b32 s76, s76, 31
    s_mul_i32 s76, s76, 4096
    s_add_u32 s76, s76, s13
    buffer_load_dwordx4 v[68:71], v6, s[56:59], s76 offen
    s_waitcnt vmcnt(1)
    s_add_u32 s77, s42, 2
    s_and_b32 s77, s77, 31
    s_mul_i32 s77, s77, 4096
    s_add_u32 s77, s77, s13
    buffer_load_dwordx4 v[72:75], v6, s[56:59], s77 offen
    s_waitcnt vmcnt(1)
    s_add_u32 s78, s42, 3
    s_and_b32 s78, s78, 31
    s_mul_i32 s78, s78, 4096
    s_add_u32 s78, s78, s13
    buffer_load_dwordx4 v[76:79], v6, s[56:59], s78 offen
    s_waitcnt vmcnt(1)
    s_add_u32 s79, s42, 4
    s_and_b32 s79, s79, 31
    s_mul_i32 s79, s79, 4096
    s_add_u32 s79, s79, s13
    buffer_load_dwordx4 v[80:83], v6, s[56:59], s79 offen
    s_waitcnt vmcnt(1)
    s_add_u32 s80, s42, 5
    s_and_b32 s80, s80, 31
    s_mul_i32 s80, s80, 4096
    s_add_u32 s80, s80, s13
    buffer_load_dwordx4 v[84:87], v6, s[56:59], s80 offen
    s_waitcnt vmcnt(1)
    s_add_u32 s81, s42, 6
    s_and_b32 s81, s81, 31
    s_mul_i32 s81, s81, 4096
    s_add_u32 s81, s81, s13
    buffer_load_dwordx4 v[88:91], v6, s[56:59], s81 offen
    s_waitcnt vmcnt(1)
    s_add_u32 s82, s42, 7
    s_and_b32 s82, s82, 31
    s_mul_i32 s82, s82, 4096
    s_add_u32 s82, s82, s13
    buffer_load_dwordx4 v[92:95], v6, s[56:59], s82 offen
    s_waitcnt vmcnt(1)
    s_add_u32 s83, s42, 8
    s_and_b32 s83, s83, 31
    s_mul_i32 s83, s83, 4096
    s_add_u32 s83, s83, s13
    buffer_load_dwordx4 v[96:99], v6, s[56:59], s83 offen
    s_waitcnt vmcnt(1)
    s_add_u32 s84, s42, 9
    s_and_b32 s84, s84, 31
    s_mul_i32 s84, s84, 4096
    s_add_u32 s84, s84, s13
    buffer_load_dwordx4 v[100:103], v6, s[56:59], s84 offen
    s_waitcnt vmcnt(1)
    s_add_u32 s85, s42, 10
    s_and_b32 s85, s85, 31
    s_mul_i32 s85, s85, 4096
    s_add_u32 s85, s85, s13
    buffer_load_dwordx4 v[104:107], v6, s[56:59], s85 offen
    s_waitcnt vmcnt(1)
    s_add_u32 s86, s42, 11
    s_and_b32 s86, s86, 31
    s_mul_i32 s86, s86, 4096
    s_add_u32 s86, s86, s13
    buffer_load_dwordx4 v[108:111], v6, s[56:59], s86 offen
    s_waitcnt vmcnt(1)
    s_add_u32 s87, s42, 12
    s_and_b32 s87, s87, 31
    s_mul_i32 s87, s87, 4096
    s_add_u32 s87, s87, s13
    buffer_load_dwordx4 v[112:115], v6, s[56:59], s87 offen
    s_waitcnt vmcnt(1)
    s_add_u32 s88, s42, 13
    s_and_b32 s88, s88, 31
    s_mul_i32 s88, s88, 4096
    s_add_u32 s88, s88, s13
    buffer_load_dwordx4 v[116:119], v6, s[56:59], s88 offen
    s_waitcnt vmcnt(1)
    s_add_u32 s89, s42, 14
    s_and_b32 s89, s89, 31
    s_mul_i32 s89, s89, 4096
    s_add_u32 s89, s89, s13
    buffer_load_dwordx4 v[120:123], v6, s[56:59], s89 offen
    s_waitcnt vmcnt(1)
    s_add_u32 s90, s42, 15
    s_and_b32 s90, s90, 31
    s_mul_i32 s90, s90, 4096
    s_add_u32 s90, s90, s13
    buffer_load_dwordx4 v[124:127], v6, s[56:59], s90 offen
    s_waitcnt vmcnt(1)
    s_add_u32 s91, s42, 16
    s_and_b32 s91, s91, 31
    s_mul_i32 s91, s91, 4096
    s_add_u32 s91, s91, s13
    buffer_load_dwordx4 v[128:131], v6, s[56:59], s91 offen
    s_waitcnt vmcnt(1)
    s_add_u32 s76, s42, 17
    s_and_b32 s76, s76, 31
    s_mul_i32 s76, s76, 4096
    s_add_u32 s76, s76, s13
    buffer_load_dwordx4 v[132:135], v6, s[56:59], s76 offen
    s_waitcnt vmcnt(1)
    s_add_u32 s77, s42, 18
    s_and_b32 s77, s77, 31
    s_mul_i32 s77, s77, 4096
    s_add_u32 s77, s77, s13
    buffer_load_dwordx4 v[136:139], v6, s[56:59], s77 offen
    s_waitcnt vmcnt(1)
    s_add_u32 s78, s42, 19
    s_and_b32 s78, s78, 31
    s_mul_i32 s78, s78, 4096
    s_add_u32 s78, s78, s13
    buffer_load_dwordx4 v[140:143], v6, s[56:59], s78 offen
    s_waitcnt vmcnt(1)
    s_add_u32 s79, s42, 20
    s_and_b32 s79, s79, 31
    s_mul_i32 s79, s79, 4096
    s_add_u32 s79, s79, s13
    buffer_load_dwordx4 v[144:147], v6, s[56:59], s79 offen
    s_waitcnt vmcnt(1)
    s_add_u32 s80, s42, 21
    s_and_b32 s80, s80, 31
    s_mul_i32 s80, s80, 4096
    s_add_u32 s80, s80, s13
    buffer_load_dwordx4 v[148:151], v6, s[56:59], s80 offen
    s_waitcnt vmcnt(1)
    s_add_u32 s81, s42, 22
    s_and_b32 s81, s81, 31
    s_mul_i32 s81, s81, 4096
    s_add_u32 s81, s81, s13
    buffer_load_dwordx4 v[152:155], v6, s[56:59], s81 offen
    s_waitcnt vmcnt(1)
    s_add_u32 s82, s42, 23
    s_and_b32 s82, s82, 31
    s_mul_i32 s82, s82, 4096
    s_add_u32 s82, s82, s13
    buffer_load_dwordx4 v[156:159], v6, s[56:59], s82 offen
    s_waitcnt vmcnt(1)
    s_add_u32 s83, s42, 24
    s_and_b32 s83, s83, 31
    s_mul_i32 s83, s83, 4096
    s_add_u32 s83, s83, s13
    buffer_load_dwordx4 v[160:163], v6, s[56:59], s83 offen
    s_waitcnt vmcnt(1)
    s_add_u32 s84, s42, 25
    s_and_b32 s84, s84, 31
    s_mul_i32 s84, s84, 4096
    s_add_u32 s84, s84, s13
    buffer_load_dwordx4 v[164:167], v6, s[56:59], s84 offen
    s_waitcnt vmcnt(1)
    s_add_u32 s85, s42, 26
    s_and_b32 s85, s85, 31
    s_mul_i32 s85, s85, 4096
    s_add_u32 s85, s85, s13
    buffer_load_dwordx4 v[168:171], v6, s[56:59], s85 offen
    s_waitcnt vmcnt(1)
    s_add_u32 s86, s42, 27
    s_and_b32 s86, s86, 31
    s_mul_i32 s86, s86, 4096
    s_add_u32 s86, s86, s13
    buffer_load_dwordx4 v[172:175], v6, s[56:59], s86 offen
    s_waitcnt vmcnt(1)
    s_add_u32 s87, s42, 28
    s_and_b32 s87, s87, 31
    s_mul_i32 s87, s87, 4096
    s_add_u32 s87, s87, s13
    buffer_load_dwordx4 v[176:179], v6, s[56:59], s87 offen
    s_waitcnt vmcnt(1)
    s_add_u32 s88, s42, 29
    s_and_b32 s88, s88, 31
    s_mul_i32 s88, s88, 4096
    s_add_u32 s88, s88, s13
    buffer_load_dwordx4 v[180:183], v6, s[56:59], s88 offen
    s_waitcnt vmcnt(1)
    s_add_u32 s89, s42, 30
    s_and_b32 s89, s89, 31
    s_mul_i32 s89, s89, 4096
    s_add_u32 s89, s89, s13
    buffer_load_dwordx4 v[184:187], v6, s[56:59], s89 offen
    s_waitcnt vmcnt(1)
    s_add_u32 s90, s42, 31
    s_and_b32 s90, s90, 31
    s_mul_i32 s90, s90, 4096
    s_add_u32 s90, s90, s13
    buffer_load_dwordx4 v[188:191], v6, s[56:59], s90 offen
    v_lshlrev_b32 v30, 2, v14
    v_lshlrev_b32 v20, 2, v56
    v_lshlrev_b32 v21, 2, v57
    v_lshl_add_u32 v31, v3, 3, v2
    v_lshlrev_b32 v31, 4, v31
    s_lshl_b32 s14, s2, 11
    s_lshl_b32 s7, s8, 9
    s_add_u32 s14, s14, s7
    s_waitcnt vmcnt(0) lgkmcnt(0)
    s_barrier
    ds_read_b32 v48, v30 offset:2048
    ds_read_b32 v49, v30 offset:2560
    ds_read_b32 v50, v30 offset:3072
    ds_read_b32 v51, v30 offset:3584
    s_waitcnt lgkmcnt(0)
    v_add_f32 v48, v48, v49
    v_add_f32 v50, v50, v51
    v_add_f32 v48, v48, v50
    v_cvt_pk_bf16_f32 v48, v48, v48
    v_and_b32 v48, 0xffff0000, v48
    v_lshlrev_b32 v15, 16, v15
    v_add_f32 v48, v48, v15
    v_cvt_pk_bf16_f32 v48, v48, v48
    v_and_b32 v48, 0xffff0000, v48
    v_mul_f32 v49, v48, v48
    v_mul_f32 v49, 0x3d372713, v49
    v_add_f32 v49, 1.0, v49
    v_mul_f32 v49, v49, v48
    v_mul_f32 v49, 0xc0135761, v49
    v_exp_f32 v49, v49
    s_nop 0
    v_add_f32 v49, 1.0, v49
    v_rcp_f32 v49, v49
    s_nop 0
    v_mul_f32 v49, v49, v48
    v_cvt_pk_bf16_f32 v49, v49, v49
    s_nop 1
    v_and_b32_dpp v32, v49, v8 row_newbcast:0 row_mask:0xf bank_mask:0xf
    v_and_b32_dpp v33, v49, v9 row_newbcast:0 row_mask:0xf bank_mask:0xf
    v_and_b32_dpp v34, v49, v10 row_newbcast:0 row_mask:0xf bank_mask:0xf
    v_and_b32_dpp v35, v49, v11 row_newbcast:0 row_mask:0xf bank_mask:0xf
    v_and_b32_dpp v36, v49, v8 row_newbcast:1 row_mask:0xf bank_mask:0xf
    v_and_b32_dpp v37, v49, v9 row_newbcast:1 row_mask:0xf bank_mask:0xf
    v_and_b32_dpp v38, v49, v10 row_newbcast:1 row_mask:0xf bank_mask:0xf
    v_and_b32_dpp v39, v49, v11 row_newbcast:1 row_mask:0xf bank_mask:0xf
    v_mfma_f32_16x16x32_bf16 v[44:47], v[192:195], v[32:35], 0
    v_and_b32_dpp v32, v49, v8 row_newbcast:2 row_mask:0xf bank_mask:0xf
    v_and_b32_dpp v33, v49, v9 row_newbcast:2 row_mask:0xf bank_mask:0xf
    v_and_b32_dpp v34, v49, v10 row_newbcast:2 row_mask:0xf bank_mask:0xf
    v_and_b32_dpp v35, v49, v11 row_newbcast:2 row_mask:0xf bank_mask:0xf
    v_mfma_f32_16x16x32_bf16 v[44:47], v[196:199], v[36:39], v[44:47]
    v_and_b32_dpp v36, v49, v8 row_newbcast:3 row_mask:0xf bank_mask:0xf
    v_and_b32_dpp v37, v49, v9 row_newbcast:3 row_mask:0xf bank_mask:0xf
    v_and_b32_dpp v38, v49, v10 row_newbcast:3 row_mask:0xf bank_mask:0xf
    v_and_b32_dpp v39, v49, v11 row_newbcast:3 row_mask:0xf bank_mask:0xf
    v_mfma_f32_16x16x32_bf16 v[44:47], v[200:203], v[32:35], v[44:47]
    v_and_b32_dpp v32, v49, v8 row_newbcast:4 row_mask:0xf bank_mask:0xf
    v_and_b32_dpp v33, v49, v9 row_newbcast:4 row_mask:0xf bank_mask:0xf
    v_and_b32_dpp v34, v49, v10 row_newbcast:4 row_mask:0xf bank_mask:0xf
    v_and_b32_dpp v35, v49, v11 row_newbcast:4 row_mask:0xf bank_mask:0xf
    v_mfma_f32_16x16x32_bf16 v[44:47], v[204:207], v[36:39], v[44:47]
    v_and_b32_dpp v36, v49, v8 row_newbcast:5 row_mask:0xf bank_mask:0xf
    v_and_b32_dpp v37, v49, v9 row_newbcast:5 row_mask:0xf bank_mask:0xf
    v_and_b32_dpp v38, v49, v10 row_newbcast:5 row_mask:0xf bank_mask:0xf
    v_and_b32_dpp v39, v49, v11 row_newbcast:5 row_mask:0xf bank_mask:0xf
    v_mfma_f32_16x16x32_bf16 v[44:47], v[208:211], v[32:35], v[44:47]
    v_and_b32_dpp v32, v49, v8 row_newbcast:6 row_mask:0xf bank_mask:0xf
    v_and_b32_dpp v33, v49, v9 row_newbcast:6 row_mask:0xf bank_mask:0xf
    v_and_b32_dpp v34, v49, v10 row_newbcast:6 row_mask:0xf bank_mask:0xf
    v_and_b32_dpp v35, v49, v11 row_newbcast:6 row_mask:0xf bank_mask:0xf
    v_mfma_f32_16x16x32_bf16 v[44:47], v[212:215], v[36:39], v[44:47]
    v_and_b32_dpp v36, v49, v8 row_newbcast:7 row_mask:0xf bank_mask:0xf
    v_and_b32_dpp v37, v49, v9 row_newbcast:7 row_mask:0xf bank_mask:0xf
    v_and_b32_dpp v38, v49, v10 row_newbcast:7 row_mask:0xf bank_mask:0xf
    v_and_b32_dpp v39, v49, v11 row_newbcast:7 row_mask:0xf bank_mask:0xf
    v_mfma_f32_16x16x32_bf16 v[44:47], v[216:219], v[32:35], v[44:47]
    v_and_b32_dpp v32, v49, v8 row_newbcast:8 row_mask:0xf bank_mask:0xf
    v_and_b32_dpp v33, v49, v9 row_newbcast:8 row_mask:0xf bank_mask:0xf
    v_and_b32_dpp v34, v49, v10 row_newbcast:8 row_mask:0xf bank_mask:0xf
    v_and_b32_dpp v35, v49, v11 row_newbcast:8 row_mask:0xf bank_mask:0xf
    v_mfma_f32_16x16x32_bf16 v[44:47], v[220:223], v[36:39], v[44:47]
    v_and_b32_dpp v36, v49, v8 row_newbcast:9 row_mask:0xf bank_mask:0xf
    v_and_b32_dpp v37, v49, v9 row_newbcast:9 row_mask:0xf bank_mask:0xf
    v_and_b32_dpp v38, v49, v10 row_newbcast:9 row_mask:0xf bank_mask:0xf
    v_and_b32_dpp v39, v49, v11 row_newbcast:9 row_mask:0xf bank_mask:0xf
    v_mfma_f32_16x16x32_bf16 v[44:47], v[224:227], v[32:35], v[44:47]
    v_and_b32_dpp v32, v49, v8 row_newbcast:10 row_mask:0xf bank_mask:0xf
    v_and_b32_dpp v33, v49, v9 row_newbcast:10 row_mask:0xf bank_mask:0xf
    v_and_b32_dpp v34, v49, v10 row_newbcast:10 row_mask:0xf bank_mask:0xf
    v_and_b32_dpp v35, v49, v11 row_newbcast:10 row_mask:0xf bank_mask:0xf
    v_mfma_f32_16x16x32_bf16 v[44:47], v[228:231], v[36:39], v[44:47]
    v_and_b32_dpp v36, v49, v8 row_newbcast:11 row_mask:0xf bank_mask:0xf
    v_and_b32_dpp v37, v49, v9 row_newbcast:11 row_mask:0xf bank_mask:0xf
    v_and_b32_dpp v38, v49, v10 row_newbcast:11 row_mask:0xf bank_mask:0xf
    v_and_b32_dpp v39, v49, v11 row_newbcast:11 row_mask:0xf bank_mask:0xf
    v_mfma_f32_16x16x32_bf16 v[44:47], v[232:235], v[32:35], v[44:47]
    v_and_b32_dpp v32, v49, v8 row_newbcast:12 row_mask:0xf bank_mask:0xf
    v_and_b32_dpp v33, v49, v9 row_newbcast:12 row_mask:0xf bank_mask:0xf
    v_and_b32_dpp v34, v49, v10 row_newbcast:12 row_mask:0xf bank_mask:0xf
    v_and_b32_dpp v35, v49, v11 row_newbcast:12 row_mask:0xf bank_mask:0xf
    v_mfma_f32_16x16x32_bf16 v[44:47], v[236:239], v[36:39], v[44:47]
    v_and_b32_dpp v36, v49, v8 row_newbcast:13 row_mask:0xf bank_mask:0xf
    v_and_b32_dpp v37, v49, v9 row_newbcast:13 row_mask:0xf bank_mask:0xf
    v_and_b32_dpp v38, v49, v10 row_newbcast:13 row_mask:0xf bank_mask:0xf
    v_and_b32_dpp v39, v49, v11 row_newbcast:13 row_mask:0xf bank_mask:0xf
    v_mfma_f32_16x16x32_bf16 v[44:47], v[240:243], v[32:35], v[44:47]
    s_nop 0
    v_mfma_f32_16x16x32_bf16 v[44:47], v[244:247], v[36:39], v[44:47]
    s_add_u32 s7, s14, 524288
    s_mov_b64 exec, s[96:97]
    s_nop 5
    buffer_store_dwordx4 v[44:47], v31, s[68:71], s7 offen sc1
    s_mov_b64 exec, -1
    s_lshl_b32 s7, s4, 5
    v_mov_b32 v58, s7
    global_load_dword v59, v58, s[38:39] sc1
    global_load_ushort v12, v29, s[34:35] offset:0 nt
    global_load_ushort v13, v29, s[34:35] offset:16 nt
    global_load_ushort v14, v29, s[34:35] offset:32 nt
    global_load_ushort v15, v29, s[34:35] offset:48 nt
    s_lshl_b32 s45, s4, 11
    s_lshl_b32 s7, s8, 9
    s_add_u32 s45, s45, s7
    s_add_u32 s45, s45, 1310720
    s_waitcnt vmcnt(0)
    v_readfirstlane_b32 s7, v59
    s_nop 0
    s_cmp_eq_u32 s7, 2
    s_cbranch_scc1 L_sbok
    s_lshl_b32 s7, s4, 5
    v_mov_b32 v58, s7
L_sbtry1:
    v_mov_b32 v60, 1
    v_mov_b32 v61, 0
    s_mov_b64 exec, 1
    global_atomic_cmpswap v59, v58, v[60:61], s[38:39] sc0
    s_waitcnt vmcnt(0)
    v_readfirstlane_b32 s7, v59
    s_mov_b64 exec, -1
    s_cmp_eq_u32 s7, 2
    s_cbranch_scc1 L_sbdone1
    s_cmp_eq_u32 s7, 0
    s_cbranch_scc1 L_sbzero1
    s_sleep 8
    s_branch L_sbtry1
L_sbzero1:
    s_lshl_b32 s7, s4, 11
    s_add_u32 s7, s7, 1310720
    v_lshlrev_b32 v60, 8, v0
    s_mov_b64 exec, 0xff
    buffer_store_dword v61, v60, s[68:71], s7 offen sc1
    s_waitcnt vmcnt(0)
    v_mov_b32 v60, 2
    s_mov_b64 exec, 1
    global_store_dword v58, v60, s[38:39] sc1
    s_mov_b64 exec, -1
    s_waitcnt vmcnt(0)
    s_nop 0
L_sbdone1:
L_sbok:
    v_mov_b32 v23, 0
    v_mov_b32 v25, 1
    s_mov_b64 exec, 1
    buffer_atomic_add v25, v23, s[68:71], s45 offen offset:256
    s_mov_b64 exec, -1
    v_lshlrev_b32 v12, 16, v12
    v_lshlrev_b32 v13, 16, v13
    v_lshlrev_b32 v14, 16, v14
    v_lshlrev_b32 v15, 16, v15
    v_lshrrev_b32 v26, 5, v0
    v_lshlrev_b32 v26, 11, v26
    v_and_b32 v27, 31, v0
    v_lshl_add_u32 v26, v27, 4, v26
    v_lshlrev_b32 v27, 4, v27
    s_lshl_b32 s15, s4, 16
    s_lshl_b32 s7, s8, 9
    s_add_u32 s15, s15, s7
    s_lshl_b32 s9, s4, 11
    s_add_u32 s9, s9, s7
    s_add_u32 s9, s9, 1048576
    s_add_u32 s76, s15, 0
    s_add_u32 s77, s15, 4096
    s_add_u32 s78, s15, 8192
    s_add_u32 s79, s15, 12288
    s_add_u32 s80, s15, 16384
    s_add_u32 s81, s15, 20480
    s_add_u32 s82, s15, 24576
    s_add_u32 s83, s15, 28672
    s_add_u32 s84, s15, 32768
    s_add_u32 s85, s15, 36864
    s_add_u32 s86, s15, 40960
    s_add_u32 s87, s15, 45056
    s_add_u32 s88, s15, 49152
    s_add_u32 s89, s15, 53248
    s_add_u32 s90, s15, 57344
    s_add_u32 s91, s15, 61440
    v_add_u32 v22, 524288, v26
    v_lshlrev_b32 v16, 16, v16
    v_lshlrev_b32 v17, 16, v17
    v_lshlrev_b32 v18, 16, v18
    v_lshlrev_b32 v19, 16, v19
    s_lshl_b32 s10, s4, 10
    s_barrier
    ds_read_b32 v48, v20 offset:4096
    ds_read_b32 v49, v20 offset:4608
    ds_read_b32 v50, v20 offset:5120
    ds_read_b32 v51, v20 offset:5632
    ds_read_b32 v52, v21 offset:4096
    ds_read_b32 v53, v21 offset:4608
    ds_read_b32 v54, v21 offset:5120
    ds_read_b32 v55, v21 offset:5632
    s_waitcnt lgkmcnt(4)
    v_add_f32 v48, v48, v49
    v_add_f32 v50, v50, v51
    v_add_f32 v48, v48, v50
    v_cvt_pk_bf16_f32 v48, v48, v48
    s_waitcnt lgkmcnt(0)
    v_add_f32 v52, v52, v53
    v_add_f32 v54, v54, v55
    v_and_b32_dpp v32, v48, v8 row_newbcast:0 row_mask:0xf bank_mask:0xf
    v_and_b32_dpp v33, v48, v9 row_newbcast:0 row_mask:0xf bank_mask:0xf
    v_and_b32_dpp v34, v48, v10 row_newbcast:0 row_mask:0xf bank_mask:0xf
    v_and_b32_dpp v35, v48, v11 row_newbcast:0 row_mask:0xf bank_mask:0xf
    v_add_f32 v52, v52, v54
    v_cvt_pk_bf16_f32 v49, v52, v52
    v_and_b32_dpp v36, v48, v8 row_newbcast:1 row_mask:0xf bank_mask:0xf
    v_and_b32_dpp v37, v48, v9 row_newbcast:1 row_mask:0xf bank_mask:0xf
    v_and_b32_dpp v38, v48, v10 row_newbcast:1 row_mask:0xf bank_mask:0xf
    v_and_b32_dpp v39, v48, v11 row_newbcast:1 row_mask:0xf bank_mask:0xf
    v_mfma_f32_16x16x32_bf16 v[40:43], v[64:67], v[32:35], 0
    v_and_b32_dpp v32, v48, v8 row_newbcast:2 row_mask:0xf bank_mask:0xf
    v_and_b32_dpp v33, v48, v9 row_newbcast:2 row_mask:0xf bank_mask:0xf
    v_and_b32_dpp v34, v48, v10 row_newbcast:2 row_mask:0xf bank_mask:0xf
    v_and_b32_dpp v35, v48, v11 row_newbcast:2 row_mask:0xf bank_mask:0xf
    v_mfma_f32_16x16x32_bf16 v[40:43], v[68:71], v[36:39], v[40:43]
    v_and_b32_dpp v36, v48, v8 row_newbcast:3 row_mask:0xf bank_mask:0xf
    v_and_b32_dpp v37, v48, v9 row_newbcast:3 row_mask:0xf bank_mask:0xf
    v_and_b32_dpp v38, v48, v10 row_newbcast:3 row_mask:0xf bank_mask:0xf
    v_and_b32_dpp v39, v48, v11 row_newbcast:3 row_mask:0xf bank_mask:0xf
    v_mfma_f32_16x16x32_bf16 v[40:43], v[72:75], v[32:35], v[40:43]
    v_and_b32_dpp v32, v48, v8 row_newbcast:4 row_mask:0xf bank_mask:0xf
    v_and_b32_dpp v33, v48, v9 row_newbcast:4 row_mask:0xf bank_mask:0xf
    v_and_b32_dpp v34, v48, v10 row_newbcast:4 row_mask:0xf bank_mask:0xf
    v_and_b32_dpp v35, v48, v11 row_newbcast:4 row_mask:0xf bank_mask:0xf
    v_mfma_f32_16x16x32_bf16 v[40:43], v[76:79], v[36:39], v[40:43]
    v_and_b32_dpp v36, v48, v8 row_newbcast:5 row_mask:0xf bank_mask:0xf
    v_and_b32_dpp v37, v48, v9 row_newbcast:5 row_mask:0xf bank_mask:0xf
    v_and_b32_dpp v38, v48, v10 row_newbcast:5 row_mask:0xf bank_mask:0xf
    v_and_b32_dpp v39, v48, v11 row_newbcast:5 row_mask:0xf bank_mask:0xf
    v_mfma_f32_16x16x32_bf16 v[40:43], v[80:83], v[32:35], v[40:43]
    v_and_b32_dpp v32, v48, v8 row_newbcast:6 row_mask:0xf bank_mask:0xf
    v_and_b32_dpp v33, v48, v9 row_newbcast:6 row_mask:0xf bank_mask:0xf
    v_and_b32_dpp v34, v48, v10 row_newbcast:6 row_mask:0xf bank_mask:0xf
    v_and_b32_dpp v35, v48, v11 row_newbcast:6 row_mask:0xf bank_mask:0xf
    v_mfma_f32_16x16x32_bf16 v[40:43], v[84:87], v[36:39], v[40:43]
    v_and_b32_dpp v36, v48, v8 row_newbcast:7 row_mask:0xf bank_mask:0xf
    v_and_b32_dpp v37, v48, v9 row_newbcast:7 row_mask:0xf bank_mask:0xf
    v_and_b32_dpp v38, v48, v10 row_newbcast:7 row_mask:0xf bank_mask:0xf
    v_and_b32_dpp v39, v48, v11 row_newbcast:7 row_mask:0xf bank_mask:0xf
    v_mfma_f32_16x16x32_bf16 v[40:43], v[88:91], v[32:35], v[40:43]
    v_and_b32_dpp v32, v48, v8 row_newbcast:8 row_mask:0xf bank_mask:0xf
    v_and_b32_dpp v33, v48, v9 row_newbcast:8 row_mask:0xf bank_mask:0xf
    v_and_b32_dpp v34, v48, v10 row_newbcast:8 row_mask:0xf bank_mask:0xf
    v_and_b32_dpp v35, v48, v11 row_newbcast:8 row_mask:0xf bank_mask:0xf
    v_mfma_f32_16x16x32_bf16 v[40:43], v[92:95], v[36:39], v[40:43]
    v_and_b32_dpp v36, v48, v8 row_newbcast:9 row_mask:0xf bank_mask:0xf
    v_and_b32_dpp v37, v48, v9 row_newbcast:9 row_mask:0xf bank_mask:0xf
    v_and_b32_dpp v38, v48, v10 row_newbcast:9 row_mask:0xf bank_mask:0xf
    v_and_b32_dpp v39, v48, v11 row_newbcast:9 row_mask:0xf bank_mask:0xf
    v_mfma_f32_16x16x32_bf16 v[40:43], v[96:99], v[32:35], v[40:43]
    v_and_b32_dpp v32, v48, v8 row_newbcast:10 row_mask:0xf bank_mask:0xf
    v_and_b32_dpp v33, v48, v9 row_newbcast:10 row_mask:0xf bank_mask:0xf
    v_and_b32_dpp v34, v48, v10 row_newbcast:10 row_mask:0xf bank_mask:0xf
    v_and_b32_dpp v35, v48, v11 row_newbcast:10 row_mask:0xf bank_mask:0xf
    v_mfma_f32_16x16x32_bf16 v[40:43], v[100:103], v[36:39], v[40:43]
    v_and_b32_dpp v36, v48, v8 row_newbcast:11 row_mask:0xf bank_mask:0xf
    v_and_b32_dpp v37, v48, v9 row_newbcast:11 row_mask:0xf bank_mask:0xf
    v_and_b32_dpp v38, v48, v10 row_newbcast:11 row_mask:0xf bank_mask:0xf
    v_and_b32_dpp v39, v48, v11 row_newbcast:11 row_mask:0xf bank_mask:0xf
    v_mfma_f32_16x16x32_bf16 v[40:43], v[104:107], v[32:35], v[40:43]
    v_and_b32_dpp v32, v48, v8 row_newbcast:12 row_mask:0xf bank_mask:0xf
    v_and_b32_dpp v33, v48, v9 row_newbcast:12 row_mask:0xf bank_mask:0xf
    v_and_b32_dpp v34, v48, v10 row_newbcast:12 row_mask:0xf bank_mask:0xf
    v_and_b32_dpp v35, v48, v11 row_newbcast:12 row_mask:0xf bank_mask:0xf
    v_mfma_f32_16x16x32_bf16 v[40:43], v[108:111], v[36:39], v[40:43]
    v_and_b32_dpp v36, v48, v8 row_newbcast:13 row_mask:0xf bank_mask:0xf
    v_and_b32_dpp v37, v48, v9 row_newbcast:13 row_mask:0xf bank_mask:0xf
    v_and_b32_dpp v38, v48, v10 row_newbcast:13 row_mask:0xf bank_mask:0xf
    v_and_b32_dpp v39, v48, v11 row_newbcast:13 row_mask:0xf bank_mask:0xf
    v_mfma_f32_16x16x32_bf16 v[40:43], v[112:115], v[32:35], v[40:43]
    v_and_b32_dpp v32, v48, v8 row_newbcast:14 row_mask:0xf bank_mask:0xf
    v_and_b32_dpp v33, v48, v9 row_newbcast:14 row_mask:0xf bank_mask:0xf
    v_and_b32_dpp v34, v48, v10 row_newbcast:14 row_mask:0xf bank_mask:0xf
    v_and_b32_dpp v35, v48, v11 row_newbcast:14 row_mask:0xf bank_mask:0xf
    v_mfma_f32_16x16x32_bf16 v[40:43], v[116:119], v[36:39], v[40:43]
    v_and_b32_dpp v36, v48, v8 row_newbcast:15 row_mask:0xf bank_mask:0xf
    v_and_b32_dpp v37, v48, v9 row_newbcast:15 row_mask:0xf bank_mask:0xf
    v_and_b32_dpp v38, v48, v10 row_newbcast:15 row_mask:0xf bank_mask:0xf
    v_and_b32_dpp v39, v48, v11 row_newbcast:15 row_mask:0xf bank_mask:0xf
    v_mfma_f32_16x16x32_bf16 v[40:43], v[120:123], v[32:35], v[40:43]
    v_and_b32_dpp v32, v49, v8 row_newbcast:0 row_mask:0xf bank_mask:0xf
    v_and_b32_dpp v33, v49, v9 row_newbcast:0 row_mask:0xf bank_mask:0xf
    v_and_b32_dpp v34, v49, v10 row_newbcast:0 row_mask:0xf bank_mask:0xf
    v_and_b32_dpp v35, v49, v11 row_newbcast:0 row_mask:0xf bank_mask:0xf
    v_mfma_f32_16x16x32_bf16 v[40:43], v[124:127], v[36:39], v[40:43]
    v_and_b32_dpp v36, v49, v8 row_newbcast:1 row_mask:0xf bank_mask:0xf
    v_and_b32_dpp v37, v49, v9 row_newbcast:1 row_mask:0xf bank_mask:0xf
    v_and_b32_dpp v38, v49, v10 row_newbcast:1 row_mask:0xf bank_mask:0xf
    v_and_b32_dpp v39, v49, v11 row_newbcast:1 row_mask:0xf bank_mask:0xf
    v_mfma_f32_16x16x32_bf16 v[40:43], v[128:131], v[32:35], v[40:43]
    v_and_b32_dpp v32, v49, v8 row_newbcast:2 row_mask:0xf bank_mask:0xf
    v_and_b32_dpp v33, v49, v9 row_newbcast:2 row_mask:0xf bank_mask:0xf
    v_and_b32_dpp v34, v49, v10 row_newbcast:2 row_mask:0xf bank_mask:0xf
    v_and_b32_dpp v35, v49, v11 row_newbcast:2 row_mask:0xf bank_mask:0xf
    v_mfma_f32_16x16x32_bf16 v[40:43], v[132:135], v[36:39], v[40:43]
    v_and_b32_dpp v36, v49, v8 row_newbcast:3 row_mask:0xf bank_mask:0xf
    v_and_b32_dpp v37, v49, v9 row_newbcast:3 row_mask:0xf bank_mask:0xf
    v_and_b32_dpp v38, v49, v10 row_newbcast:3 row_mask:0xf bank_mask:0xf
    v_and_b32_dpp v39, v49, v11 row_newbcast:3 row_mask:0xf bank_mask:0xf
    v_mfma_f32_16x16x32_bf16 v[40:43], v[136:139], v[32:35], v[40:43]
    v_and_b32_dpp v32, v49, v8 row_newbcast:4 row_mask:0xf bank_mask:0xf
    v_and_b32_dpp v33, v49, v9 row_newbcast:4 row_mask:0xf bank_mask:0xf
    v_and_b32_dpp v34, v49, v10 row_newbcast:4 row_mask:0xf bank_mask:0xf
    v_and_b32_dpp v35, v49, v11 row_newbcast:4 row_mask:0xf bank_mask:0xf
    v_mfma_f32_16x16x32_bf16 v[40:43], v[140:143], v[36:39], v[40:43]
    v_and_b32_dpp v36, v49, v8 row_newbcast:5 row_mask:0xf bank_mask:0xf
    v_and_b32_dpp v37, v49, v9 row_newbcast:5 row_mask:0xf bank_mask:0xf
    v_and_b32_dpp v38, v49, v10 row_newbcast:5 row_mask:0xf bank_mask:0xf
    v_and_b32_dpp v39, v49, v11 row_newbcast:5 row_mask:0xf bank_mask:0xf
    v_mfma_f32_16x16x32_bf16 v[40:43], v[144:147], v[32:35], v[40:43]
    v_and_b32_dpp v32, v49, v8 row_newbcast:6 row_mask:0xf bank_mask:0xf
    v_and_b32_dpp v33, v49, v9 row_newbcast:6 row_mask:0xf bank_mask:0xf
    v_and_b32_dpp v34, v49, v10 row_newbcast:6 row_mask:0xf bank_mask:0xf
    v_and_b32_dpp v35, v49, v11 row_newbcast:6 row_mask:0xf bank_mask:0xf
    v_mfma_f32_16x16x32_bf16 v[40:43], v[148:151], v[36:39], v[40:43]
    v_and_b32_dpp v36, v49, v8 row_newbcast:7 row_mask:0xf bank_mask:0xf
    v_and_b32_dpp v37, v49, v9 row_newbcast:7 row_mask:0xf bank_mask:0xf
    v_and_b32_dpp v38, v49, v10 row_newbcast:7 row_mask:0xf bank_mask:0xf
    v_and_b32_dpp v39, v49, v11 row_newbcast:7 row_mask:0xf bank_mask:0xf
    v_mfma_f32_16x16x32_bf16 v[40:43], v[152:155], v[32:35], v[40:43]
    v_and_b32_dpp v32, v49, v8 row_newbcast:8 row_mask:0xf bank_mask:0xf
    v_and_b32_dpp v33, v49, v9 row_newbcast:8 row_mask:0xf bank_mask:0xf
    v_and_b32_dpp v34, v49, v10 row_newbcast:8 row_mask:0xf bank_mask:0xf
    v_and_b32_dpp v35, v49, v11 row_newbcast:8 row_mask:0xf bank_mask:0xf
    v_mfma_f32_16x16x32_bf16 v[40:43], v[156:159], v[36:39], v[40:43]
    v_and_b32_dpp v36, v49, v8 row_newbcast:9 row_mask:0xf bank_mask:0xf
    v_and_b32_dpp v37, v49, v9 row_newbcast:9 row_mask:0xf bank_mask:0xf
    v_and_b32_dpp v38, v49, v10 row_newbcast:9 row_mask:0xf bank_mask:0xf
    v_and_b32_dpp v39, v49, v11 row_newbcast:9 row_mask:0xf bank_mask:0xf
    v_mfma_f32_16x16x32_bf16 v[40:43], v[160:163], v[32:35], v[40:43]
    v_and_b32_dpp v32, v49, v8 row_newbcast:10 row_mask:0xf bank_mask:0xf
    v_and_b32_dpp v33, v49, v9 row_newbcast:10 row_mask:0xf bank_mask:0xf
    v_and_b32_dpp v34, v49, v10 row_newbcast:10 row_mask:0xf bank_mask:0xf
    v_and_b32_dpp v35, v49, v11 row_newbcast:10 row_mask:0xf bank_mask:0xf
    v_mfma_f32_16x16x32_bf16 v[40:43], v[164:167], v[36:39], v[40:43]
    v_and_b32_dpp v36, v49, v8 row_newbcast:11 row_mask:0xf bank_mask:0xf
    v_and_b32_dpp v37, v49, v9 row_newbcast:11 row_mask:0xf bank_mask:0xf
    v_and_b32_dpp v38, v49, v10 row_newbcast:11 row_mask:0xf bank_mask:0xf
    v_and_b32_dpp v39, v49, v11 row_newbcast:11 row_mask:0xf bank_mask:0xf
    v_mfma_f32_16x16x32_bf16 v[40:43], v[168:171], v[32:35], v[40:43]
    v_and_b32_dpp v32, v49, v8 row_newbcast:12 row_mask:0xf bank_mask:0xf
    v_and_b32_dpp v33, v49, v9 row_newbcast:12 row_mask:0xf bank_mask:0xf
    v_and_b32_dpp v34, v49, v10 row_newbcast:12 row_mask:0xf bank_mask:0xf
    v_and_b32_dpp v35, v49, v11 row_newbcast:12 row_mask:0xf bank_mask:0xf
    v_mfma_f32_16x16x32_bf16 v[40:43], v[172:175], v[36:39], v[40:43]
    v_and_b32_dpp v36, v49, v8 row_newbcast:13 row_mask:0xf bank_mask:0xf
    v_and_b32_dpp v37, v49, v9 row_newbcast:13 row_mask:0xf bank_mask:0xf
    v_and_b32_dpp v38, v49, v10 row_newbcast:13 row_mask:0xf bank_mask:0xf
    v_and_b32_dpp v39, v49, v11 row_newbcast:13 row_mask:0xf bank_mask:0xf
    v_mfma_f32_16x16x32_bf16 v[40:43], v[176:179], v[32:35], v[40:43]
    v_and_b32_dpp v32, v49, v8 row_newbcast:14 row_mask:0xf bank_mask:0xf
    v_and_b32_dpp v33, v49, v9 row_newbcast:14 row_mask:0xf bank_mask:0xf
    v_and_b32_dpp v34, v49, v10 row_newbcast:14 row_mask:0xf bank_mask:0xf
    v_and_b32_dpp v35, v49, v11 row_newbcast:14 row_mask:0xf bank_mask:0xf
    v_mfma_f32_16x16x32_bf16 v[40:43], v[180:183], v[36:39], v[40:43]
    v_and_b32_dpp v36, v49, v8 row_newbcast:15 row_mask:0xf bank_mask:0xf
    v_and_b32_dpp v37, v49, v9 row_newbcast:15 row_mask:0xf bank_mask:0xf
    v_and_b32_dpp v38, v49, v10 row_newbcast:15 row_mask:0xf bank_mask:0xf
    v_and_b32_dpp v39, v49, v11 row_newbcast:15 row_mask:0xf bank_mask:0xf
    v_mfma_f32_16x16x32_bf16 v[40:43], v[184:187], v[32:35], v[40:43]
    s_nop 0
    v_mfma_f32_16x16x32_bf16 v[40:43], v[188:191], v[36:39], v[40:43]
    s_mov_b64 exec, s[96:97]
    s_nop 6
    buffer_store_dwordx4 v[40:43], v31, s[68:71], s14 offen sc1
    s_mov_b64 exec, -1
    v_mov_b32 v62, 1
    s_waitcnt vmcnt(0)
    s_mov_b64 exec, 1
    buffer_atomic_add v62, v23, s[68:71], s45 offen sc0
    s_waitcnt vmcnt(0)
    v_readfirstlane_b32 s46, v62
    s_mov_b64 exec, -1
    s_cmp_lg_u32 s46, 0
    s_cbranch_scc1 L_notfirst
    buffer_load_dword v62, v23, s[68:71], s45 offen offset:256 sc1
    s_waitcnt vmcnt(0)
    v_readfirstlane_b32 s7, v62
    s_mov_b32 s47, 0x10001
    s_cmp_lg_u32 s7, 32
    s_cbranch_scc1 L_ret1
    s_mov_b32 s47, 1
    s_mov_b32 s44, 0
L_mlpred:
    buffer_load_dwordx4 v[64:67], v22, s[68:71], s76 offen sc1
    buffer_load_dwordx4 v[68:71], v22, s[68:71], s77 offen sc1
    buffer_load_dwordx4 v[72:75], v22, s[68:71], s78 offen sc1
    buffer_load_dwordx4 v[76:79], v22, s[68:71], s79 offen sc1
    buffer_load_dwordx4 v[80:83], v22, s[68:71], s80 offen sc1
    buffer_load_dwordx4 v[84:87], v22, s[68:71], s81 offen sc1
    buffer_load_dwordx4 v[88:91], v22, s[68:71], s82 offen sc1
    buffer_load_dwordx4 v[92:95], v22, s[68:71], s83 offen sc1
    buffer_load_dwordx4 v[96:99], v22, s[68:71], s84 offen sc1
    buffer_load_dwordx4 v[100:103], v22, s[68:71], s85 offen sc1
    buffer_load_dwordx4 v[104:107], v22, s[68:71], s86 offen sc1
    buffer_load_dwordx4 v[108:111], v22, s[68:71], s87 offen sc1
    buffer_load_dwordx4 v[112:115], v22, s[68:71], s88 offen sc1
    buffer_load_dwordx4 v[116:119], v22, s[68:71], s89 offen sc1
    buffer_load_dwordx4 v[120:123], v22, s[68:71], s90 offen sc1
    buffer_load_dwordx4 v[124:127], v22, s[68:71], s91 offen sc1
    s_waitcnt vmcnt(0)
    v_pk_add_f32 v[64:65], v[64:65], v[68:69]
    v_pk_add_f32 v[66:67], v[66:67], v[70:71]
    v_pk_add_f32 v[72:73], v[72:73], v[76:77]
    v_pk_add_f32 v[74:75], v[74:75], v[78:79]
    v_pk_add_f32 v[80:81], v[80:81], v[84:85]
    v_pk_add_f32 v[82:83], v[82:83], v[86:87]
    v_pk_add_f32 v[88:89], v[88:89], v[92:93]
    v_pk_add_f32 v[90:91], v[90:91], v[94:95]
    v_pk_add_f32 v[96:97], v[96:97], v[100:101]
    v_pk_add_f32 v[98:99], v[98:99], v[102:103]
    v_pk_add_f32 v[104:105], v[104:105], v[108:109]
    v_pk_add_f32 v[106:107], v[106:107], v[110:111]
    v_pk_add_f32 v[112:113], v[112:113], v[116:117]
    v_pk_add_f32 v[114:115], v[114:115], v[118:119]
    v_pk_add_f32 v[120:121], v[120:121], v[124:125]
    v_pk_add_f32 v[122:123], v[122:123], v[126:127]
    v_pk_add_f32 v[64:65], v[64:65], v[72:73]
    v_pk_add_f32 v[66:67], v[66:67], v[74:75]
    v_pk_add_f32 v[80:81], v[80:81], v[88:89]
    v_pk_add_f32 v[82:83], v[82:83], v[90:91]
    v_pk_add_f32 v[96:97], v[96:97], v[104:105]
    v_pk_add_f32 v[98:99], v[98:99], v[106:107]
    v_pk_add_f32 v[112:113], v[112:113], v[120:121]
    v_pk_add_f32 v[114:115], v[114:115], v[122:123]
    v_pk_add_f32 v[64:65], v[64:65], v[80:81]
    v_pk_add_f32 v[66:67], v[66:67], v[82:83]
    v_pk_add_f32 v[96:97], v[96:97], v[112:113]
    v_pk_add_f32 v[98:99], v[98:99], v[114:115]
    v_pk_add_f32 v[64:65], v[64:65], v[96:97]
    v_pk_add_f32 v[66:67], v[66:67], v[98:99]
    v_mov_b32 v68, v64
    v_mov_b32 v69, v65
    v_mov_b32 v70, v66
    v_mov_b32 v71, v67
    v_permlane32_swap_b32 v64, v68
    v_permlane32_swap_b32 v65, v69
    v_permlane32_swap_b32 v66, v70
    v_permlane32_swap_b32 v67, v71
    v_add_f32 v64, v64, v68
    v_add_f32 v65, v65, v69
    v_add_f32 v66, v66, v70
    v_add_f32 v67, v67, v71
    v_cvt_pk_bf16_f32 v64, v64, v64
    v_and_b32 v64, 0xffff0000, v64
    v_cvt_pk_bf16_f32 v65, v65, v65
    v_and_b32 v65, 0xffff0000, v65
    v_cvt_pk_bf16_f32 v66, v66, v66
    v_and_b32 v66, 0xffff0000, v66
    v_cvt_pk_bf16_f32 v67, v67, v67
    v_and_b32 v67, 0xffff0000, v67
    v_add_f32 v56, v64, v12
    v_add_f32 v57, v65, v13
    v_add_f32 v58, v66, v14
    v_add_f32 v59, v67, v15
    v_cvt_pk_bf16_f32 v56, v56, v56
    v_and_b32 v56, 0xffff0000, v56
    v_cvt_pk_bf16_f32 v57, v57, v57
    v_and_b32 v57, 0xffff0000, v57
    v_cvt_pk_bf16_f32 v58, v58, v58
    v_and_b32 v58, 0xffff0000, v58
    v_cvt_pk_bf16_f32 v59, v59, v59
    v_and_b32 v59, 0xffff0000, v59
    s_mov_b64 exec, 0xffffffff
    buffer_store_dwordx4 v[56:59], v27, s[68:71], s9 offen sc1
    s_mov_b64 exec, -1
    s_waitcnt vmcnt(0)
    s_cmp_lg_u32 s44, 0
    s_cbranch_scc1 L_final
L_ret1:
    v_mov_b32 v62, s47
    s_mov_b64 exec, 1
    buffer_atomic_add v62, v23, s[68:71], s45 offen sc0
    s_waitcnt vmcnt(0)
    v_readfirstlane_b32 s46, v62
    s_mov_b64 exec, -1
    s_and_b32 s47, s47, 0x10000
    s_or_b32 s46, s46, s47
L_notfirst:
    s_and_b32 s7, s46, 0xffff
    s_cmp_lg_u32 s7, 32
    s_cbranch_scc1 L_end
    s_mov_b32 s44, 1
    s_bitcmp1_b32 s46, 16
    s_cbranch_scc1 L_mlpred
L_final:
    buffer_load_dwordx4 v[64:67], v26, s[68:71], s76 offen sc1
    buffer_load_dwordx4 v[68:71], v26, s[68:71], s77 offen sc1
    buffer_load_dwordx4 v[72:75], v26, s[68:71], s78 offen sc1
    buffer_load_dwordx4 v[76:79], v26, s[68:71], s79 offen sc1
    buffer_load_dwordx4 v[80:83], v26, s[68:71], s80 offen sc1
    buffer_load_dwordx4 v[84:87], v26, s[68:71], s81 offen sc1
    buffer_load_dwordx4 v[88:91], v26, s[68:71], s82 offen sc1
    buffer_load_dwordx4 v[92:95], v26, s[68:71], s83 offen sc1
    buffer_load_dwordx4 v[96:99], v26, s[68:71], s84 offen sc1
    buffer_load_dwordx4 v[100:103], v26, s[68:71], s85 offen sc1
    buffer_load_dwordx4 v[104:107], v26, s[68:71], s86 offen sc1
    buffer_load_dwordx4 v[108:111], v26, s[68:71], s87 offen sc1
    buffer_load_dwordx4 v[112:115], v26, s[68:71], s88 offen sc1
    buffer_load_dwordx4 v[116:119], v26, s[68:71], s89 offen sc1
    buffer_load_dwordx4 v[120:123], v26, s[68:71], s90 offen sc1
    buffer_load_dwordx4 v[124:127], v26, s[68:71], s91 offen sc1
    buffer_load_dwordx4 v[44:47], v27, s[68:71], s9 offen sc1
    s_waitcnt vmcnt(15)
    v_pk_add_f32 v[64:65], v[64:65], v[68:69]
    v_pk_add_f32 v[66:67], v[66:67], v[70:71]
    s_waitcnt vmcnt(13)
    v_pk_add_f32 v[72:73], v[72:73], v[76:77]
    v_pk_add_f32 v[74:75], v[74:75], v[78:79]
    s_waitcnt vmcnt(11)
    v_pk_add_f32 v[80:81], v[80:81], v[84:85]
    v_pk_add_f32 v[82:83], v[82:83], v[86:87]
    s_waitcnt vmcnt(9)
    v_pk_add_f32 v[88:89], v[88:89], v[92:93]
    v_pk_add_f32 v[90:91], v[90:91], v[94:95]
    s_waitcnt vmcnt(7)
    v_pk_add_f32 v[96:97], v[96:97], v[100:101]
    v_pk_add_f32 v[98:99], v[98:99], v[102:103]
    s_waitcnt vmcnt(5)
    v_pk_add_f32 v[104:105], v[104:105], v[108:109]
    v_pk_add_f32 v[106:107], v[106:107], v[110:111]
    s_waitcnt vmcnt(3)
    v_pk_add_f32 v[112:113], v[112:113], v[116:117]
    v_pk_add_f32 v[114:115], v[114:115], v[118:119]
    s_waitcnt vmcnt(1)
    v_pk_add_f32 v[120:121], v[120:121], v[124:125]
    v_pk_add_f32 v[122:123], v[122:123], v[126:127]
    v_pk_add_f32 v[64:65], v[64:65], v[72:73]
    v_pk_add_f32 v[66:67], v[66:67], v[74:75]
    v_pk_add_f32 v[80:81], v[80:81], v[88:89]
    v_pk_add_f32 v[82:83], v[82:83], v[90:91]
    v_pk_add_f32 v[96:97], v[96:97], v[104:105]
    v_pk_add_f32 v[98:99], v[98:99], v[106:107]
    v_pk_add_f32 v[112:113], v[112:113], v[120:121]
    v_pk_add_f32 v[114:115], v[114:115], v[122:123]
    v_pk_add_f32 v[64:65], v[64:65], v[80:81]
    v_pk_add_f32 v[66:67], v[66:67], v[82:83]
    v_pk_add_f32 v[96:97], v[96:97], v[112:113]
    v_pk_add_f32 v[98:99], v[98:99], v[114:115]
    v_pk_add_f32 v[64:65], v[64:65], v[96:97]
    v_pk_add_f32 v[66:67], v[66:67], v[98:99]
    v_mov_b32 v68, v64
    v_mov_b32 v69, v65
    v_mov_b32 v70, v66
    v_mov_b32 v71, v67
    v_permlane32_swap_b32 v64, v68
    v_permlane32_swap_b32 v65, v69
    v_permlane32_swap_b32 v66, v70
    v_permlane32_swap_b32 v67, v71
    v_add_f32 v64, v64, v68
    v_add_f32 v65, v65, v69
    v_add_f32 v66, v66, v70
    v_add_f32 v67, v67, v71
    v_cvt_pk_bf16_f32 v64, v64, v64
    v_and_b32 v64, 0xffff0000, v64
    v_cvt_pk_bf16_f32 v65, v65, v65
    v_and_b32 v65, 0xffff0000, v65
    v_cvt_pk_bf16_f32 v66, v66, v66
    v_and_b32 v66, 0xffff0000, v66
    v_cvt_pk_bf16_f32 v67, v67, v67
    v_and_b32 v67, 0xffff0000, v67
    v_add_f32 v64, v64, v16
    v_add_f32 v65, v65, v17
    v_add_f32 v66, v66, v18
    v_add_f32 v67, v67, v19
    v_cvt_pk_bf16_f32 v64, v64, v64
    v_and_b32 v64, 0xffff0000, v64
    v_cvt_pk_bf16_f32 v65, v65, v65
    v_and_b32 v65, 0xffff0000, v65
    v_cvt_pk_bf16_f32 v66, v66, v66
    v_and_b32 v66, 0xffff0000, v66
    v_cvt_pk_bf16_f32 v67, v67, v67
    v_and_b32 v67, 0xffff0000, v67
    s_waitcnt vmcnt(0)
    v_add_f32 v64, v64, v44
    v_add_f32 v65, v65, v45
    v_add_f32 v66, v66, v46
    v_add_f32 v67, v67, v47
    v_cvt_pk_bf16_f32 v64, v64, v64
    v_cvt_pk_bf16_f32 v65, v65, v65
    v_cvt_pk_bf16_f32 v66, v66, v66
    v_cvt_pk_bf16_f32 v67, v67, v67
    s_mov_b64 exec, 0xffffffff
    buffer_store_short v64, v29, s[72:75], s10 offen offset:0
    buffer_store_short v65, v29, s[72:75], s10 offen offset:16
    buffer_store_short v66, v29, s[72:75], s10 offen offset:32
    buffer_store_short v67, v29, s[72:75], s10 offen offset:48
    s_mov_b64 exec, -1
L_end:
L_done:
s_endpgm
.section .rodata,"a"
.p2align 6
.amdhsa_kernel parallel_sum__mha_block_cached__dense_activation_gelu__decode_kernel
  .amdhsa_next_free_vgpr 256
  .amdhsa_next_free_sgpr 102
  .amdhsa_accum_offset 256
  .amdhsa_group_segment_fixed_size 0
  .amdhsa_kernarg_size 104
  .amdhsa_user_sgpr_count 2
  .amdhsa_user_sgpr_kernarg_segment_ptr 1
  .amdhsa_system_sgpr_workgroup_id_x 1
  .amdhsa_float_denorm_mode_32 3
.end_amdhsa_kernel
```
